```python
import torch

def _softmax(x, axis=-1):
    return torch.softmax(x, dim=axis)

def _gelu(x):
    return torch.nn.functional.gelu(x, approximate='tanh')

def _silu(x):
    return torch.nn.functional.silu(x)

def _sigmoid(x):
    return torch.sigmoid(x)

def _layernorm(x, axis=-1, eps=1e-05):
    m = x.mean(dim=axis, keepdim=True)
    v = x.var(dim=axis, keepdim=True, unbiased=False)
    return (x - m) / torch.sqrt(v + eps)

def _scatter_add(tgt, idx, src, axis=0):
    return tgt.clone().index_add_(axis, idx, src)

def _segment_sum(src, seg, n):
    out = torch.zeros((n,) + src.shape[1:], dtype=src.dtype)
    return out.index_add_(0, seg, src)

def _pad(x, pw):
    flat = tuple((v for pair in reversed(pw) for v in pair))
    return torch.nn.functional.pad(x, flat)
kernel_name = 'gated_mix__memory_aug_recurrent_mem_tr__ssm_conv_s4d__prompt'

def setup_inputs():

    _w = lambda a: (lambda t: t.to(torch.bfloat16) if t.is_floating_point() else t)(torch.as_tensor(a))

    def _A_setup():
        B, S, Dm = (1, 2048, 576)
        H, Dh = (32, 128)
        M, seg = (8, 32)
        seg = min(seg, S)
        S = S // seg * seg
        return {'x': _w((lambda *s: torch.randn(*s, dtype=torch.bfloat16) * 0.05)(B, S, Dm)), 'mem0': _w((lambda *s: torch.randn(*s, dtype=torch.bfloat16) * 0.4)(B, M, Dm)), 'Wq': _w((lambda *s: torch.randn(*s, dtype=torch.bfloat16) * 6.4)(Dm, H, Dh) * Dm ** (-0.5)), 'Wk': _w((lambda *s: torch.randn(*s, dtype=torch.bfloat16) * 6.4)(Dm, H, Dh) * Dm ** (-0.5)), 'Wv': _w((lambda *s: torch.randn(*s, dtype=torch.bfloat16) * 0.4)(Dm, H, Dh) * Dm ** (-0.5)), 'Wo': _w((lambda *s: torch.randn(*s, dtype=torch.bfloat16) * 0.4)(H, Dh, Dm) * (H * Dh) ** (-0.5)), 'seg_len': seg}
    _A_in = _A_setup()

    def _B_setup():
        Bsz, L, D, N = (1, 2048, 576, 128)
        return {'u': _w((lambda *s: torch.randn(*s, dtype=torch.bfloat16) * 0.05)(Bsz, L, D)), 'log_A_real': _w((lambda *s: torch.randn(*s, dtype=torch.bfloat16) * 6.4)(D, N) * 0.5), 'A_imag': _w((lambda *s: torch.randn(*s, dtype=torch.bfloat16) * 0.05)(D, N) * 3.14), 'C_real': _w((lambda *s: torch.randn(*s, dtype=torch.bfloat16) * 0.2)(D, N) / N ** 0.5), 'C_imag': _w((lambda *s: torch.randn(*s, dtype=torch.bfloat16) * 0.2)(D, N) / N ** 0.5), 'log_dt': _w((lambda *s: torch.randn(*s, dtype=torch.bfloat16) * 0.05)(D) * 0.5 - 4.0), 'D_skip': _w((lambda *s: torch.randn(*s, dtype=torch.bfloat16) * 0.05)(D))}
    _B_in = _B_setup()
    return {'A_x': _A_in['x'], 'A_mem0': _A_in['mem0'], 'A_Wq': _A_in['Wq'], 'A_Wk': _A_in['Wk'], 'A_Wv': _A_in['Wv'], 'A_Wo': _A_in['Wo'], 'A_seg_len': _A_in['seg_len'], 'B_u': _B_in['u'], 'B_log_A_real': _B_in['log_A_real'], 'B_A_imag': _B_in['A_imag'], 'B_C_real': _B_in['C_real'], 'B_C_imag': _B_in['C_imag'], 'B_log_dt': _B_in['log_dt'], 'B_D_skip': _B_in['D_skip'], 'gate_w': _w((lambda *s: torch.randn(*s, dtype=torch.bfloat16) * 0.05)(576) * 16.0)}

def reference(A_x, A_mem0, A_Wq, A_Wk, A_Wv, A_Wo, A_seg_len, B_u, B_log_A_real, B_A_imag, B_C_real, B_C_imag, B_log_dt, B_D_skip, gate_w):

    def _A_ref(x, mem0, Wq, Wk, Wv, Wo, seg_len):
        B, S, Dm = x.shape
        H, Dh = (Wq.shape[1], Wq.shape[2])
        M = mem0.shape[1]
        scale = Dh ** (-0.5)
        n_seg = S // seg_len
        L = M + seg_len
        idx = torch.arange(L)
        mask = (idx[:, None] < M) | (idx[:, None] >= idx[None, :])
        mem = mem0
        outs = []
        for s in range(n_seg):
            xs = x[:, s * seg_len:(s + 1) * seg_len, :].clone()
            h = torch.concatenate([mem, xs], axis=1)
            q = torch.einsum('btd,dhe->bhte', h, Wq)
            k = torch.einsum('btd,dhe->bhte', h, Wk)
            v = torch.einsum('btd,dhe->bhte', h, Wv)
            scores = torch.einsum('bhqe,bhke->bhqk', q, k) * scale
            scores = torch.where(mask[None, None], scores, -1000000000.0)
            p = _softmax(scores, axis=-1)
            o = torch.einsum('bhqk,bhke->bhqe', p, v)
            o = torch.einsum('bhte,hed->btd', o, Wo)
            mem = o[:, :M, :].clone()
            outs.append(o[:, M:, :])
        return torch.concatenate(outs, axis=1)

    def _B_ref(u, log_A_real, A_imag, C_real, C_imag, log_dt, D_skip):
        L = u.shape[1]
        dt = torch.exp(log_dt)
        A = -torch.exp(log_A_real) + 1j * A_imag
        C = (C_real + 1j * C_imag) * dt[:, None]
        pos = (lambda x, dt: x.to(dt))(torch.arange(L), log_dt.dtype)
        P = torch.exp((A * dt[:, None])[:, :, None] * pos[None, None, :])
        K = 2.0 * torch.einsum('dn,dnl->dl', C, P).real
        L2 = 2 * L
        u_t = (lambda x, *d: x.permute(*d))(u, 0, 2, 1)
        Kf = (lambda x, *a, **k: torch.fft.rfft(x.float(), *a, **k))(K, L2)
        Uf = (lambda x, *a, **k: torch.fft.rfft(x.float(), *a, **k))(u_t, L2)
        y = (lambda x, *a, **k: torch.fft.irfft(x, *a, **k).to(torch.bfloat16))(Uf * Kf[None, :, :], L2)[:, :, :L]
        y = (lambda x, *d: x.permute(*d))(y, 0, 2, 1)
        return y + u * D_skip[None, None, :]
    x = A_x
    g = _sigmoid((x * gate_w).sum(-1, keepdims=True))
    a = _A_ref(x, A_mem0, A_Wq, A_Wk, A_Wv, A_Wo, A_seg_len)
    b = _B_ref(x, B_log_A_real, B_A_imag, B_C_real, B_C_imag, B_log_dt, B_D_skip)
    return g * a + (1 - g) * b
```

```asm
; @launch grid=(256,1,1) block=(256,1,1) lds=163840
.amdgcn_target "amdgcn-amd-amdhsa--gfx950"
.text
.globl gated_mix__memory_aug_recurrent_mem_tr__ssm_conv_s4d__prompt_kernel
.p2align 8
.type gated_mix__memory_aug_recurrent_mem_tr__ssm_conv_s4d__prompt_kernel,@function
gated_mix__memory_aug_recurrent_mem_tr__ssm_conv_s4d__prompt_kernel:
s_load_dwordx2 s[8:9], s[0:1], 136
s_mov_b32 s10, 67108864
s_mov_b32 s11, 0x00020000
s_load_dwordx2 s[12:13], s[0:1], 128
s_load_dwordx2 s[16:17], s[0:1], 16
s_mov_b32 s18, 4718592
s_mov_b32 s19, 0x00020000
s_load_dwordx2 s[20:21], s[0:1], 24
s_mov_b32 s22, 4718592
s_mov_b32 s23, 0x00020000
s_load_dwordx2 s[24:25], s[0:1], 32
s_mov_b32 s26, 4718592
s_mov_b32 s27, 0x00020000
s_load_dwordx2 s[28:29], s[0:1], 40
s_mov_b32 s30, 4718592
s_mov_b32 s31, 0x00020000
s_load_dwordx2 s[32:33], s[0:1], 0
s_mov_b32 s34, 2359296
s_mov_b32 s35, 0x00020000
s_and_b32 s40, s2, 7
s_lshl_b32 s40, s40, 5
s_lshr_b32 s3, s2, 3
s_add_u32 s40, s40, s3
v_lshrrev_b32 v1, 6, v0
s_nop 0
v_readfirstlane_b32 s42, v1
v_and_b32 v0, 63, v0
s_mov_b32 s45, 400000
s_waitcnt lgkmcnt(0)
s_cmp_ge_u32 s2, 256
s_cbranch_scc1 EXIT
s_cmp_lt_u32 s40, 32
s_cbranch_scc1 CHAIN
s_cmp_lt_u32 s40, 160
s_cbranch_scc1 PROJ
s_branch OUTP
CHAIN:
s_mov_b32 s41, s40
s_getreg_b32 s46, hwreg(HW_REG_XCC_ID, 0, 4)
s_load_dwordx2 s[36:37], s[0:1], 8
s_mov_b32 s38, 9216
s_mov_b32 s39, 0x00020000
s_mov_b32 s50, 0
s_mov_b32 s51, 32768
s_mov_b32 s52, 65536
s_mov_b32 s53, 98304
s_mov_b32 s54, 131072
s_mov_b32 s55, 163840
s_mov_b32 s56, 196608
s_mov_b32 s57, 229376
s_mov_b32 s58, 262144
s_mov_b32 s60, 0x000f000f
s_mov_b32 s61, 0x000f000f
s_mov_b32 s62, 0xcccccccc
s_mov_b32 s63, 0xcccccccc
s_mul_i32 s47, s42, 36864
s_lshl_b32 s48, s42, 18
s_lshl_b32 s49, s42, 17
s_lshl_b32 s2, s41, 8
v_lshrrev_b32 v1, 4, v0
v_and_b32 v2, 15, v0
v_lshlrev_b32 v3, 2, v1
v_xor_b32 v2, v2, v3
v_lshl_add_u32 v3, v1, 13, s2
v_lshl_add_u32 v44, v2, 4, v3
v_xor_b32 v45, 32, v44
s_lshr_b32 s3, s42, 1
s_lshl_b32 s3, s3, 3
s_and_b32 s14, s42, 1
s_add_u32 s3, s3, s14
s_mul_i32 s3, s3, 4608
s_mul_i32 s2, s41, 147456
s_add_u32 s2, s2, s3
v_lshrrev_b32 v3, 1, v1
v_and_b32 v4, 1, v1
v_lshl_add_u32 v3, v3, 4, v4
v_lshrrev_b32 v4, 3, v2
v_lshl_add_u32 v3, v4, 6, v3
v_xor_b32 v5, 64, v3
v_lshl_add_u32 v6, v2, 4, s2
v_mul_u32_u24 v3, 1152, v3
v_mul_u32_u24 v5, 1152, v5
v_add_u32 v46, v3, v6
v_add_u32 v47, v5, v6
v_lshlrev_b32 v4, 7, v4
v_sub_u32 v48, v46, v4
s_add_u32 m0, s47, 0
s_mov_b32 s2, 0
buffer_load_dwordx4 v46, s[28:31], s2 offen offset:0 lds
s_mov_b32 s2, 1280
buffer_load_dwordx4 v46, s[28:31], s2 offen offset:1024 lds
s_mov_b32 s2, 7168
buffer_load_dwordx4 v46, s[28:31], s2 offen offset:2048 lds
s_mov_b32 s2, 8448
buffer_load_dwordx4 v46, s[28:31], s2 offen offset:3072 lds
s_add_u32 m0, s47, 4096
s_mov_b32 s2, 256
buffer_load_dwordx4 v46, s[28:31], s2 offen offset:0 lds
s_mov_b32 s2, 1536
buffer_load_dwordx4 v46, s[28:31], s2 offen offset:1024 lds
s_mov_b32 s2, 7424
buffer_load_dwordx4 v46, s[28:31], s2 offen offset:2048 lds
s_mov_b32 s2, 8704
buffer_load_dwordx4 v46, s[28:31], s2 offen offset:3072 lds
s_add_u32 m0, s47, 8192
s_mov_b32 s2, 256
buffer_load_dwordx4 v47, s[28:31], s2 offen offset:0 lds
s_mov_b32 s2, 1536
buffer_load_dwordx4 v47, s[28:31], s2 offen offset:1024 lds
s_mov_b32 s2, 7424
buffer_load_dwordx4 v47, s[28:31], s2 offen offset:2048 lds
s_mov_b32 s2, 8704
buffer_load_dwordx4 v47, s[28:31], s2 offen offset:3072 lds
s_add_u32 m0, s47, 12288
s_mov_b32 s2, 512
buffer_load_dwordx4 v46, s[28:31], s2 offen offset:0 lds
s_mov_b32 s2, 1792
buffer_load_dwordx4 v46, s[28:31], s2 offen offset:1024 lds
s_mov_b32 s2, 7680
buffer_load_dwordx4 v46, s[28:31], s2 offen offset:2048 lds
s_mov_b32 s2, 8960
buffer_load_dwordx4 v46, s[28:31], s2 offen offset:3072 lds
s_add_u32 m0, s47, 16384
s_mov_b32 s2, 768
buffer_load_dwordx4 v46, s[28:31], s2 offen offset:0 lds
s_mov_b32 s2, 2048
buffer_load_dwordx4 v46, s[28:31], s2 offen offset:1024 lds
s_mov_b32 s2, 7936
buffer_load_dwordx4 v46, s[28:31], s2 offen offset:2048 lds
s_mov_b32 s2, 9216
buffer_load_dwordx4 v46, s[28:31], s2 offen offset:3072 lds
s_add_u32 m0, s47, 20480
s_mov_b32 s2, 768
buffer_load_dwordx4 v47, s[28:31], s2 offen offset:0 lds
s_mov_b32 s2, 2048
buffer_load_dwordx4 v47, s[28:31], s2 offen offset:1024 lds
s_mov_b32 s2, 7936
buffer_load_dwordx4 v47, s[28:31], s2 offen offset:2048 lds
s_mov_b32 s2, 9216
buffer_load_dwordx4 v47, s[28:31], s2 offen offset:3072 lds
s_add_u32 m0, s47, 24576
s_add_u32 s2, s48, 0
buffer_load_dwordx4 v44, s[24:27], s2 offen offset:0 lds
s_add_u32 s2, s48, 31744
buffer_load_dwordx4 v44, s[24:27], s2 offen offset:1024 lds
s_add_u32 s2, s48, 63488
buffer_load_dwordx4 v45, s[24:27], s2 offen offset:2048 lds
s_add_u32 s2, s48, 95232
buffer_load_dwordx4 v45, s[24:27], s2 offen offset:3072 lds
s_add_u32 m0, s47, 28672
s_add_u32 s2, s48, 131072
buffer_load_dwordx4 v44, s[24:27], s2 offen offset:0 lds
s_add_u32 s2, s48, 162816
buffer_load_dwordx4 v44, s[24:27], s2 offen offset:1024 lds
s_add_u32 s2, s48, 194560
buffer_load_dwordx4 v45, s[24:27], s2 offen offset:2048 lds
s_add_u32 s2, s48, 226304
buffer_load_dwordx4 v45, s[24:27], s2 offen offset:3072 lds
s_add_u32 m0, s47, 32768
s_add_u32 s2, s48, 1048576
buffer_load_dwordx4 v44, s[24:27], s2 offen offset:0 lds
s_add_u32 s2, s48, 1080320
buffer_load_dwordx4 v44, s[24:27], s2 offen offset:1024 lds
s_add_u32 s2, s48, 1112064
buffer_load_dwordx4 v45, s[24:27], s2 offen offset:2048 lds
s_add_u32 s2, s48, 1143808
buffer_load_dwordx4 v45, s[24:27], s2 offen offset:3072 lds
v_lshrrev_b32 v2, 1, v1
v_mul_u32_u24 v2, 36864, v2
v_and_b32 v3, 1, v1
v_lshl_add_u32 v2, v3, 11, v2
v_lshl_add_u32 v2, v3, 5, v2
v_bfe_u32 v3, v0, 2, 2
v_lshl_add_u32 v2, v3, 8, v2
v_xor_b32 v3, s42, v3
v_lshl_add_u32 v2, v3, 6, v2
v_and_b32 v3, 3, v0
v_lshl_add_u32 v50, v3, 3, v2
v_add_u32 v51, 73728, v50
v_xor_b32 v52, 32, v50
v_xor_b32 v53, 32, v51
v_lshl_add_u32 v54, v0, 4, s47
v_bfe_u32 v2, v0, 2, 1
v_and_b32 v3, 1, v1
v_lshl_add_u32 v2, v3, 1, v2
v_lshrrev_b32 v3, 1, v1
v_mul_u32_u24 v3, 36864, v3
v_lshl_add_u32 v3, v2, 8, v3
v_and_b32 v4, 3, v0
v_lshl_add_u32 v3, v4, 3, v3
v_bfe_u32 v4, v0, 3, 1
v_lshlrev_b32 v2, 6, v2
s_lshl_b32 s2, s42, 6
v_lshl_add_u32 v5, v4, 5, s2
v_xor_b32 v5, v5, v2
v_add_u32 v5, v5, v3
s_and_b32 s2, s42, 1
s_mul_i32 s3, s2, 73728
s_sub_u32 s14, 73728, s3
v_add_u32 v56, s3, v5
v_add_u32 v57, s14, v5
v_xor_b32 v4, s2, v4
v_mul_u32_u24 v4, 73728, v4
v_add_u32 v3, v3, v4
s_lshr_b32 s2, s42, 1
s_lshl_b32 s2, s2, 7
s_lshl_b32 s3, s42, 5
s_add_u32 s2, s2, s3
v_xor_b32 v2, s2, v2
v_add_u32 v58, v2, v3
v_xor_b32 v59, 128, v58
v_and_b32 v20, 15, v0
v_lshrrev_b32 v21, 4, v0
s_lshl_b32 s2, s42, 2
v_add_u32 v1, s2, v21
v_lshlrev_b32 v2, 1, v1
v_add_u32 v2, s41, v2
v_and_b32 v2, 31, v2
v_lshlrev_b32 v2, 6, v2
v_lshl_add_u32 v2, v1, 11, v2
v_lshl_add_u32 v2, v20, 2, v2
v_add_u32 v22, 524288, v2
s_lshl_b32 s2, s42, 5
s_add_u32 s2, s2, s41
s_lshl_b32 s64, s2, 11
s_add_u32 s64, s64, 376832
s_and_b32 s3, s41, 15
s_lshl_b32 s65, s3, 11
s_add_u32 s65, s65, 638976
s_lshl_b32 s2, s2, 6
s_add_u32 s2, s2, 262144
v_lshlrev_b32 v2, 4, v21
v_lshl_add_u32 v2, v20, 2, v2
v_add_u32 v23, s2, v2
s_lshl_b32 s66, s42, 11
s_add_u32 s66, s66, 114688
v_mov_b32 v1, 0
buffer_store_dword v1, v22, s[8:11], s50 offen sc1
buffer_store_dword v1, v22, s[8:11], s51 offen sc1
buffer_store_dword v1, v22, s[8:11], s52 offen sc1
buffer_store_dword v1, v22, s[8:11], s53 offen sc1
buffer_store_dword v1, v22, s[8:11], s54 offen sc1
buffer_store_dword v1, v22, s[8:11], s55 offen sc1
buffer_store_dword v1, v22, s[8:11], s56 offen sc1
buffer_store_dword v1, v22, s[8:11], s57 offen sc1
buffer_store_dword v1, v22, s[8:11], s58 offen sc1
s_mov_b64 exec, s[60:61]
buffer_store_dword v1, v23, s[8:11], 0 offen sc1
buffer_store_dword v1, v23, s[8:11], 0 offen offset:2048 sc1
s_mov_b64 exec, -1
v_lshrrev_b32 v1, 1, v20
v_mul_u32_u24 v1, 1152, v1
v_and_b32 v2, 1, v20
v_lshl_add_u32 v1, v2, 2, v1
v_lshl_add_u32 v2, v21, 5, v1
v_lshl_add_u32 v1, v21, 6, v1
s_lshl_b32 s2, s42, 8
s_waitcnt lgkmcnt(0)
buffer_load_dword v24, v1, s[36:39], s2 offen offset:0
buffer_load_dword v25, v1, s[36:39], s2 offen offset:8
buffer_load_dword v26, v1, s[36:39], s2 offen offset:16
buffer_load_dword v27, v1, s[36:39], s2 offen offset:24
buffer_load_dword v28, v1, s[36:39], s2 offen offset:32
buffer_load_dword v29, v1, s[36:39], s2 offen offset:40
buffer_load_dword v30, v1, s[36:39], s2 offen offset:48
buffer_load_dword v31, v1, s[36:39], s2 offen offset:56
buffer_load_dword v32, v2, s[36:39], 0 offen offset:1024
buffer_load_dword v33, v2, s[36:39], 0 offen offset:1032
buffer_load_dword v34, v2, s[36:39], 0 offen offset:1040
buffer_load_dword v35, v2, s[36:39], 0 offen offset:1048
s_waitcnt vmcnt(55)
s_barrier
ds_read_b64_tr_b16 a[80:81], v56 offset:0
ds_read_b64_tr_b16 a[82:83], v56 offset:1024
ds_read_b64_tr_b16 a[84:85], v56 offset:2048
ds_read_b64_tr_b16 a[86:87], v56 offset:3072
ds_read_b64_tr_b16 a[88:89], v57 offset:0
ds_read_b64_tr_b16 a[90:91], v57 offset:1024
ds_read_b64_tr_b16 a[92:93], v57 offset:2048
ds_read_b64_tr_b16 a[94:95], v57 offset:3072
s_waitcnt lgkmcnt(0)
s_waitcnt vmcnt(51)
s_barrier
s_add_u32 m0, s47, 0
s_mov_b32 s2, 1024
buffer_load_dwordx4 v48, s[28:31], s2 offen offset:0 lds
s_mov_b32 s2, 2304
buffer_load_dwordx4 v48, s[28:31], s2 offen offset:1024 lds
s_mov_b32 s2, 8192
buffer_load_dwordx4 v48, s[28:31], s2 offen offset:2048 lds
s_mov_b32 s2, 9472
buffer_load_dwordx4 v48, s[28:31], s2 offen offset:3072 lds
ds_read_b64_tr_b16 a[96:97], v56 offset:4096
ds_read_b64_tr_b16 a[98:99], v56 offset:5120
ds_read_b64_tr_b16 a[100:101], v56 offset:6144
ds_read_b64_tr_b16 a[102:103], v56 offset:7168
ds_read_b64_tr_b16 a[104:105], v57 offset:4096
ds_read_b64_tr_b16 a[106:107], v57 offset:5120
ds_read_b64_tr_b16 a[108:109], v57 offset:6144
ds_read_b64_tr_b16 a[110:111], v57 offset:7168
s_waitcnt lgkmcnt(0)
s_waitcnt vmcnt(51)
s_barrier
s_add_u32 m0, s47, 4096
s_mov_b32 s2, 0
buffer_load_dwordx4 v47, s[28:31], s2 offen offset:0 lds
s_mov_b32 s2, 1280
buffer_load_dwordx4 v47, s[28:31], s2 offen offset:1024 lds
s_mov_b32 s2, 7168
buffer_load_dwordx4 v47, s[28:31], s2 offen offset:2048 lds
s_mov_b32 s2, 8448
buffer_load_dwordx4 v47, s[28:31], s2 offen offset:3072 lds
ds_read_b64_tr_b16 a[160:161], v56 offset:8192
ds_read_b64_tr_b16 a[162:163], v56 offset:9216
ds_read_b64_tr_b16 a[164:165], v56 offset:10240
ds_read_b64_tr_b16 a[166:167], v56 offset:11264
ds_read_b64_tr_b16 a[168:169], v57 offset:8192
ds_read_b64_tr_b16 a[170:171], v57 offset:9216
ds_read_b64_tr_b16 a[172:173], v57 offset:10240
ds_read_b64_tr_b16 a[174:175], v57 offset:11264
s_waitcnt lgkmcnt(0)
s_waitcnt vmcnt(51)
s_barrier
s_add_u32 m0, s47, 8192
s_mov_b32 s2, 512
buffer_load_dwordx4 v47, s[28:31], s2 offen offset:0 lds
s_mov_b32 s2, 1792
buffer_load_dwordx4 v47, s[28:31], s2 offen offset:1024 lds
s_mov_b32 s2, 7680
buffer_load_dwordx4 v47, s[28:31], s2 offen offset:2048 lds
s_mov_b32 s2, 8960
buffer_load_dwordx4 v47, s[28:31], s2 offen offset:3072 lds
ds_read_b64_tr_b16 a[176:177], v56 offset:12288
ds_read_b64_tr_b16 a[178:179], v56 offset:13312
ds_read_b64_tr_b16 a[180:181], v56 offset:14336
ds_read_b64_tr_b16 a[182:183], v56 offset:15360
ds_read_b64_tr_b16 a[184:185], v57 offset:12288
ds_read_b64_tr_b16 a[186:187], v57 offset:13312
ds_read_b64_tr_b16 a[188:189], v57 offset:14336
ds_read_b64_tr_b16 a[190:191], v57 offset:15360
s_waitcnt lgkmcnt(0)
s_waitcnt vmcnt(51)
s_barrier
s_add_u32 m0, s47, 12288
s_add_u32 s2, s48, 0
buffer_load_dwordx4 v44, s[16:19], s2 offen offset:0 lds
s_add_u32 s2, s48, 31744
buffer_load_dwordx4 v44, s[16:19], s2 offen offset:1024 lds
s_add_u32 s2, s48, 63488
buffer_load_dwordx4 v45, s[16:19], s2 offen offset:2048 lds
s_add_u32 s2, s48, 95232
buffer_load_dwordx4 v45, s[16:19], s2 offen offset:3072 lds
ds_read_b64_tr_b16 a[192:193], v56 offset:16384
ds_read_b64_tr_b16 a[194:195], v56 offset:17408
ds_read_b64_tr_b16 a[196:197], v56 offset:18432
ds_read_b64_tr_b16 a[198:199], v56 offset:19456
ds_read_b64_tr_b16 a[200:201], v57 offset:16384
ds_read_b64_tr_b16 a[202:203], v57 offset:17408
ds_read_b64_tr_b16 a[204:205], v57 offset:18432
ds_read_b64_tr_b16 a[206:207], v57 offset:19456
s_waitcnt lgkmcnt(0)
s_waitcnt vmcnt(51)
s_barrier
s_add_u32 m0, s47, 16384
s_add_u32 s2, s48, 131072
buffer_load_dwordx4 v44, s[16:19], s2 offen offset:0 lds
s_add_u32 s2, s48, 162816
buffer_load_dwordx4 v44, s[16:19], s2 offen offset:1024 lds
s_add_u32 s2, s48, 194560
buffer_load_dwordx4 v45, s[16:19], s2 offen offset:2048 lds
s_add_u32 s2, s48, 226304
buffer_load_dwordx4 v45, s[16:19], s2 offen offset:3072 lds
ds_read_b64_tr_b16 a[208:209], v56 offset:20480
ds_read_b64_tr_b16 a[210:211], v56 offset:21504
ds_read_b64_tr_b16 a[212:213], v56 offset:22528
ds_read_b64_tr_b16 a[214:215], v56 offset:23552
ds_read_b64_tr_b16 a[216:217], v57 offset:20480
ds_read_b64_tr_b16 a[218:219], v57 offset:21504
ds_read_b64_tr_b16 a[220:221], v57 offset:22528
ds_read_b64_tr_b16 a[222:223], v57 offset:23552
s_waitcnt lgkmcnt(0)
s_waitcnt vmcnt(51)
s_barrier
s_add_u32 m0, s47, 20480
s_add_u32 s2, s48, 1048576
buffer_load_dwordx4 v44, s[16:19], s2 offen offset:0 lds
s_add_u32 s2, s48, 1080320
buffer_load_dwordx4 v44, s[16:19], s2 offen offset:1024 lds
s_add_u32 s2, s48, 1112064
buffer_load_dwordx4 v45, s[16:19], s2 offen offset:2048 lds
s_add_u32 s2, s48, 1143808
buffer_load_dwordx4 v45, s[16:19], s2 offen offset:3072 lds
ds_read_b64_tr_b16 a[224:225], v50 offset:24576
ds_read_b64_tr_b16 a[226:227], v50 offset:25600
ds_read_b64_tr_b16 a[228:229], v51 offset:24576
ds_read_b64_tr_b16 a[230:231], v51 offset:25600
ds_read_b64_tr_b16 a[232:233], v52 offset:24576
ds_read_b64_tr_b16 a[234:235], v52 offset:25600
ds_read_b64_tr_b16 a[236:237], v53 offset:24576
ds_read_b64_tr_b16 a[238:239], v53 offset:25600
s_waitcnt lgkmcnt(0)
s_waitcnt vmcnt(51)
s_barrier
s_add_u32 m0, s47, 24576
s_add_u32 s2, s48, 1179648
buffer_load_dwordx4 v44, s[16:19], s2 offen offset:0 lds
s_add_u32 s2, s48, 1211392
buffer_load_dwordx4 v44, s[16:19], s2 offen offset:1024 lds
s_add_u32 s2, s48, 1243136
buffer_load_dwordx4 v45, s[16:19], s2 offen offset:2048 lds
s_add_u32 s2, s48, 1274880
buffer_load_dwordx4 v45, s[16:19], s2 offen offset:3072 lds
ds_read_b64_tr_b16 a[240:241], v50 offset:28672
ds_read_b64_tr_b16 a[242:243], v50 offset:29696
ds_read_b64_tr_b16 a[244:245], v51 offset:28672
ds_read_b64_tr_b16 a[246:247], v51 offset:29696
ds_read_b64_tr_b16 a[248:249], v52 offset:28672
ds_read_b64_tr_b16 a[250:251], v52 offset:29696
ds_read_b64_tr_b16 a[252:253], v53 offset:28672
ds_read_b64_tr_b16 a[254:255], v53 offset:29696
s_waitcnt lgkmcnt(0)
s_waitcnt vmcnt(51)
s_barrier
s_add_u32 m0, s47, 28672
s_add_u32 s2, s48, 2097152
buffer_load_dwordx4 v44, s[16:19], s2 offen offset:0 lds
s_add_u32 s2, s48, 2128896
buffer_load_dwordx4 v44, s[16:19], s2 offen offset:1024 lds
s_add_u32 s2, s48, 2160640
buffer_load_dwordx4 v45, s[16:19], s2 offen offset:2048 lds
s_add_u32 s2, s48, 2192384
buffer_load_dwordx4 v45, s[16:19], s2 offen offset:3072 lds
ds_read_b64_tr_b16 v[64:65], v50 offset:32768
ds_read_b64_tr_b16 v[66:67], v50 offset:33792
ds_read_b64_tr_b16 v[68:69], v51 offset:32768
ds_read_b64_tr_b16 v[70:71], v51 offset:33792
ds_read_b64_tr_b16 v[72:73], v52 offset:32768
ds_read_b64_tr_b16 v[74:75], v52 offset:33792
ds_read_b64_tr_b16 v[76:77], v53 offset:32768
ds_read_b64_tr_b16 v[78:79], v53 offset:33792
s_waitcnt lgkmcnt(0)
s_waitcnt vmcnt(28)
s_barrier
s_add_u32 m0, s47, 32768
s_add_u32 s2, s48, 2228224
buffer_load_dwordx4 v44, s[16:19], s2 offen offset:0 lds
s_add_u32 s2, s48, 2259968
buffer_load_dwordx4 v44, s[16:19], s2 offen offset:1024 lds
s_add_u32 s2, s48, 2291712
buffer_load_dwordx4 v45, s[16:19], s2 offen offset:2048 lds
s_add_u32 s2, s48, 2323456
buffer_load_dwordx4 v45, s[16:19], s2 offen offset:3072 lds
ds_read_b64_tr_b16 a[112:113], v58 offset:0
ds_read_b64_tr_b16 a[114:115], v58 offset:1024
ds_read_b64_tr_b16 a[116:117], v58 offset:2048
ds_read_b64_tr_b16 a[118:119], v58 offset:3072
ds_read_b64_tr_b16 a[120:121], v59 offset:0
ds_read_b64_tr_b16 a[122:123], v59 offset:1024
ds_read_b64_tr_b16 a[124:125], v59 offset:2048
ds_read_b64_tr_b16 a[126:127], v59 offset:3072
s_mul_i32 s15, s46, s46
s_lshl_b32 s15, s15, 10
s_add_u32 s15, s15, s46
s_lshl_b32 s15, s15, 8
s_add_u32 s15, s15, 1
s_cmp_lg_u32 s42, 0
s_cbranch_scc1 C_NOARR
v_mov_b32 v1, 4
v_mov_b32 v2, s15
s_mov_b64 exec, 1
global_atomic_add v1, v2, s[12:13] sc1
s_mov_b64 exec, -1
C_NOARR:
v_mov_b32 v36, 192
global_load_dword v37, v36, s[12:13] sc1
s_waitcnt lgkmcnt(0)
s_waitcnt vmcnt(29)
s_barrier
s_add_u32 m0, s47, 0
s_add_u32 s2, s48, 3145728
buffer_load_dwordx4 v44, s[16:19], s2 offen offset:0 lds
s_add_u32 s2, s48, 3177472
buffer_load_dwordx4 v44, s[16:19], s2 offen offset:1024 lds
s_add_u32 s2, s48, 3209216
buffer_load_dwordx4 v45, s[16:19], s2 offen offset:2048 lds
s_add_u32 s2, s48, 3240960
buffer_load_dwordx4 v45, s[16:19], s2 offen offset:3072 lds
ds_read_b64_tr_b16 a[128:129], v56 offset:4096
ds_read_b64_tr_b16 a[130:131], v56 offset:5120
ds_read_b64_tr_b16 a[132:133], v56 offset:6144
ds_read_b64_tr_b16 a[134:135], v56 offset:7168
ds_read_b64_tr_b16 a[136:137], v57 offset:4096
ds_read_b64_tr_b16 a[138:139], v57 offset:5120
ds_read_b64_tr_b16 a[140:141], v57 offset:6144
ds_read_b64_tr_b16 a[142:143], v57 offset:7168
s_waitcnt lgkmcnt(0)
s_waitcnt vmcnt(29)
s_barrier
s_add_u32 m0, s47, 4096
s_add_u32 s2, s48, 3276800
buffer_load_dwordx4 v44, s[16:19], s2 offen offset:0 lds
s_add_u32 s2, s48, 3308544
buffer_load_dwordx4 v44, s[16:19], s2 offen offset:1024 lds
s_add_u32 s2, s48, 3340288
buffer_load_dwordx4 v45, s[16:19], s2 offen offset:2048 lds
s_add_u32 s2, s48, 3372032
buffer_load_dwordx4 v45, s[16:19], s2 offen offset:3072 lds
ds_read_b64_tr_b16 a[144:145], v56 offset:8192
ds_read_b64_tr_b16 a[146:147], v56 offset:9216
ds_read_b64_tr_b16 a[148:149], v56 offset:10240
ds_read_b64_tr_b16 a[150:151], v56 offset:11264
ds_read_b64_tr_b16 a[152:153], v57 offset:8192
ds_read_b64_tr_b16 a[154:155], v57 offset:9216
ds_read_b64_tr_b16 a[156:157], v57 offset:10240
ds_read_b64_tr_b16 a[158:159], v57 offset:11264
s_waitcnt lgkmcnt(0)
s_waitcnt vmcnt(29)
s_barrier
s_add_u32 m0, s47, 8192
s_add_u32 s2, s49, 4194304
buffer_load_dwordx4 v44, s[16:19], s2 offen offset:0 lds
s_add_u32 s2, s49, 4226048
buffer_load_dwordx4 v44, s[16:19], s2 offen offset:1024 lds
s_add_u32 s2, s49, 4257792
buffer_load_dwordx4 v45, s[16:19], s2 offen offset:2048 lds
s_add_u32 s2, s49, 4289536
buffer_load_dwordx4 v45, s[16:19], s2 offen offset:3072 lds
ds_read_b64_tr_b16 v[80:81], v50 offset:12288
ds_read_b64_tr_b16 v[82:83], v50 offset:13312
ds_read_b64_tr_b16 v[84:85], v51 offset:12288
ds_read_b64_tr_b16 v[86:87], v51 offset:13312
ds_read_b64_tr_b16 v[88:89], v52 offset:12288
ds_read_b64_tr_b16 v[90:91], v52 offset:13312
ds_read_b64_tr_b16 v[92:93], v53 offset:12288
ds_read_b64_tr_b16 v[94:95], v53 offset:13312
s_waitcnt lgkmcnt(0)
s_waitcnt vmcnt(29)
s_barrier
s_add_u32 m0, s47, 12288
s_add_u32 s2, s48, 0
buffer_load_dwordx4 v44, s[20:23], s2 offen offset:0 lds
s_add_u32 s2, s48, 31744
buffer_load_dwordx4 v44, s[20:23], s2 offen offset:1024 lds
s_add_u32 s2, s48, 63488
buffer_load_dwordx4 v45, s[20:23], s2 offen offset:2048 lds
s_add_u32 s2, s48, 95232
buffer_load_dwordx4 v45, s[20:23], s2 offen offset:3072 lds
ds_read_b64_tr_b16 v[96:97], v50 offset:16384
ds_read_b64_tr_b16 v[98:99], v50 offset:17408
ds_read_b64_tr_b16 v[100:101], v51 offset:16384
ds_read_b64_tr_b16 v[102:103], v51 offset:17408
ds_read_b64_tr_b16 v[104:105], v52 offset:16384
ds_read_b64_tr_b16 v[106:107], v52 offset:17408
ds_read_b64_tr_b16 v[108:109], v53 offset:16384
ds_read_b64_tr_b16 v[110:111], v53 offset:17408
s_waitcnt lgkmcnt(0)
s_waitcnt vmcnt(29)
s_barrier
s_add_u32 m0, s47, 16384
s_add_u32 s2, s48, 131072
buffer_load_dwordx4 v44, s[20:23], s2 offen offset:0 lds
s_add_u32 s2, s48, 162816
buffer_load_dwordx4 v44, s[20:23], s2 offen offset:1024 lds
s_add_u32 s2, s48, 194560
buffer_load_dwordx4 v45, s[20:23], s2 offen offset:2048 lds
s_add_u32 s2, s48, 226304
buffer_load_dwordx4 v45, s[20:23], s2 offen offset:3072 lds
ds_read_b64_tr_b16 v[112:113], v50 offset:20480
ds_read_b64_tr_b16 v[114:115], v50 offset:21504
ds_read_b64_tr_b16 v[116:117], v51 offset:20480
ds_read_b64_tr_b16 v[118:119], v51 offset:21504
ds_read_b64_tr_b16 v[120:121], v52 offset:20480
ds_read_b64_tr_b16 v[122:123], v52 offset:21504
ds_read_b64_tr_b16 v[124:125], v53 offset:20480
ds_read_b64_tr_b16 v[126:127], v53 offset:21504
s_waitcnt lgkmcnt(0)
s_waitcnt vmcnt(29)
s_barrier
s_add_u32 m0, s47, 20480
s_add_u32 s2, s48, 1048576
buffer_load_dwordx4 v44, s[20:23], s2 offen offset:0 lds
s_add_u32 s2, s48, 1080320
buffer_load_dwordx4 v44, s[20:23], s2 offen offset:1024 lds
s_add_u32 s2, s48, 1112064
buffer_load_dwordx4 v45, s[20:23], s2 offen offset:2048 lds
s_add_u32 s2, s48, 1143808
buffer_load_dwordx4 v45, s[20:23], s2 offen offset:3072 lds
ds_read_b64_tr_b16 v[128:129], v50 offset:24576
ds_read_b64_tr_b16 v[130:131], v50 offset:25600
ds_read_b64_tr_b16 v[132:133], v51 offset:24576
ds_read_b64_tr_b16 v[134:135], v51 offset:25600
ds_read_b64_tr_b16 v[136:137], v52 offset:24576
ds_read_b64_tr_b16 v[138:139], v52 offset:25600
ds_read_b64_tr_b16 v[140:141], v53 offset:24576
ds_read_b64_tr_b16 v[142:143], v53 offset:25600
s_waitcnt lgkmcnt(0)
s_waitcnt vmcnt(29)
s_barrier
s_add_u32 m0, s47, 24576
s_add_u32 s2, s48, 1179648
buffer_load_dwordx4 v44, s[20:23], s2 offen offset:0 lds
s_add_u32 s2, s48, 1211392
buffer_load_dwordx4 v44, s[20:23], s2 offen offset:1024 lds
s_add_u32 s2, s48, 1243136
buffer_load_dwordx4 v45, s[20:23], s2 offen offset:2048 lds
s_add_u32 s2, s48, 1274880
buffer_load_dwordx4 v45, s[20:23], s2 offen offset:3072 lds
ds_read_b64_tr_b16 v[144:145], v50 offset:28672
ds_read_b64_tr_b16 v[146:147], v50 offset:29696
ds_read_b64_tr_b16 v[148:149], v51 offset:28672
ds_read_b64_tr_b16 v[150:151], v51 offset:29696
ds_read_b64_tr_b16 v[152:153], v52 offset:28672
ds_read_b64_tr_b16 v[154:155], v52 offset:29696
ds_read_b64_tr_b16 v[156:157], v53 offset:28672
ds_read_b64_tr_b16 v[158:159], v53 offset:29696
s_waitcnt lgkmcnt(0)
s_waitcnt vmcnt(29)
s_barrier
s_add_u32 m0, s47, 28672
s_add_u32 s2, s48, 2097152
buffer_load_dwordx4 v44, s[20:23], s2 offen offset:0 lds
s_add_u32 s2, s48, 2128896
buffer_load_dwordx4 v44, s[20:23], s2 offen offset:1024 lds
s_add_u32 s2, s48, 2160640
buffer_load_dwordx4 v45, s[20:23], s2 offen offset:2048 lds
s_add_u32 s2, s48, 2192384
buffer_load_dwordx4 v45, s[20:23], s2 offen offset:3072 lds
ds_read_b64_tr_b16 v[160:161], v50 offset:32768
ds_read_b64_tr_b16 v[162:163], v50 offset:33792
ds_read_b64_tr_b16 v[164:165], v51 offset:32768
ds_read_b64_tr_b16 v[166:167], v51 offset:33792
ds_read_b64_tr_b16 v[168:169], v52 offset:32768
ds_read_b64_tr_b16 v[170:171], v52 offset:33792
ds_read_b64_tr_b16 v[172:173], v53 offset:32768
ds_read_b64_tr_b16 v[174:175], v53 offset:33792
s_waitcnt lgkmcnt(0)
s_waitcnt vmcnt(28)
s_barrier
s_add_u32 m0, s47, 32768
s_add_u32 s2, s48, 2228224
buffer_load_dwordx4 v44, s[20:23], s2 offen offset:0 lds
s_add_u32 s2, s48, 2259968
buffer_load_dwordx4 v44, s[20:23], s2 offen offset:1024 lds
s_add_u32 s2, s48, 2291712
buffer_load_dwordx4 v45, s[20:23], s2 offen offset:2048 lds
s_add_u32 s2, s48, 2323456
buffer_load_dwordx4 v45, s[20:23], s2 offen offset:3072 lds
ds_read_b64_tr_b16 v[176:177], v50 offset:0
ds_read_b64_tr_b16 v[178:179], v50 offset:1024
ds_read_b64_tr_b16 v[180:181], v51 offset:0
ds_read_b64_tr_b16 v[182:183], v51 offset:1024
ds_read_b64_tr_b16 v[184:185], v52 offset:0
ds_read_b64_tr_b16 v[186:187], v52 offset:1024
ds_read_b64_tr_b16 v[188:189], v53 offset:0
ds_read_b64_tr_b16 v[190:191], v53 offset:1024
s_waitcnt lgkmcnt(0)
s_waitcnt vmcnt(28)
s_barrier
s_add_u32 m0, s47, 0
s_add_u32 s2, s48, 3145728
buffer_load_dwordx4 v44, s[20:23], s2 offen offset:0 lds
s_add_u32 s2, s48, 3177472
buffer_load_dwordx4 v44, s[20:23], s2 offen offset:1024 lds
s_add_u32 s2, s48, 3209216
buffer_load_dwordx4 v45, s[20:23], s2 offen offset:2048 lds
s_add_u32 s2, s48, 3240960
buffer_load_dwordx4 v45, s[20:23], s2 offen offset:3072 lds
ds_read_b64_tr_b16 v[192:193], v50 offset:4096
ds_read_b64_tr_b16 v[194:195], v50 offset:5120
ds_read_b64_tr_b16 v[196:197], v51 offset:4096
ds_read_b64_tr_b16 v[198:199], v51 offset:5120
ds_read_b64_tr_b16 v[200:201], v52 offset:4096
ds_read_b64_tr_b16 v[202:203], v52 offset:5120
ds_read_b64_tr_b16 v[204:205], v53 offset:4096
ds_read_b64_tr_b16 v[206:207], v53 offset:5120
s_waitcnt lgkmcnt(0)
s_waitcnt vmcnt(28)
s_barrier
s_add_u32 m0, s47, 4096
s_add_u32 s2, s48, 3276800
buffer_load_dwordx4 v44, s[20:23], s2 offen offset:0 lds
s_add_u32 s2, s48, 3308544
buffer_load_dwordx4 v44, s[20:23], s2 offen offset:1024 lds
s_add_u32 s2, s48, 3340288
buffer_load_dwordx4 v45, s[20:23], s2 offen offset:2048 lds
s_add_u32 s2, s48, 3372032
buffer_load_dwordx4 v45, s[20:23], s2 offen offset:3072 lds
ds_read_b64_tr_b16 v[208:209], v50 offset:8192
ds_read_b64_tr_b16 v[210:211], v50 offset:9216
ds_read_b64_tr_b16 v[212:213], v51 offset:8192
ds_read_b64_tr_b16 v[214:215], v51 offset:9216
ds_read_b64_tr_b16 v[216:217], v52 offset:8192
ds_read_b64_tr_b16 v[218:219], v52 offset:9216
ds_read_b64_tr_b16 v[220:221], v53 offset:8192
ds_read_b64_tr_b16 v[222:223], v53 offset:9216
s_waitcnt lgkmcnt(0)
s_waitcnt vmcnt(28)
s_barrier
s_add_u32 m0, s47, 8192
s_add_u32 s2, s49, 4194304
buffer_load_dwordx4 v44, s[20:23], s2 offen offset:0 lds
s_add_u32 s2, s49, 4226048
buffer_load_dwordx4 v44, s[20:23], s2 offen offset:1024 lds
s_add_u32 s2, s49, 4257792
buffer_load_dwordx4 v45, s[20:23], s2 offen offset:2048 lds
s_add_u32 s2, s49, 4289536
buffer_load_dwordx4 v45, s[20:23], s2 offen offset:3072 lds
ds_read_b64_tr_b16 v[224:225], v50 offset:12288
ds_read_b64_tr_b16 v[226:227], v50 offset:13312
ds_read_b64_tr_b16 v[228:229], v51 offset:12288
ds_read_b64_tr_b16 v[230:231], v51 offset:13312
ds_read_b64_tr_b16 v[232:233], v52 offset:12288
ds_read_b64_tr_b16 v[234:235], v52 offset:13312
ds_read_b64_tr_b16 v[236:237], v53 offset:12288
ds_read_b64_tr_b16 v[238:239], v53 offset:13312
s_waitcnt lgkmcnt(0)
s_waitcnt vmcnt(28)
s_barrier
s_add_u32 m0, s47, 12288
s_add_u32 s2, s48, 1179648
buffer_load_dwordx4 v44, s[24:27], s2 offen offset:0 lds
s_add_u32 s2, s48, 1211392
buffer_load_dwordx4 v44, s[24:27], s2 offen offset:1024 lds
s_add_u32 s2, s48, 1243136
buffer_load_dwordx4 v45, s[24:27], s2 offen offset:2048 lds
s_add_u32 s2, s48, 1274880
buffer_load_dwordx4 v45, s[24:27], s2 offen offset:3072 lds
ds_read_b64_tr_b16 v[240:241], v50 offset:16384
ds_read_b64_tr_b16 v[242:243], v50 offset:17408
ds_read_b64_tr_b16 v[244:245], v51 offset:16384
ds_read_b64_tr_b16 v[246:247], v51 offset:17408
ds_read_b64_tr_b16 v[248:249], v52 offset:16384
ds_read_b64_tr_b16 v[250:251], v52 offset:17408
ds_read_b64_tr_b16 v[252:253], v53 offset:16384
ds_read_b64_tr_b16 v[254:255], v53 offset:17408
s_waitcnt lgkmcnt(0)
s_waitcnt vmcnt(28)
s_barrier
s_add_u32 m0, s47, 16384
s_add_u32 s2, s48, 2097152
buffer_load_dwordx4 v44, s[24:27], s2 offen offset:0 lds
s_add_u32 s2, s48, 2128896
buffer_load_dwordx4 v44, s[24:27], s2 offen offset:1024 lds
s_add_u32 s2, s48, 2160640
buffer_load_dwordx4 v45, s[24:27], s2 offen offset:2048 lds
s_add_u32 s2, s48, 2192384
buffer_load_dwordx4 v45, s[24:27], s2 offen offset:3072 lds
ds_read_b64_tr_b16 a[0:1], v50 offset:20480
ds_read_b64_tr_b16 a[2:3], v50 offset:21504
ds_read_b64_tr_b16 a[4:5], v51 offset:20480
ds_read_b64_tr_b16 a[6:7], v51 offset:21504
ds_read_b64_tr_b16 a[8:9], v52 offset:20480
ds_read_b64_tr_b16 a[10:11], v52 offset:21504
ds_read_b64_tr_b16 a[12:13], v53 offset:20480
ds_read_b64_tr_b16 a[14:15], v53 offset:21504
s_waitcnt lgkmcnt(0)
s_waitcnt vmcnt(28)
s_barrier
s_add_u32 m0, s47, 20480
s_add_u32 s2, s48, 2228224
buffer_load_dwordx4 v44, s[24:27], s2 offen offset:0 lds
s_add_u32 s2, s48, 2259968
buffer_load_dwordx4 v44, s[24:27], s2 offen offset:1024 lds
s_add_u32 s2, s48, 2291712
buffer_load_dwordx4 v45, s[24:27], s2 offen offset:2048 lds
s_add_u32 s2, s48, 2323456
buffer_load_dwordx4 v45, s[24:27], s2 offen offset:3072 lds
ds_read_b64_tr_b16 a[16:17], v50 offset:24576
ds_read_b64_tr_b16 a[18:19], v50 offset:25600
ds_read_b64_tr_b16 a[20:21], v51 offset:24576
ds_read_b64_tr_b16 a[22:23], v51 offset:25600
ds_read_b64_tr_b16 a[24:25], v52 offset:24576
ds_read_b64_tr_b16 a[26:27], v52 offset:25600
ds_read_b64_tr_b16 a[28:29], v53 offset:24576
ds_read_b64_tr_b16 a[30:31], v53 offset:25600
s_waitcnt lgkmcnt(0)
s_waitcnt vmcnt(28)
s_barrier
s_add_u32 m0, s47, 24576
s_add_u32 s2, s48, 3145728
buffer_load_dwordx4 v44, s[24:27], s2 offen offset:0 lds
s_add_u32 s2, s48, 3177472
buffer_load_dwordx4 v44, s[24:27], s2 offen offset:1024 lds
s_add_u32 s2, s48, 3209216
buffer_load_dwordx4 v45, s[24:27], s2 offen offset:2048 lds
s_add_u32 s2, s48, 3240960
buffer_load_dwordx4 v45, s[24:27], s2 offen offset:3072 lds
ds_read_b64_tr_b16 a[32:33], v50 offset:28672
ds_read_b64_tr_b16 a[34:35], v50 offset:29696
ds_read_b64_tr_b16 a[36:37], v51 offset:28672
ds_read_b64_tr_b16 a[38:39], v51 offset:29696
ds_read_b64_tr_b16 a[40:41], v52 offset:28672
ds_read_b64_tr_b16 a[42:43], v52 offset:29696
ds_read_b64_tr_b16 a[44:45], v53 offset:28672
ds_read_b64_tr_b16 a[46:47], v53 offset:29696
s_waitcnt lgkmcnt(0)
s_waitcnt vmcnt(28)
s_barrier
s_add_u32 m0, s47, 28672
s_add_u32 s2, s48, 3276800
buffer_load_dwordx4 v44, s[24:27], s2 offen offset:0 lds
s_add_u32 s2, s48, 3308544
buffer_load_dwordx4 v44, s[24:27], s2 offen offset:1024 lds
s_add_u32 s2, s48, 3340288
buffer_load_dwordx4 v45, s[24:27], s2 offen offset:2048 lds
s_add_u32 s2, s48, 3372032
buffer_load_dwordx4 v45, s[24:27], s2 offen offset:3072 lds
ds_read_b64_tr_b16 a[48:49], v50 offset:32768
ds_read_b64_tr_b16 a[50:51], v50 offset:33792
ds_read_b64_tr_b16 a[52:53], v51 offset:32768
ds_read_b64_tr_b16 a[54:55], v51 offset:33792
ds_read_b64_tr_b16 a[56:57], v52 offset:32768
ds_read_b64_tr_b16 a[58:59], v52 offset:33792
ds_read_b64_tr_b16 a[60:61], v53 offset:32768
ds_read_b64_tr_b16 a[62:63], v53 offset:33792
s_waitcnt lgkmcnt(0)
s_waitcnt vmcnt(28)
s_barrier
s_add_u32 m0, s47, 32768
s_add_u32 s2, s49, 4194304
buffer_load_dwordx4 v44, s[24:27], s2 offen offset:0 lds
s_add_u32 s2, s49, 4226048
buffer_load_dwordx4 v44, s[24:27], s2 offen offset:1024 lds
s_add_u32 s2, s49, 4257792
buffer_load_dwordx4 v45, s[24:27], s2 offen offset:2048 lds
s_add_u32 s2, s49, 4289536
buffer_load_dwordx4 v45, s[24:27], s2 offen offset:3072 lds
ds_read_b64_tr_b16 a[64:65], v50 offset:0
ds_read_b64_tr_b16 a[66:67], v50 offset:1024
ds_read_b64_tr_b16 a[68:69], v51 offset:0
ds_read_b64_tr_b16 a[70:71], v51 offset:1024
ds_read_b64_tr_b16 a[72:73], v52 offset:0
ds_read_b64_tr_b16 a[74:75], v52 offset:1024
ds_read_b64_tr_b16 a[76:77], v53 offset:0
ds_read_b64_tr_b16 a[78:79], v53 offset:1024
s_waitcnt lgkmcnt(0)
s_waitcnt vmcnt(28)
s_barrier
ds_write_b128 v54, a[80:83] offset:0
ds_write_b128 v54, a[84:87] offset:1024
ds_write_b128 v54, a[88:91] offset:2048
ds_write_b128 v54, a[92:95] offset:3072
ds_read_b64_tr_b16 a[80:81], v50 offset:4096
ds_read_b64_tr_b16 a[82:83], v50 offset:5120
ds_read_b64_tr_b16 a[84:85], v51 offset:4096
ds_read_b64_tr_b16 a[86:87], v51 offset:5120
ds_read_b64_tr_b16 a[88:89], v52 offset:4096
ds_read_b64_tr_b16 a[90:91], v52 offset:5120
ds_read_b64_tr_b16 a[92:93], v53 offset:4096
ds_read_b64_tr_b16 a[94:95], v53 offset:5120
s_load_dwordx2 s[36:37], s[0:1], 136
s_cmp_lt_u32 s41, 9
s_cselect_b32 s38, 67108864, 0
s_mov_b32 s39, 0x00020000
s_min_u32 s2, s41, 8
s_lshl_b32 s48, s2, 10
s_add_u32 s68, s48, 901120
s_lshl_b32 s49, s2, 2
s_add_u32 s49, s49, 4608
v_mov_b32 v6, v54
v_lshlrev_b32 v18, 4, v0
v_add_u32 v18, 147456, v18
s_lshl_b32 s2, s42, 11
v_add_u32 v17, s2, v18
ds_write_b128 v17, v[24:27]
ds_write_b128 v17, v[28:31] offset:1024
ds_write_b128 v18, v[32:35] offset:8192
s_lshl_b32 s2, s41, 14
s_add_u32 s74, s66, s2
s_add_u32 s74, s74, 6029312
s_lshl_b32 s3, s42, 10
s_add_u32 s2, s2, s3
s_add_u32 s2, s2, 6152192
buffer_store_dwordx4 v[24:27], v18, s[8:11], s74 offen offset:0
buffer_store_dwordx4 v[28:31], v18, s[8:11], s74 offen offset:1024
buffer_store_dwordx4 v[32:35], v18, s[8:11], s2 offen offset:0
s_cmp_eq_u32 s42, 0
s_cselect_b32 s74, s2, s74
v_lshrrev_b32 v40, 2, v20
v_cmp_eq_u32 vcc, v40, v21
v_and_b32 v40, 3, v20
s_nop 0
v_cndmask_b32 v40, 7, v40, vcc
v_mov_b32 v41, 0x3f803f80
v_cmp_eq_u32 vcc, 2, v40
s_nop 1
v_cndmask_b32 v8, 0, v41, vcc
v_cmp_eq_u32 vcc, 3, v40
s_nop 1
v_cndmask_b32 v9, 0, v41, vcc
v_cmp_eq_u32 vcc, 0, v40
s_nop 1
v_cndmask_b32 v10, 0, v41, vcc
v_cmp_eq_u32 vcc, 1, v40
s_nop 1
v_cndmask_b32 v11, 0, v41, vcc
v_and_b32 v40, 1, v20
v_mul_u32_u24 v40, 0xaaaa, v40
v_add_u32 v4, 0x4444, v40
v_bfe_u32 v40, v20, 1, 1
v_mul_u32_u24 v40, 0xaaaa, v40
v_add_u32 v40, 0x4444, v40
v_lshl_or_b32 v4, v40, 16, v4
s_mov_b32 s24, 16843009
s_mov_b32 s25, 16843009
s_mov_b32 s26, 33686018
s_mov_b32 s27, 33686018
s_mov_b32 s28, 269488144
s_mov_b32 s29, 269488144
s_mov_b32 s30, 538976288
s_mov_b32 s31, 538976288
s_mov_b32 s32, 4278255360
s_mov_b32 s33, 4278255360
s_cmp_lt_u32 s41, 16
s_cselect_b32 s34, s60, 0
s_cselect_b32 s35, 0, s60
s_cselect_b32 s4, 1024, 0
s_add_u32 s4, s4, 5120
v_lshrrev_b32 v40, 2, v20
v_and_b32 v41, 1, v20
v_lshl_add_u32 v40, v40, 1, v41
v_lshl_add_u32 v40, v21, 3, v40
v_lshlrev_b32 v40, 4, v40
v_add_u32 v3, 161792, v40
v_mov_b32 v1, v22
v_mov_b32 v2, v23
s_mov_b32 s6, 122880
s_cmp_eq_u32 s42, 1
s_cselect_b32 s5, 4096, 0
s_sub_u32 s5, 4294459392, s5
v_mov_b32 v0, v18
s_cmp_eq_u32 s42, 0
s_cselect_b32 s2, s6, s66
s_add_u32 m0, s2, 32768
s_lshl_b32 s67, s41, 14
s_lshl_b32 s2, s42, 12
s_add_u32 s67, s67, s2
s_add_u32 s67, s67, 16629760
s_mov_b32 s72, 0x3e0293ee
s_mov_b32 s73, s72
s_mov_b32 s47, 0x5d800000
s_mov_b32 s43, 0
s_mov_b32 s44, 0
s_mov_b32 s59, 2
v_readfirstlane_b32 s2, v37
s_lshl_b32 s70, s41, 7
s_cmp_lg_u32 s2, 0
s_cbranch_scc1 C_INI
v_mov_b32 v36, 192
WD_1:
s_sub_u32 s45, s45, 1
s_cbranch_scc1 END
global_load_dword v37, v36, s[12:13] sc1
s_waitcnt vmcnt(0)
v_readfirstlane_b32 s2, v37
s_cmp_lt_u32 s2, 1
s_cbranch_scc1 WD_1
C_INI:
s_waitcnt lgkmcnt(0)
s_waitcnt vmcnt(27)
s_barrier
ds_write_b128 v54, a[96:99] offset:4096
ds_write_b128 v54, a[100:103] offset:5120
ds_write_b128 v54, a[104:107] offset:6144
ds_write_b128 v54, a[108:111] offset:7168
ds_read_b64_tr_b16 a[96:97], v50 offset:8192
ds_read_b64_tr_b16 a[98:99], v50 offset:9216
ds_read_b64_tr_b16 a[100:101], v51 offset:8192
ds_read_b64_tr_b16 a[102:103], v51 offset:9216
ds_read_b64_tr_b16 a[104:105], v52 offset:8192
ds_read_b64_tr_b16 a[106:107], v52 offset:9216
ds_read_b64_tr_b16 a[108:109], v53 offset:8192
ds_read_b64_tr_b16 a[110:111], v53 offset:9216
s_waitcnt lgkmcnt(0)
s_waitcnt vmcnt(23)
s_barrier
ds_write_b128 v54, a[160:163] offset:8192
ds_write_b128 v54, a[164:167] offset:9216
ds_write_b128 v54, a[168:171] offset:10240
ds_write_b128 v54, a[172:175] offset:11264
ds_read_b64_tr_b16 a[160:161], v50 offset:12288
ds_read_b64_tr_b16 a[162:163], v50 offset:13312
ds_read_b64_tr_b16 a[164:165], v51 offset:12288
ds_read_b64_tr_b16 a[166:167], v51 offset:13312
ds_read_b64_tr_b16 a[168:169], v52 offset:12288
ds_read_b64_tr_b16 a[170:171], v52 offset:13312
ds_read_b64_tr_b16 a[172:173], v53 offset:12288
ds_read_b64_tr_b16 a[174:175], v53 offset:13312
s_waitcnt lgkmcnt(0)
s_waitcnt vmcnt(19)
s_barrier
ds_write_b128 v54, a[176:179] offset:12288
ds_write_b128 v54, a[180:183] offset:13312
ds_write_b128 v54, a[184:187] offset:14336
ds_write_b128 v54, a[188:191] offset:15360
ds_read_b64_tr_b16 a[176:177], v50 offset:16384
ds_read_b64_tr_b16 a[178:179], v50 offset:17408
ds_read_b64_tr_b16 a[180:181], v51 offset:16384
ds_read_b64_tr_b16 a[182:183], v51 offset:17408
ds_read_b64_tr_b16 a[184:185], v52 offset:16384
ds_read_b64_tr_b16 a[186:187], v52 offset:17408
ds_read_b64_tr_b16 a[188:189], v53 offset:16384
ds_read_b64_tr_b16 a[190:191], v53 offset:17408
s_waitcnt lgkmcnt(0)
s_waitcnt vmcnt(15)
s_barrier
ds_write_b128 v54, a[192:195] offset:16384
ds_write_b128 v54, a[196:199] offset:17408
ds_write_b128 v54, a[200:203] offset:18432
ds_write_b128 v54, a[204:207] offset:19456
ds_read_b64_tr_b16 a[192:193], v50 offset:20480
ds_read_b64_tr_b16 a[194:195], v50 offset:21504
ds_read_b64_tr_b16 a[196:197], v51 offset:20480
ds_read_b64_tr_b16 a[198:199], v51 offset:21504
ds_read_b64_tr_b16 a[200:201], v52 offset:20480
ds_read_b64_tr_b16 a[202:203], v52 offset:21504
ds_read_b64_tr_b16 a[204:205], v53 offset:20480
ds_read_b64_tr_b16 a[206:207], v53 offset:21504
s_waitcnt lgkmcnt(0)
s_waitcnt vmcnt(11)
s_barrier
ds_write_b128 v54, a[208:211] offset:20480
ds_write_b128 v54, a[212:215] offset:21504
ds_write_b128 v54, a[216:219] offset:22528
ds_write_b128 v54, a[220:223] offset:23552
ds_read_b64_tr_b16 a[208:209], v50 offset:24576
ds_read_b64_tr_b16 a[210:211], v50 offset:25600
ds_read_b64_tr_b16 a[212:213], v51 offset:24576
ds_read_b64_tr_b16 a[214:215], v51 offset:25600
ds_read_b64_tr_b16 a[216:217], v52 offset:24576
ds_read_b64_tr_b16 a[218:219], v52 offset:25600
ds_read_b64_tr_b16 a[220:221], v53 offset:24576
ds_read_b64_tr_b16 a[222:223], v53 offset:25600
s_waitcnt lgkmcnt(0)
s_waitcnt vmcnt(7)
s_barrier
ds_write_b128 v54, a[224:227] offset:24576
ds_write_b128 v54, a[228:231] offset:25600
ds_write_b128 v54, a[232:235] offset:26624
ds_write_b128 v54, a[236:239] offset:27648
ds_read_b64_tr_b16 a[224:225], v50 offset:28672
ds_read_b64_tr_b16 a[226:227], v50 offset:29696
ds_read_b64_tr_b16 a[228:229], v51 offset:28672
ds_read_b64_tr_b16 a[230:231], v51 offset:29696
ds_read_b64_tr_b16 a[232:233], v52 offset:28672
ds_read_b64_tr_b16 a[234:235], v52 offset:29696
ds_read_b64_tr_b16 a[236:237], v53 offset:28672
ds_read_b64_tr_b16 a[238:239], v53 offset:29696
v_mov_b32 v36, 4
buffer_load_dwordx2 v[40:41], off, s[8:11], s70 sc1
global_load_dword v37, v36, s[12:13] sc1
s_waitcnt lgkmcnt(0)
s_waitcnt vmcnt(5)
s_barrier
ds_write_b128 v54, a[240:243] offset:28672
ds_write_b128 v54, a[244:247] offset:29696
ds_write_b128 v54, a[248:251] offset:30720
ds_write_b128 v54, a[252:255] offset:31744
ds_read_b64_tr_b16 a[240:241], v50 offset:32768
ds_read_b64_tr_b16 a[242:243], v50 offset:33792
ds_read_b64_tr_b16 a[244:245], v51 offset:32768
ds_read_b64_tr_b16 a[246:247], v51 offset:33792
ds_read_b64_tr_b16 a[248:249], v52 offset:32768
ds_read_b64_tr_b16 a[250:251], v52 offset:33792
ds_read_b64_tr_b16 a[252:253], v53 offset:32768
ds_read_b64_tr_b16 a[254:255], v53 offset:33792
s_waitcnt lgkmcnt(0)
s_barrier
ds_write_b128 v54, v[64:67] offset:32768
ds_write_b128 v54, v[68:71] offset:33792
ds_write_b128 v54, v[72:75] offset:34816
ds_write_b128 v54, v[76:79] offset:35840
s_branch C_W1
C_W0:
s_sub_u32 s45, s45, 1
s_cbranch_scc1 END
v_mov_b32 v36, 4
buffer_load_dwordx2 v[40:41], off, s[8:11], s70 sc1
global_load_dword v37, v36, s[12:13] sc1
C_W1:
s_waitcnt vmcnt(0)
v_min_u32 v40, v40, v41
v_readfirstlane_b32 s3, v37
v_cmp_eq_u32 vcc, 0, v40
s_and_b32 s2, s3, 0xff
s_cbranch_vccnz C_W0
s_cmp_lt_u32 s2, 32
s_cbranch_scc1 C_W0
s_waitcnt lgkmcnt(0)
s_lshl_b32 s15, s15, 5
s_cmp_lg_u32 s3, s15
s_cselect_b32 s3, 4, 0
s_add_u32 s2, s42, s3
s_cmp_eq_u32 s2, 0
s_cbranch_scc1 C_ENTRY0
s_cmp_eq_u32 s2, 1
s_cbranch_scc1 C_ENTRY1
s_cmp_eq_u32 s2, 2
s_cbranch_scc1 C_ENTRY2
s_cmp_eq_u32 s2, 3
s_cbranch_scc1 C_ENTRY3
s_cmp_eq_u32 s2, 4
s_cbranch_scc1 C_ENTRY4
s_cmp_eq_u32 s2, 5
s_cbranch_scc1 C_ENTRY5
s_cmp_eq_u32 s2, 6
s_cbranch_scc1 C_ENTRY6
s_cmp_eq_u32 s2, 7
s_cbranch_scc1 C_ENTRY7
s_branch END
C_RA0:
s_sub_u32 s45, s45, 1
s_cbranch_scc1 END
s_waitcnt vmcnt(0) lgkmcnt(0)
s_barrier
C_ENTRY0:
s_nop 7
v_mov_b32 v16, 0
v_mov_b32 v17, 0
v_mov_b32 v18, 0
v_mov_b32 v19, 0
v_mov_b32 v20, 0
v_mov_b32 v21, 0
v_mov_b32 v22, 0
v_mov_b32 v23, 0
v_mov_b32 v24, 0
v_mov_b32 v25, 0
v_mov_b32 v26, 0
v_mov_b32 v27, 0
v_mov_b32 v28, 0
v_mov_b32 v29, 0
v_mov_b32 v30, 0
v_mov_b32 v31, 0
v_mov_b32 v32, 0
v_mov_b32 v33, 0
v_mov_b32 v34, 0
v_mov_b32 v35, 0
v_mov_b32 v36, 0
v_mov_b32 v37, 0
v_mov_b32 v38, 0
v_mov_b32 v39, 0
ds_read_b128 v[64:67], v6 offset:24576
ds_read_b128 v[68:71], v6 offset:25600
ds_read_b128 v[72:75], v6 offset:26624
ds_read_b128 v[76:79], v6 offset:27648
s_waitcnt vmcnt(0)
C_A0:
s_waitcnt lgkmcnt(0)
s_barrier
ds_read_b128 v[56:59], v0 offset:0
ds_read_b128 v[60:63], v0 offset:1024
s_waitcnt lgkmcnt(1)
v_smfmac_f32_16x16x64_bf16 v[16:19], v[56:59], v[80:87], v4
v_smfmac_f32_16x16x64_bf16 v[20:23], v[56:59], v[224:231], v4
v_smfmac_f32_16x16x64_bf16 v[24:27], v[56:59], v[88:95], v4
buffer_load_dwordx4 v[40:43], v0, s[8:11], s67 offen offset:0
v_smfmac_f32_16x16x64_bf16 v[28:31], v[56:59], v[232:239], v4
buffer_load_dwordx4 v[44:47], v0, s[8:11], s67 offen offset:1024
v_smfmac_f32_16x16x64_bf16 v[32:35], v[56:59], v[64:71], v4
ds_read_b128 v[64:67], v6 offset:28672
ds_read_b128 v[68:71], v6 offset:29696
v_smfmac_f32_16x16x64_bf16 v[36:39], v[56:59], v[72:79], v4
buffer_load_dwordx4 v0, s[8:11], s74 offen offset:0 sc1 lds
ds_read_b128 v[72:75], v6 offset:30720
ds_read_b128 v[76:79], v6 offset:31744
s_waitcnt lgkmcnt(4)
v_smfmac_f32_16x16x64_bf16 v[16:19], v[60:63], v[96:103], v4
s_waitcnt vmcnt(3)
s_barrier
ds_read_b128 v[12:15], v0 offset:2048
v_smfmac_f32_16x16x64_bf16 v[20:23], v[60:63], v[240:247], v4
ds_read_b128 v[56:59], v0 offset:3072
v_smfmac_f32_16x16x64_bf16 v[24:27], v[60:63], v[104:111], v4
buffer_load_dwordx4 v[48:51], v0, s[8:11], s67 offen offset:2048
v_smfmac_f32_16x16x64_bf16 v[28:31], v[60:63], v[248:255], v4
buffer_load_dwordx4 v[52:55], v0, s[8:11], s67 offen offset:3072
s_waitcnt lgkmcnt(4)
v_smfmac_f32_16x16x64_bf16 v[32:35], v[60:63], v[64:71], v4
ds_read_b128 v[64:67], v6 offset:32768
ds_read_b128 v[68:71], v6 offset:33792
s_waitcnt lgkmcnt(4)
v_smfmac_f32_16x16x64_bf16 v[36:39], v[60:63], v[72:79], v4
ds_read_b128 v[72:75], v6 offset:34816
ds_read_b128 v[76:79], v6 offset:35840
s_waitcnt lgkmcnt(5)
v_smfmac_f32_16x16x64_bf16 v[16:19], v[12:15], v[112:119], v4
s_waitcnt lgkmcnt(4)
v_bitop3_b32 v7, v12, v56, s44 bitop3:0x7e
v_smfmac_f32_16x16x64_bf16 v[20:23], v[12:15], a[0:7], v4
v_and_b32 v7, 1, v7
s_waitcnt lgkmcnt(2)
v_smfmac_f32_16x16x64_bf16 v[32:35], v[12:15], v[64:71], v4
s_barrier
ds_read_b128 v[60:63], v0 offset:4096
ds_read_b128 v[64:67], v0 offset:5120
v_cmp_eq_u32 vcc, s59, v7
s_waitcnt lgkmcnt(2)
v_smfmac_f32_16x16x64_bf16 v[36:39], v[12:15], v[72:79], v4
v_smfmac_f32_16x16x64_bf16 v[24:27], v[12:15], v[120:127], v4
s_cbranch_vccnz C_RA0
v_smfmac_f32_16x16x64_bf16 v[28:31], v[12:15], a[8:15], v4
v_smfmac_f32_16x16x64_bf16 v[16:19], v[56:59], v[128:135], v4
s_waitcnt lgkmcnt(0)
v_bitop3_b32 v7, v60, v64, s44 bitop3:0x7e
v_smfmac_f32_16x16x64_bf16 v[20:23], v[56:59], a[16:23], v4
v_and_b32 v7, 1, v7
v_smfmac_f32_16x16x64_bf16 v[24:27], v[56:59], v[136:143], v4
v_cmp_eq_u32 vcc, s59, v7
v_smfmac_f32_16x16x64_bf16 v[28:31], v[56:59], a[24:31], v4
s_cbranch_vccnz C_OF00
C_OK00:
s_waitcnt vmcnt(2)
s_barrier
ds_read_b128 v[68:71], v0 offset:6144
v_smfmac_f32_16x16x64_bf16 v[16:19], v[60:63], v[144:151], v4
ds_read_b128 v[72:75], v0 offset:7168
ds_read_b128 v[76:79], v0 offset:8192
v_smfmac_f32_16x16x64_bf16 v[20:23], v[60:63], a[32:39], v4
v_smfmac_f32_16x16x64_bf16 v[24:27], v[60:63], v[152:159], v4
v_smfmac_f32_16x16x64_bf16 v[28:31], v[60:63], a[40:47], v4
s_waitcnt lgkmcnt(1)
v_bitop3_b32 v13, v68, v72, s44 bitop3:0x7e
v_smfmac_f32_16x16x64_bf16 v[16:19], v[64:67], v[160:167], v4
s_waitcnt lgkmcnt(0)
v_bitop3_b32 v13, v76, v13, s44 bitop3:0xde
v_smfmac_f32_16x16x64_bf16 v[20:23], v[64:67], a[48:55], v4
v_and_b32 v13, 1, v13
v_smfmac_f32_16x16x64_bf16 v[24:27], v[64:67], v[168:175], v4
v_cmp_eq_u32 vcc, s59, v13
v_smfmac_f32_16x16x64_bf16 v[28:31], v[64:67], a[56:63], v4
s_cbranch_vccnz C_OF10
C_OK10:
v_smfmac_f32_16x16x64_bf16 v[16:19], v[68:71], v[176:183], v4
v_smfmac_f32_16x16x64_bf16 v[20:23], v[68:71], a[64:71], v4
s_add_u32 s67, s67, 524288
s_mov_b32 s74, s6
v_smfmac_f32_16x16x64_bf16 v[16:19], v[72:75], v[192:199], v4
v_smfmac_f32_16x16x64_bf16 v[20:23], v[72:75], a[80:87], v4
v_smfmac_f32_16x16x64_bf16 v[16:19], v[76:79], v[208:215], v4
v_smfmac_f32_16x16x64_bf16 v[20:23], v[76:79], a[96:103], v4
s_xor_b32 s44, s44, -1
s_mov_b32 s59, 1
v_smfmac_f32_16x16x64_bf16 v[24:27], v[68:71], v[184:191], v4
v_cvt_pk_bf16_f32 v16, v16, v17
v_smfmac_f32_16x16x64_bf16 v[24:27], v[72:75], v[200:207], v4
v_cvt_pk_bf16_f32 v17, v18, v19
v_smfmac_f32_16x16x64_bf16 v[24:27], v[76:79], v[216:223], v4
v_cvt_pk_bf16_f32 v18, v20, v21
v_smfmac_f32_16x16x64_bf16 v[28:31], v[68:71], a[72:79], v4
v_cvt_pk_bf16_f32 v19, v22, v23
v_smfmac_f32_16x16x64_bf16 v[28:31], v[72:75], a[88:95], v4
v_cvt_pk_bf16_f32 v24, v24, v25
v_smfmac_f32_16x16x64_bf16 v[28:31], v[76:79], a[104:111], v4
v_cvt_pk_bf16_f32 v25, v26, v27
v_mfma_f32_16x16x32_bf16 v[20:23], v[16:19], v[8:11], 0
s_nop 3
v_cvt_pk_bf16_f32 v26, v28, v29
v_cvt_pk_bf16_f32 v27, v30, v31
s_nop 1
v_mfma_f32_16x16x32_bf16 v[28:31], v[24:27], v[8:11], 0
v_cvt_pk_bf16_f32 v16, v20, v21
v_cvt_pk_bf16_f32 v17, v22, v23
v_smfmac_f32_16x16x64_bf16 v[32:35], v[72:75], a[224:231], v4
s_mov_b64 vcc, s[62:63]
s_nop 2
v_cvt_pk_bf16_f32 v18, v28, v29
v_cvt_pk_bf16_f32 v19, v30, v31
s_nop 1
v_mfma_f32_16x16x32_bf16 v[24:27], v[44:47], v[16:19], 0
v_mfma_f32_16x16x32_bf16 v[20:23], v[40:43], v[16:19], 0
v_mfma_f32_16x16x32_bf16 v[28:31], v[16:19], v[16:19], 0
s_nop 3
v_cndmask_b32_dpp v20, v24, v20, vcc quad_perm:[2,3,2,3] row_mask:0xf bank_mask:0xf
v_cndmask_b32_dpp v21, v25, v21, vcc quad_perm:[2,3,2,3] row_mask:0xf bank_mask:0xf
v_cndmask_b32_dpp v22, v26, v22, vcc quad_perm:[2,3,2,3] row_mask:0xf bank_mask:0xf
v_cndmask_b32_dpp v23, v27, v23, vcc quad_perm:[2,3,2,3] row_mask:0xf bank_mask:0xf
v_smfmac_f32_16x16x64_bf16 v[36:39], v[72:75], a[232:239], v4
ds_write_b128 v0, v[20:23] offset:9216
v_cndmask_b32_dpp v28, v29, v28, vcc quad_perm:[2,3,2,3] row_mask:0xf bank_mask:0xf
v_smfmac_f32_16x16x64_bf16 v[32:35], v[76:79], a[240:247], v4
ds_write_b32 v0, v28 offset:13312
v_mul_f32 v24, s72, v20
v_smfmac_f32_16x16x64_bf16 v[36:39], v[76:79], a[248:255], v4
v_mul_f32 v25, s72, v21
v_smfmac_f32_16x16x64_bf16 v[32:35], v[64:67], a[192:199], v4
v_mul_f32 v26, s72, v22
v_smfmac_f32_16x16x64_bf16 v[36:39], v[64:67], a[200:207], v4
v_mul_f32 v27, s72, v23
v_smfmac_f32_16x16x64_bf16 v[32:35], v[68:71], a[208:215], v4
v_mov_b32 v12, 0x3f803f80
v_smfmac_f32_16x16x64_bf16 v[36:39], v[68:71], a[216:223], v4
s_waitcnt lgkmcnt(0)
s_barrier
ds_read_b128 v[28:31], v0 offset:13312
ds_read_b128 v[16:19], v0 offset:10240
v_smfmac_f32_16x16x64_bf16 v[32:35], v[56:59], a[160:167], v4
ds_read_b128 v[40:43], v0 offset:11264
ds_read_b128 v[44:47], v0 offset:12288
v_mov_b32 v13, 0x3f803f80
v_smfmac_f32_16x16x64_bf16 v[36:39], v[56:59], a[168:175], v4
ds_read_b128 v[72:75], v6 offset:0
ds_read_b128 v[76:79], v6 offset:1024
v_mov_b32 v14, 0x3f803f80
v_smfmac_f32_16x16x64_bf16 v[32:35], v[60:63], a[176:183], v4
ds_read_b128 v[64:67], v6 offset:4096
ds_read_b128 v[68:71], v6 offset:5120
v_mov_b32 v15, 0x3f803f80
v_smfmac_f32_16x16x64_bf16 v[36:39], v[60:63], a[184:191], v4
v_mov_b32 v20, 0x3f003f00
v_mov_b32 v21, 0x3f003f00
s_waitcnt lgkmcnt(7)
v_pk_add_f32 v[28:29], v[28:29], v[30:31]
v_add_f32 v28, v28, v29
v_mul_f32 v28, s72, v28
s_waitcnt lgkmcnt(6)
v_pk_fma_f32 v[24:25], v[16:17], s[72:73], v[24:25]
v_exp_f32 v29, v28
v_pk_fma_f32 v[26:27], v[18:19], s[72:73], v[26:27]
s_waitcnt lgkmcnt(5)
v_pk_fma_f32 v[24:25], v[40:41], s[72:73], v[24:25]
v_cvt_pk_bf16_f32 v30, v29, v29
v_pk_fma_f32 v[26:27], v[42:43], s[72:73], v[26:27]
s_waitcnt lgkmcnt(4)
v_pk_fma_f32 v[24:25], v[44:45], s[72:73], v[24:25]
v_mov_b32_dpp v31, v30 quad_perm:[2,3,0,1] row_mask:0xf bank_mask:0xf
v_pk_fma_f32 v[26:27], v[46:47], s[72:73], v[26:27]
v_cvt_pk_bf16_f32 v32, v32, v33
v_cvt_pk_bf16_f32 v33, v34, v35
v_cvt_pk_bf16_f32 v34, v36, v37
v_cvt_pk_bf16_f32 v35, v38, v39
v_exp_f32 v24, v24
v_mfma_f32_16x16x16_bf16 v[40:43], v[32:33], v[30:31], 0
ds_read_b128 v[56:59], v6 offset:12288
ds_read_b128 v[60:63], v6 offset:13312
v_exp_f32 v25, v25
v_mfma_f32_16x16x16_bf16 v[44:47], v[34:35], v[30:31], 0
s_waitcnt vmcnt(0)
v_exp_f32 v26, v26
v_mfma_f32_16x16x16_bf16 v[36:39], v[20:21], v[30:31], 0
v_exp_f32 v27, v27
v_cvt_pk_bf16_f32 v16, v24, v25
v_cvt_pk_bf16_f32 v17, v26, v27
v_mov_b64 v[22:23], 0
v_mov_b32_dpp v18, v16 quad_perm:[2,3,0,1] row_mask:0xf bank_mask:0xf
v_mov_b32_dpp v19, v17 quad_perm:[2,3,0,1] row_mask:0xf bank_mask:0xf
v_mov_b64 v[24:25], 0
v_mov_b64 v[26:27], 0
v_mfma_f32_16x16x32_bf16 v[36:39], v[12:15], v[16:19], v[36:39]
v_mov_b32 v20, 0
v_mov_b32 v21, 0
v_mfma_f32_16x16x32_bf16 v[40:43], v[48:51], v[16:19], v[40:43]
v_mov_b32 v28, 0
v_mov_b32 v29, 0
v_mfma_f32_16x16x32_bf16 v[44:47], v[52:55], v[16:19], v[44:47]
v_rcp_f32 v38, v36
s_nop 2
v_pk_mul_f32 v[40:41], v[40:41], v[38:39] op_sel_hi:[1,0]
v_pk_mul_f32 v[42:43], v[42:43], v[38:39] op_sel_hi:[1,0]
v_cvt_pk_bf16_f32 v40, v40, v41
v_cvt_pk_bf16_f32 v41, v42, v43
v_pk_mul_f32 v[44:45], v[44:45], v[38:39] op_sel_hi:[1,0]
v_pk_mul_f32 v[46:47], v[46:47], v[38:39] op_sel_hi:[1,0]
s_mov_b64 exec, s[62:63]
v_cvt_pk_bf16_f32 v42, v44, v45
v_cvt_pk_bf16_f32 v43, v46, v47
ds_write_b128 v3, v[40:43] offset:0
s_mov_b64 exec, -1
v_max_f32 v36, v36, v38
v_cmp_nge_f32 vcc, s47, v36
v_mov_b32_dpp v40, v40 quad_perm:[2,3,2,3] row_mask:0xf bank_mask:0xf
v_mov_b32_dpp v41, v41 quad_perm:[2,3,2,3] row_mask:0xf bank_mask:0xf
v_mov_b32_dpp v42, v42 quad_perm:[2,3,2,3] row_mask:0xf bank_mask:0xf
v_mov_b32_dpp v43, v43 quad_perm:[2,3,2,3] row_mask:0xf bank_mask:0xf
s_cbranch_vccnz C_FB0
C_FBOK0:
v_mov_b64 v[30:31], 0
s_waitcnt lgkmcnt(5)
v_smfmac_f32_16x16x64_bf16 v[20:23], v[40:43], v[72:79], v4 abid:1
ds_read_b128 v[48:51], v6 offset:16384
ds_read_b128 v[52:55], v6 offset:17408
v_mov_b64 v[16:17], 0
s_waitcnt lgkmcnt(5)
v_smfmac_f32_16x16x64_bf16 v[24:27], v[40:43], v[64:71], v4 abid:1
ds_read_b128 v[72:75], v6 offset:2048
ds_read_b128 v[76:79], v6 offset:3072
v_mov_b64 v[18:19], 0
s_waitcnt lgkmcnt(4)
s_barrier
ds_read_b128 v[44:47], v3 offset:512
ds_read_b128 v[36:39], v3 offset:1024
ds_read_b128 v[12:15], v3 offset:1536
v_smfmac_f32_16x16x64_bf16 v[28:31], v[40:43], v[56:63], v4 abid:1
ds_read_b128 v[64:67], v6 offset:6144
ds_read_b128 v[68:71], v6 offset:7168
v_mov_b64 v[32:33], 0
v_smfmac_f32_16x16x64_bf16 v[16:19], v[40:43], a[112:119], v4 abid:1
ds_read_b128 v[56:59], v6 offset:8192
ds_read_b128 v[60:63], v6 offset:9216
v_mov_b64 v[34:35], 0
s_waitcnt lgkmcnt(9)
s_nop 0
v_smfmac_f32_16x16x64_bf16 v[32:35], v[40:43], v[48:55], v4 abid:1
ds_read_b128 v[48:51], v6 offset:10240
ds_read_b128 v[52:55], v6 offset:11264
s_waitcnt lgkmcnt(8)
v_smfmac_f32_16x16x64_bf16 v[20:23], v[44:47], v[72:79], v4 abid:1
ds_read_b128 v[72:75], v6 offset:14336
ds_read_b128 v[76:79], v6 offset:15360
s_waitcnt lgkmcnt(9)
v_smfmac_f32_16x16x64_bf16 v[20:23], v[36:39], a[128:135], v4 abid:1
s_waitcnt lgkmcnt(8)
v_smfmac_f32_16x16x64_bf16 v[20:23], v[12:15], a[136:143], v4 abid:1
s_waitcnt lgkmcnt(6)
v_smfmac_f32_16x16x64_bf16 v[24:27], v[44:47], v[64:71], v4 abid:1
ds_read_b128 v[64:67], v6 offset:18432
ds_read_b128 v[68:71], v6 offset:19456
s_waitcnt lgkmcnt(6)
v_smfmac_f32_16x16x64_bf16 v[24:27], v[36:39], v[56:63], v4 abid:1
ds_read_b128 v[56:59], v6 offset:20480
ds_read_b128 v[60:63], v6 offset:21504
v_cvt_pk_bf16_f32 v20, v20, v21
v_bfi_b32 v20, 1, s44, v20
v_cvt_pk_bf16_f32 v22, v22, v23
v_bfi_b32 v22, 1, s44, v22
s_waitcnt lgkmcnt(6)
v_smfmac_f32_16x16x64_bf16 v[24:27], v[12:15], v[48:55], v4 abid:1
buffer_store_dword v20, v1, s[8:11], s50 offen
buffer_store_dword v22, v1, s[8:11], s51 offen
ds_read_b128 v[48:51], v6 offset:22528
ds_read_b128 v[52:55], v6 offset:23552
s_waitcnt lgkmcnt(6)
v_smfmac_f32_16x16x64_bf16 v[28:31], v[44:47], v[72:79], v4 abid:1
v_mov_b32 v21, 0xeeee
v_smfmac_f32_16x16x64_bf16 v[28:31], v[36:39], a[144:151], v4 abid:1
v_cvt_pk_bf16_f32 v24, v24, v25
v_bfi_b32 v24, 1, s44, v24
v_smfmac_f32_16x16x64_bf16 v[28:31], v[12:15], a[152:159], v4 abid:1
buffer_store_dword v24, v1, s[8:11], s52 offen
v_cvt_pk_bf16_f32 v26, v26, v27
v_bfi_b32 v26, 1, s44, v26
s_waitcnt lgkmcnt(4)
v_smfmac_f32_16x16x64_bf16 v[32:35], v[44:47], v[64:71], v4 abid:1
buffer_store_dword v26, v1, s[8:11], s53 offen
s_waitcnt lgkmcnt(2)
v_smfmac_f32_16x16x64_bf16 v[32:35], v[36:39], v[56:63], v4 abid:1
v_cvt_pk_bf16_f32 v28, v28, v29
v_bfi_b32 v28, 1, s44, v28
s_waitcnt lgkmcnt(0)
v_smfmac_f32_16x16x64_bf16 v[32:35], v[12:15], v[48:55], v4 abid:1
buffer_store_dword v28, v1, s[8:11], s54 offen
v_cvt_pk_bf16_f32 v30, v30, v31
v_bfi_b32 v30, 1, s44, v30
v_smfmac_f32_16x16x64_bf16 v[16:19], v[44:47], a[112:119], v21
buffer_store_dword v30, v1, s[8:11], s55 offen
buffer_load_dwordx4 v[72:75], v0, s[8:11], s64 offen offset:0 sc1
buffer_load_dwordx4 v[76:79], v0, s[8:11], s64 offen offset:1024 sc1
v_smfmac_f32_16x16x64_bf16 v[16:19], v[36:39], a[120:127], v4 abid:1
v_cvt_pk_bf16_f32 v32, v32, v33
v_bfi_b32 v32, 1, s44, v32
v_smfmac_f32_16x16x64_bf16 v[16:19], v[12:15], a[120:127], v21
buffer_store_dword v32, v1, s[8:11], s56 offen
v_cvt_pk_bf16_f32 v34, v34, v35
v_bfi_b32 v34, 1, s44, v34
buffer_store_dword v34, v1, s[8:11], s57 offen
s_nop 3
v_cvt_pk_bf16_f32 v16, v16, v17
v_bfi_b32 v16, 1, s44, v16
buffer_store_dword v16, v1, s[8:11], s58 offen
v_mov_b32 v60, 0x3f80
v_cndmask_b32 v60, v60, 1.0, s[32:33]
v_cndmask_b32 v56, 0, v60, s[24:25]
v_cndmask_b32 v57, 0, v60, s[26:27]
v_cndmask_b32 v58, 0, v60, s[28:29]
v_cndmask_b32 v59, 0, v60, s[30:31]
buffer_load_dwordx4 v[64:67], v0, s[8:11], s64 offen offset:0 sc1
buffer_load_dwordx4 v[68:71], v0, s[8:11], s64 offen offset:1024 sc1
s_waitcnt vmcnt(8)
buffer_load_dwordx4 v[48:51], v0, s[8:11], s64 offen offset:0 sc1
buffer_load_dwordx4 v[52:55], v0, s[8:11], s64 offen offset:1024 sc1
s_waitcnt vmcnt(8)
v_mfma_f32_16x16x32_bf16 v[60:63], v[56:59], v[72:75], 0
s_waitcnt vmcnt(7)
v_mfma_f32_16x16x32_bf16 v[60:63], v[56:59], v[76:79], v[60:63]
v_bitop3_b32 v12, v72, v73, s44 bitop3:0x7e
v_bitop3_b32 v13, v74, v75, s44 bitop3:0x7e
v_bitop3_b32 v14, v76, v77, s44 bitop3:0x7e
v_bitop3_b32 v15, v78, v79, s44 bitop3:0x7e
v_or3_b32 v12, v12, v13, v14
v_bitop3_b32 v12, v12, v15, 1 bitop3:0xa8
v_cmp_ne_u32 vcc, 0, v12
s_nop 0
v_add_f32_dpp v60, v60, v60 row_ror:4 row_mask:0xf bank_mask:0xf
v_add_f32_dpp v61, v61, v61 row_ror:4 row_mask:0xf bank_mask:0xf
s_cbranch_vccnz C_RR00
C_RT00:
v_add_f32_dpp v60, v60, v60 row_ror:8 row_mask:0xf bank_mask:0xf
v_add_f32_dpp v61, v61, v61 row_ror:8 row_mask:0xf bank_mask:0xf
s_mov_b64 exec, s[60:61]
v_cvt_pk_bf16_f32 v60, v60, v61
v_bfi_b32 v60, 1, s44, v60
buffer_store_dword v60, v2, s[8:11], 0 offen
s_mov_b64 exec, -1
s_add_u32 s43, s43, 1
s_cmp_eq_u32 s43, 63
s_cbranch_scc1 C_X0
v_mov_b32 v20, 0
v_mov_b32 v21, 0
v_mov_b32 v22, 0
v_mov_b32 v23, 0
v_mov_b32 v24, 0
v_mov_b32 v25, 0
v_mov_b32 v26, 0
v_mov_b32 v27, 0
v_mov_b32 v28, 0
v_mov_b32 v29, 0
v_mov_b32 v30, 0
v_mov_b32 v31, 0
v_mov_b32 v32, 0
v_mov_b32 v33, 0
v_mov_b32 v34, 0
v_mov_b32 v35, 0
v_mov_b32 v36, 0
v_mov_b32 v37, 0
v_mov_b32 v38, 0
v_mov_b32 v39, 0
buffer_load_dwordx4 v[56:59], v0, s[8:11], s66 offen offset:0 sc1
buffer_load_dwordx4 v[60:63], v0, s[8:11], s66 offen offset:1024 sc1
v_mov_b32 v17, 0
v_mov_b32 v18, 0
v_mov_b32 v19, 0
v_mov_b32 v16, 0
buffer_load_dwordx4 v[40:43], v0, s[8:11], s66 offen offset:0 sc1
buffer_load_dwordx4 v[44:47], v0, s[8:11], s66 offen offset:1024 sc1
s_waitcnt vmcnt(5)
ds_read_b128 v[64:67], v6 offset:24576
ds_read_b128 v[68:71], v6 offset:25600
ds_read_b128 v[72:75], v6 offset:26624
ds_read_b128 v[76:79], v6 offset:27648
s_waitcnt vmcnt(4)
buffer_load_dwordx4 v[48:51], v0, s[8:11], s66 offen offset:0 sc1
buffer_load_dwordx4 v[52:55], v0, s[8:11], s66 offen offset:1024 sc1
C_G00:
s_waitcnt vmcnt(4)
v_bitop3_b32 v12, v56, v60, s44 bitop3:0x7e
v_and_b32 v12, 1, v12
v_cmp_eq_u32 vcc, s59, v12
ds_write_b128 v0, v[56:59]
s_cbranch_vccnz C_H00
s_barrier
ds_write_b128 v0, v[60:63] offset:1024
s_branch C_A0
C_H00:
buffer_load_dwordx4 v[56:59], v0, s[8:11], s66 offen offset:0 sc1
buffer_load_dwordx4 v[60:63], v0, s[8:11], s66 offen offset:1024 sc1
C_G10:
s_waitcnt vmcnt(4)
v_bitop3_b32 v12, v40, v44, s44 bitop3:0x7e
v_and_b32 v12, 1, v12
v_cmp_eq_u32 vcc, s59, v12
ds_write_b128 v0, v[40:43]
s_cbranch_vccnz C_H10
s_barrier
ds_write_b128 v0, v[44:47] offset:1024
s_branch C_A0
C_H10:
buffer_load_dwordx4 v[40:43], v0, s[8:11], s66 offen offset:0 sc1
buffer_load_dwordx4 v[44:47], v0, s[8:11], s66 offen offset:1024 sc1
C_G20:
s_waitcnt vmcnt(4)
v_bitop3_b32 v12, v48, v52, s44 bitop3:0x7e
v_and_b32 v12, 1, v12
v_cmp_eq_u32 vcc, s59, v12
ds_write_b128 v0, v[48:51]
s_cbranch_vccnz C_H20
s_barrier
ds_write_b128 v0, v[52:55] offset:1024
s_branch C_A0
C_H20:
buffer_load_dwordx4 v[48:51], v0, s[8:11], s66 offen offset:0 sc1
buffer_load_dwordx4 v[52:55], v0, s[8:11], s66 offen offset:1024 sc1
s_sub_u32 s45, s45, 1
s_cbranch_scc1 END
s_branch C_G00
C_X0:
s_waitcnt vmcnt(0) lgkmcnt(0)
s_branch END
C_RR00:
buffer_load_dwordx4 v[72:75], v0, s[8:11], s64 offen offset:0 sc1
buffer_load_dwordx4 v[76:79], v0, s[8:11], s64 offen offset:1024 sc1
s_waitcnt vmcnt(5)
v_mfma_f32_16x16x32_bf16 v[60:63], v[56:59], v[64:67], 0
s_waitcnt vmcnt(4)
v_mfma_f32_16x16x32_bf16 v[60:63], v[56:59], v[68:71], v[60:63]
v_bitop3_b32 v12, v64, v65, s44 bitop3:0x7e
v_bitop3_b32 v13, v66, v67, s44 bitop3:0x7e
v_bitop3_b32 v14, v68, v69, s44 bitop3:0x7e
v_bitop3_b32 v15, v70, v71, s44 bitop3:0x7e
v_or3_b32 v12, v12, v13, v14
v_bitop3_b32 v12, v12, v15, 1 bitop3:0xa8
v_cmp_ne_u32 vcc, 0, v12
s_nop 0
v_add_f32_dpp v60, v60, v60 row_ror:4 row_mask:0xf bank_mask:0xf
v_add_f32_dpp v61, v61, v61 row_ror:4 row_mask:0xf bank_mask:0xf
s_cbranch_vccz C_RT00
buffer_load_dwordx4 v[64:67], v0, s[8:11], s64 offen offset:0 sc1
buffer_load_dwordx4 v[68:71], v0, s[8:11], s64 offen offset:1024 sc1
s_waitcnt vmcnt(5)
v_mfma_f32_16x16x32_bf16 v[60:63], v[56:59], v[48:51], 0
s_waitcnt vmcnt(4)
v_mfma_f32_16x16x32_bf16 v[60:63], v[56:59], v[52:55], v[60:63]
v_bitop3_b32 v12, v48, v49, s44 bitop3:0x7e
v_bitop3_b32 v13, v50, v51, s44 bitop3:0x7e
v_bitop3_b32 v14, v52, v53, s44 bitop3:0x7e
v_bitop3_b32 v15, v54, v55, s44 bitop3:0x7e
v_or3_b32 v12, v12, v13, v14
v_bitop3_b32 v12, v12, v15, 1 bitop3:0xa8
v_cmp_ne_u32 vcc, 0, v12
s_nop 0
v_add_f32_dpp v60, v60, v60 row_ror:4 row_mask:0xf bank_mask:0xf
v_add_f32_dpp v61, v61, v61 row_ror:4 row_mask:0xf bank_mask:0xf
s_cbranch_vccz C_RT00
buffer_load_dwordx4 v[48:51], v0, s[8:11], s64 offen offset:0 sc1
buffer_load_dwordx4 v[52:55], v0, s[8:11], s64 offen offset:1024 sc1
s_sub_u32 s45, s45, 1
s_cbranch_scc1 END
s_waitcnt vmcnt(5)
v_mfma_f32_16x16x32_bf16 v[60:63], v[56:59], v[72:75], 0
s_waitcnt vmcnt(4)
v_mfma_f32_16x16x32_bf16 v[60:63], v[56:59], v[76:79], v[60:63]
v_bitop3_b32 v12, v72, v73, s44 bitop3:0x7e
v_bitop3_b32 v13, v74, v75, s44 bitop3:0x7e
v_bitop3_b32 v14, v76, v77, s44 bitop3:0x7e
v_bitop3_b32 v15, v78, v79, s44 bitop3:0x7e
v_or3_b32 v12, v12, v13, v14
v_bitop3_b32 v12, v12, v15, 1 bitop3:0xa8
v_cmp_ne_u32 vcc, 0, v12
s_nop 0
v_add_f32_dpp v60, v60, v60 row_ror:4 row_mask:0xf bank_mask:0xf
v_add_f32_dpp v61, v61, v61 row_ror:4 row_mask:0xf bank_mask:0xf
s_cbranch_vccz C_RT00
s_branch C_RR00
C_OF00:
s_sub_u32 s45, s45, 1
s_cbranch_scc1 END
s_waitcnt lgkmcnt(0)
s_barrier
s_barrier
ds_read_b128 v[60:63], v0 offset:4096
ds_read_b128 v[64:67], v0 offset:5120
s_waitcnt lgkmcnt(0)
v_bitop3_b32 v7, v60, v64, s44 bitop3:0x7e
v_and_b32 v7, 1, v7
v_cmp_eq_u32 vcc, s59, v7
s_cbranch_vccnz C_OF00
s_branch C_OK00
C_OF10:
s_sub_u32 s45, s45, 1
s_cbranch_scc1 END
s_waitcnt lgkmcnt(0)
s_barrier
buffer_load_dwordx4 v0, s[8:11], s74 offen offset:0 sc1 lds
s_waitcnt vmcnt(0)
s_barrier
ds_read_b128 v[68:71], v0 offset:6144
ds_read_b128 v[72:75], v0 offset:7168
ds_read_b128 v[76:79], v0 offset:8192
s_waitcnt lgkmcnt(0)
v_bitop3_b32 v13, v68, v72, s44 bitop3:0x7e
v_bitop3_b32 v13, v76, v13, s44 bitop3:0xde
v_and_b32 v13, 1, v13
v_cmp_eq_u32 vcc, s59, v13
s_cbranch_vccnz C_OF10
s_branch C_OK10
s_nop 2
C_FB0:
ds_read_b128 v[28:31], v0 offset:13312
ds_read_b128 v[24:27], v0 offset:9216
ds_read_b128 v[16:19], v0 offset:10240
ds_read_b128 v[40:43], v0 offset:11264
ds_read_b128 v[44:47], v0 offset:12288
v_mov_b32 v20, 0x3f003f00
v_mov_b32 v21, 0x3f003f00
s_waitcnt lgkmcnt(0)
v_pk_add_f32 v[28:29], v[28:29], v[30:31]
v_add_f32 v28, v28, v29
v_mul_f32 v28, s72, v28
v_mul_f32 v24, s72, v24
v_mul_f32 v25, s72, v25
v_mul_f32 v26, s72, v26
v_mul_f32 v27, s72, v27
v_pk_fma_f32 v[24:25], v[16:17], s[72:73], v[24:25]
v_pk_fma_f32 v[26:27], v[18:19], s[72:73], v[26:27]
v_pk_fma_f32 v[24:25], v[40:41], s[72:73], v[24:25]
v_pk_fma_f32 v[26:27], v[42:43], s[72:73], v[26:27]
v_pk_fma_f32 v[24:25], v[44:45], s[72:73], v[24:25]
v_pk_fma_f32 v[26:27], v[46:47], s[72:73], v[26:27]
v_max3_f32 v36, v24, v25, v26
v_max3_f32 v36, v36, v27, v28
s_nop 1
v_max_f32_dpp v36, v36, v36 quad_perm:[2,3,0,1] row_mask:0xf bank_mask:0xf
v_mov_b32 v37, v36
s_nop 1
v_permlane16_swap_b32 v36, v37
v_max_f32 v36, v36, v37
v_mov_b32 v37, v36
s_nop 1
v_permlane32_swap_b32 v36, v37
v_max_f32 v36, v36, v37
v_sub_f32 v24, v24, v36
v_sub_f32 v25, v25, v36
v_sub_f32 v26, v26, v36
v_sub_f32 v27, v27, v36
v_sub_f32 v28, v28, v36
v_exp_f32 v29, v28
s_nop 0
v_cvt_pk_bf16_f32 v30, v29, v29
s_nop 1
v_mov_b32_dpp v31, v30 quad_perm:[2,3,0,1] row_mask:0xf bank_mask:0xf
v_exp_f32 v24, v24
s_nop 0
v_mfma_f32_16x16x16_bf16 v[40:43], v[32:33], v[30:31], 0
v_exp_f32 v25, v25
v_mfma_f32_16x16x16_bf16 v[44:47], v[34:35], v[30:31], 0
v_exp_f32 v26, v26
v_mfma_f32_16x16x16_bf16 v[36:39], v[20:21], v[30:31], 0
v_exp_f32 v27, v27
v_cvt_pk_bf16_f32 v16, v24, v25
v_cvt_pk_bf16_f32 v17, v26, v27
v_mov_b64 v[22:23], 0
v_mov_b32_dpp v18, v16 quad_perm:[2,3,0,1] row_mask:0xf bank_mask:0xf
v_mov_b32_dpp v19, v17 quad_perm:[2,3,0,1] row_mask:0xf bank_mask:0xf
v_mov_b64 v[24:25], 0
v_mov_b64 v[26:27], 0
v_mfma_f32_16x16x32_bf16 v[36:39], v[12:15], v[16:19], v[36:39]
v_mov_b32 v20, 0
v_mov_b32 v21, 0
v_mfma_f32_16x16x32_bf16 v[40:43], v[48:51], v[16:19], v[40:43]
v_mov_b32 v28, 0
v_mov_b32 v29, 0
v_mfma_f32_16x16x32_bf16 v[44:47], v[52:55], v[16:19], v[44:47]
v_rcp_f32 v38, v36
s_nop 2
v_pk_mul_f32 v[40:41], v[40:41], v[38:39] op_sel_hi:[1,0]
v_pk_mul_f32 v[42:43], v[42:43], v[38:39] op_sel_hi:[1,0]
v_cvt_pk_bf16_f32 v40, v40, v41
v_cvt_pk_bf16_f32 v41, v42, v43
v_pk_mul_f32 v[44:45], v[44:45], v[38:39] op_sel_hi:[1,0]
v_pk_mul_f32 v[46:47], v[46:47], v[38:39] op_sel_hi:[1,0]
s_mov_b64 exec, s[62:63]
v_cvt_pk_bf16_f32 v42, v44, v45
v_cvt_pk_bf16_f32 v43, v46, v47
ds_write_b128 v3, v[40:43] offset:0
s_mov_b64 exec, -1
v_mov_b32_dpp v40, v40 quad_perm:[2,3,2,3] row_mask:0xf bank_mask:0xf
v_mov_b32_dpp v41, v41 quad_perm:[2,3,2,3] row_mask:0xf bank_mask:0xf
v_mov_b32_dpp v42, v42 quad_perm:[2,3,2,3] row_mask:0xf bank_mask:0xf
v_mov_b32_dpp v43, v43 quad_perm:[2,3,2,3] row_mask:0xf bank_mask:0xf
s_waitcnt lgkmcnt(0)
s_nop 1
s_branch C_FBOK0
C_RA1:
s_sub_u32 s45, s45, 1
s_cbranch_scc1 END
s_waitcnt vmcnt(0) lgkmcnt(0)
s_barrier
buffer_load_dwordx4 v0, s[8:11], s66 offen offset:0 sc1 lds
buffer_load_dwordx4 v0, s[8:11], s66 offen offset:1024 sc1 lds
C_ENTRY1:
s_nop 7
v_mov_b32 v16, 0
v_mov_b32 v17, 0
v_mov_b32 v18, 0
v_mov_b32 v19, 0
v_mov_b32 v20, 0
v_mov_b32 v21, 0
v_mov_b32 v22, 0
v_mov_b32 v23, 0
v_mov_b32 v24, 0
v_mov_b32 v25, 0
v_mov_b32 v26, 0
v_mov_b32 v27, 0
v_mov_b32 v28, 0
v_mov_b32 v29, 0
v_mov_b32 v30, 0
v_mov_b32 v31, 0
v_mov_b32 v32, 0
v_mov_b32 v33, 0
v_mov_b32 v34, 0
v_mov_b32 v35, 0
v_mov_b32 v36, 0
v_mov_b32 v37, 0
v_mov_b32 v38, 0
v_mov_b32 v39, 0
ds_read_b128 v[64:67], v6 offset:24576
ds_read_b128 v[68:71], v6 offset:25600
ds_read_b128 v[72:75], v6 offset:26624
ds_read_b128 v[76:79], v6 offset:27648
s_waitcnt vmcnt(0)
C_A1:
s_barrier
ds_read_b128 v[56:59], v0 offset:0
ds_read_b128 v[60:63], v0 offset:1024
s_waitcnt lgkmcnt(1)
v_smfmac_f32_16x16x64_bf16 v[16:19], v[56:59], v[80:87], v4
s_add_u32 s2, s43, 2
s_min_u32 s2, s2, 63
v_smfmac_f32_16x16x64_bf16 v[20:23], v[56:59], v[224:231], v4
s_lshr_b32 s69, s2, 2
s_and_b32 s2, s2, 3
v_smfmac_f32_16x16x64_bf16 v[24:27], v[56:59], v[88:95], v4
buffer_load_dwordx4 v[40:43], v0, s[8:11], s67 offen offset:0
s_lshl_b32 s70, s41, 5
v_smfmac_f32_16x16x64_bf16 v[28:31], v[56:59], v[232:239], v4
buffer_load_dwordx4 v[44:47], v0, s[8:11], s67 offen offset:1024
s_add_u32 s70, s70, s2
v_lshl_add_u32 v5, v0, 3, s5
v_smfmac_f32_16x16x64_bf16 v[32:35], v[56:59], v[64:71], v4
ds_read_b128 v[64:67], v6 offset:28672
ds_read_b128 v[68:71], v6 offset:29696
v_smfmac_f32_16x16x64_bf16 v[36:39], v[56:59], v[72:79], v4
ds_read_b128 v[72:75], v6 offset:30720
ds_read_b128 v[76:79], v6 offset:31744
s_waitcnt lgkmcnt(4)
v_smfmac_f32_16x16x64_bf16 v[16:19], v[60:63], v[96:103], v4
s_waitcnt vmcnt(2)
s_barrier
ds_read_b128 v[12:15], v0 offset:2048
v_smfmac_f32_16x16x64_bf16 v[20:23], v[60:63], v[240:247], v4
ds_read_b128 v[56:59], v0 offset:3072
v_smfmac_f32_16x16x64_bf16 v[24:27], v[60:63], v[104:111], v4
buffer_load_dwordx4 v[48:51], v0, s[8:11], s67 offen offset:2048
s_lshl_b32 s70, s70, 2
v_smfmac_f32_16x16x64_bf16 v[28:31], v[60:63], v[248:255], v4
buffer_load_dwordx4 v[52:55], v0, s[8:11], s67 offen offset:3072
s_waitcnt lgkmcnt(4)
v_smfmac_f32_16x16x64_bf16 v[32:35], v[60:63], v[64:71], v4
ds_read_b128 v[64:67], v6 offset:32768
ds_read_b128 v[68:71], v6 offset:33792
s_waitcnt lgkmcnt(4)
v_smfmac_f32_16x16x64_bf16 v[36:39], v[60:63], v[72:79], v4
ds_read_b128 v[72:75], v6 offset:34816
ds_read_b128 v[76:79], v6 offset:35840
s_waitcnt lgkmcnt(5)
v_smfmac_f32_16x16x64_bf16 v[16:19], v[12:15], v[112:119], v4
s_waitcnt lgkmcnt(4)
v_bitop3_b32 v7, v12, v56, s44 bitop3:0x7e
v_smfmac_f32_16x16x64_bf16 v[20:23], v[12:15], a[0:7], v4
v_and_b32 v7, 1, v7
s_waitcnt lgkmcnt(2)
v_smfmac_f32_16x16x64_bf16 v[32:35], v[12:15], v[64:71], v4
s_barrier
ds_read_b128 v[60:63], v0 offset:4096
ds_read_b128 v[64:67], v0 offset:5120
v_cmp_eq_u32 vcc, s59, v7
s_waitcnt lgkmcnt(2)
v_smfmac_f32_16x16x64_bf16 v[36:39], v[12:15], v[72:79], v4
v_smfmac_f32_16x16x64_bf16 v[24:27], v[12:15], v[120:127], v4
s_cbranch_vccnz C_RA1
buffer_load_dword v5, v5, s[8:11], s67 offen
v_smfmac_f32_16x16x64_bf16 v[28:31], v[12:15], a[8:15], v4
buffer_load_dword v5, off, s[8:11], s70 sc1
v_smfmac_f32_16x16x64_bf16 v[16:19], v[56:59], v[128:135], v4
s_waitcnt lgkmcnt(0)
v_bitop3_b32 v7, v60, v64, s44 bitop3:0x7e
v_smfmac_f32_16x16x64_bf16 v[20:23], v[56:59], a[16:23], v4
v_and_b32 v7, 1, v7
v_smfmac_f32_16x16x64_bf16 v[24:27], v[56:59], v[136:143], v4
v_cmp_eq_u32 vcc, s59, v7
v_smfmac_f32_16x16x64_bf16 v[28:31], v[56:59], a[24:31], v4
s_cbranch_vccnz C_OF01
C_OK01:
s_barrier
ds_read_b128 v[68:71], v0 offset:6144
v_smfmac_f32_16x16x64_bf16 v[16:19], v[60:63], v[144:151], v4
ds_read_b128 v[72:75], v0 offset:7168
ds_read_b128 v[76:79], v0 offset:8192
v_smfmac_f32_16x16x64_bf16 v[20:23], v[60:63], a[32:39], v4
v_smfmac_f32_16x16x64_bf16 v[24:27], v[60:63], v[152:159], v4
v_smfmac_f32_16x16x64_bf16 v[28:31], v[60:63], a[40:47], v4
s_waitcnt lgkmcnt(1)
v_bitop3_b32 v13, v68, v72, s44 bitop3:0x7e
v_smfmac_f32_16x16x64_bf16 v[16:19], v[64:67], v[160:167], v4
s_waitcnt lgkmcnt(0)
v_bitop3_b32 v13, v76, v13, s44 bitop3:0xde
v_smfmac_f32_16x16x64_bf16 v[20:23], v[64:67], a[48:55], v4
v_and_b32 v13, 1, v13
v_smfmac_f32_16x16x64_bf16 v[24:27], v[64:67], v[168:175], v4
v_cmp_eq_u32 vcc, s59, v13
v_smfmac_f32_16x16x64_bf16 v[28:31], v[64:67], a[56:63], v4
s_cbranch_vccnz C_OF11
C_OK11:
v_smfmac_f32_16x16x64_bf16 v[16:19], v[68:71], v[176:183], v4
v_smfmac_f32_16x16x64_bf16 v[20:23], v[68:71], a[64:71], v4
s_add_u32 s67, s67, 524288
s_mov_b32 s74, s66
v_smfmac_f32_16x16x64_bf16 v[16:19], v[72:75], v[192:199], v4
v_smfmac_f32_16x16x64_bf16 v[20:23], v[72:75], a[80:87], v4
v_smfmac_f32_16x16x64_bf16 v[16:19], v[76:79], v[208:215], v4
v_smfmac_f32_16x16x64_bf16 v[20:23], v[76:79], a[96:103], v4
s_xor_b32 s44, s44, -1
s_mov_b32 s59, 1
v_smfmac_f32_16x16x64_bf16 v[24:27], v[68:71], v[184:191], v4
v_cvt_pk_bf16_f32 v16, v16, v17
v_smfmac_f32_16x16x64_bf16 v[24:27], v[72:75], v[200:207], v4
v_cvt_pk_bf16_f32 v17, v18, v19
v_smfmac_f32_16x16x64_bf16 v[24:27], v[76:79], v[216:223], v4
v_cvt_pk_bf16_f32 v18, v20, v21
v_smfmac_f32_16x16x64_bf16 v[28:31], v[68:71], a[72:79], v4
v_cvt_pk_bf16_f32 v19, v22, v23
v_smfmac_f32_16x16x64_bf16 v[28:31], v[72:75], a[88:95], v4
v_cvt_pk_bf16_f32 v24, v24, v25
v_smfmac_f32_16x16x64_bf16 v[28:31], v[76:79], a[104:111], v4
v_cvt_pk_bf16_f32 v25, v26, v27
v_mfma_f32_16x16x32_bf16 v[20:23], v[16:19], v[8:11], 0
s_nop 3
v_cvt_pk_bf16_f32 v26, v28, v29
v_cvt_pk_bf16_f32 v27, v30, v31
s_nop 1
v_mfma_f32_16x16x32_bf16 v[28:31], v[24:27], v[8:11], 0
v_cvt_pk_bf16_f32 v16, v20, v21
v_cvt_pk_bf16_f32 v17, v22, v23
v_smfmac_f32_16x16x64_bf16 v[32:35], v[72:75], a[224:231], v4
s_waitcnt vmcnt(4)
s_mov_b64 vcc, s[62:63]
s_nop 1
v_cvt_pk_bf16_f32 v18, v28, v29
v_cvt_pk_bf16_f32 v19, v30, v31
s_nop 1
v_mfma_f32_16x16x32_bf16 v[24:27], v[44:47], v[16:19], 0
v_mfma_f32_16x16x32_bf16 v[20:23], v[40:43], v[16:19], 0
v_mfma_f32_16x16x32_bf16 v[28:31], v[16:19], v[16:19], 0
s_nop 3
v_cndmask_b32_dpp v20, v24, v20, vcc quad_perm:[2,3,2,3] row_mask:0xf bank_mask:0xf
v_cndmask_b32_dpp v21, v25, v21, vcc quad_perm:[2,3,2,3] row_mask:0xf bank_mask:0xf
v_cndmask_b32_dpp v22, v26, v22, vcc quad_perm:[2,3,2,3] row_mask:0xf bank_mask:0xf
v_cndmask_b32_dpp v23, v27, v23, vcc quad_perm:[2,3,2,3] row_mask:0xf bank_mask:0xf
v_smfmac_f32_16x16x64_bf16 v[36:39], v[72:75], a[232:239], v4
ds_write_b128 v0, v[20:23] offset:10240
v_cndmask_b32_dpp v28, v29, v28, vcc quad_perm:[2,3,2,3] row_mask:0xf bank_mask:0xf
v_smfmac_f32_16x16x64_bf16 v[32:35], v[76:79], a[240:247], v4
ds_write_b32 v0, v28 offset:13316
v_mul_f32 v24, s72, v20
v_smfmac_f32_16x16x64_bf16 v[36:39], v[76:79], a[248:255], v4
v_mul_f32 v25, s72, v21
v_smfmac_f32_16x16x64_bf16 v[32:35], v[64:67], a[192:199], v4
v_mul_f32 v26, s72, v22
v_smfmac_f32_16x16x64_bf16 v[36:39], v[64:67], a[200:207], v4
v_mul_f32 v27, s72, v23
v_smfmac_f32_16x16x64_bf16 v[32:35], v[68:71], a[208:215], v4
v_mov_b32 v12, 0x3f803f80
v_smfmac_f32_16x16x64_bf16 v[36:39], v[68:71], a[216:223], v4
s_waitcnt lgkmcnt(0)
s_barrier
ds_read_b128 v[28:31], v0 offset:13312
ds_read_b128 v[16:19], v0 offset:9216
v_smfmac_f32_16x16x64_bf16 v[32:35], v[56:59], a[160:167], v4
ds_read_b128 v[40:43], v0 offset:12288
ds_read_b128 v[44:47], v0 offset:11264
v_mov_b32 v13, 0x3f803f80
v_smfmac_f32_16x16x64_bf16 v[36:39], v[56:59], a[168:175], v4
ds_read_b128 v[72:75], v6 offset:0
ds_read_b128 v[76:79], v6 offset:1024
v_mov_b32 v14, 0x3f803f80
v_smfmac_f32_16x16x64_bf16 v[32:35], v[60:63], a[176:183], v4
ds_read_b128 v[64:67], v6 offset:4096
ds_read_b128 v[68:71], v6 offset:5120
v_mov_b32 v15, 0x3f803f80
v_smfmac_f32_16x16x64_bf16 v[36:39], v[60:63], a[184:191], v4
v_mov_b32 v20, 0x3f003f00
v_mov_b32 v21, 0x3f003f00
s_waitcnt lgkmcnt(7)
v_pk_add_f32 v[28:29], v[28:29], v[30:31]
v_add_f32 v28, v28, v29
v_mul_f32 v28, s72, v28
s_waitcnt lgkmcnt(6)
v_pk_fma_f32 v[24:25], v[16:17], s[72:73], v[24:25]
v_exp_f32 v29, v28
v_pk_fma_f32 v[26:27], v[18:19], s[72:73], v[26:27]
s_waitcnt lgkmcnt(5)
v_pk_fma_f32 v[24:25], v[40:41], s[72:73], v[24:25]
v_cvt_pk_bf16_f32 v30, v29, v29
v_pk_fma_f32 v[26:27], v[42:43], s[72:73], v[26:27]
s_waitcnt lgkmcnt(4)
v_pk_fma_f32 v[24:25], v[44:45], s[72:73], v[24:25]
v_mov_b32_dpp v31, v30 quad_perm:[2,3,0,1] row_mask:0xf bank_mask:0xf
v_pk_fma_f32 v[26:27], v[46:47], s[72:73], v[26:27]
v_cvt_pk_bf16_f32 v32, v32, v33
v_cvt_pk_bf16_f32 v33, v34, v35
v_cvt_pk_bf16_f32 v34, v36, v37
v_cvt_pk_bf16_f32 v35, v38, v39
v_exp_f32 v24, v24
v_mfma_f32_16x16x16_bf16 v[40:43], v[32:33], v[30:31], 0
ds_read_b128 v[56:59], v6 offset:12288
ds_read_b128 v[60:63], v6 offset:13312
v_exp_f32 v25, v25
v_mfma_f32_16x16x16_bf16 v[44:47], v[34:35], v[30:31], 0
s_waitcnt vmcnt(2)
v_exp_f32 v26, v26
v_mfma_f32_16x16x16_bf16 v[36:39], v[20:21], v[30:31], 0
v_exp_f32 v27, v27
v_cvt_pk_bf16_f32 v16, v24, v25
v_cvt_pk_bf16_f32 v17, v26, v27
v_mov_b64 v[22:23], 0
v_mov_b32_dpp v18, v16 quad_perm:[2,3,0,1] row_mask:0xf bank_mask:0xf
v_mov_b32_dpp v19, v17 quad_perm:[2,3,0,1] row_mask:0xf bank_mask:0xf
v_mov_b64 v[24:25], 0
v_mov_b64 v[26:27], 0
v_mfma_f32_16x16x32_bf16 v[36:39], v[12:15], v[16:19], v[36:39]
v_mov_b32 v20, 0
v_mov_b32 v21, 0
v_mfma_f32_16x16x32_bf16 v[40:43], v[48:51], v[16:19], v[40:43]
v_mov_b32 v28, 0
v_mov_b32 v29, 0
v_mfma_f32_16x16x32_bf16 v[44:47], v[52:55], v[16:19], v[44:47]
v_rcp_f32 v38, v36
s_nop 2
v_pk_mul_f32 v[40:41], v[40:41], v[38:39] op_sel_hi:[1,0]
v_pk_mul_f32 v[42:43], v[42:43], v[38:39] op_sel_hi:[1,0]
v_cvt_pk_bf16_f32 v40, v40, v41
v_cvt_pk_bf16_f32 v41, v42, v43
v_pk_mul_f32 v[44:45], v[44:45], v[38:39] op_sel_hi:[1,0]
v_pk_mul_f32 v[46:47], v[46:47], v[38:39] op_sel_hi:[1,0]
s_mov_b64 exec, s[62:63]
v_cvt_pk_bf16_f32 v42, v44, v45
v_cvt_pk_bf16_f32 v43, v46, v47
ds_write_b128 v3, v[40:43] offset:512
s_mov_b64 exec, -1
v_max_f32 v36, v36, v38
v_cmp_nge_f32 vcc, s47, v36
v_mov_b32_dpp v40, v40 quad_perm:[2,3,2,3] row_mask:0xf bank_mask:0xf
v_mov_b32_dpp v41, v41 quad_perm:[2,3,2,3] row_mask:0xf bank_mask:0xf
v_mov_b32_dpp v42, v42 quad_perm:[2,3,2,3] row_mask:0xf bank_mask:0xf
v_mov_b32_dpp v43, v43 quad_perm:[2,3,2,3] row_mask:0xf bank_mask:0xf
s_cbranch_vccnz C_FB1
C_FBOK1:
v_mov_b64 v[30:31], 0
s_waitcnt lgkmcnt(5)
v_smfmac_f32_16x16x64_bf16 v[20:23], v[40:43], v[72:79], v4 abid:1
ds_read_b128 v[48:51], v6 offset:16384
ds_read_b128 v[52:55], v6 offset:17408
v_mov_b64 v[16:17], 0
s_waitcnt lgkmcnt(5)
v_smfmac_f32_16x16x64_bf16 v[24:27], v[40:43], v[64:71], v4 abid:1
ds_read_b128 v[72:75], v6 offset:2048
ds_read_b128 v[76:79], v6 offset:3072
v_mov_b64 v[18:19], 0
s_waitcnt lgkmcnt(4)
s_barrier
ds_read_b128 v[44:47], v3 offset:0
ds_read_b128 v[36:39], v3 offset:1536
ds_read_b128 v[12:15], v3 offset:1024
v_smfmac_f32_16x16x64_bf16 v[28:31], v[40:43], v[56:63], v4 abid:1
ds_read_b128 v[64:67], v6 offset:6144
ds_read_b128 v[68:71], v6 offset:7168
v_mov_b64 v[32:33], 0
v_smfmac_f32_16x16x64_bf16 v[16:19], v[40:43], a[112:119], v4 abid:1
ds_read_b128 v[56:59], v6 offset:8192
ds_read_b128 v[60:63], v6 offset:9216
v_mov_b64 v[34:35], 0
s_waitcnt lgkmcnt(9)
s_nop 0
v_smfmac_f32_16x16x64_bf16 v[32:35], v[40:43], v[48:55], v4 abid:1
ds_read_b128 v[48:51], v6 offset:10240
ds_read_b128 v[52:55], v6 offset:11264
s_waitcnt lgkmcnt(8)
v_smfmac_f32_16x16x64_bf16 v[20:23], v[44:47], v[72:79], v4 abid:1
ds_read_b128 v[72:75], v6 offset:14336
ds_read_b128 v[76:79], v6 offset:15360
s_waitcnt lgkmcnt(9)
v_smfmac_f32_16x16x64_bf16 v[20:23], v[36:39], a[128:135], v4 abid:1
s_waitcnt lgkmcnt(8)
v_smfmac_f32_16x16x64_bf16 v[20:23], v[12:15], a[136:143], v4 abid:1
s_waitcnt lgkmcnt(6)
v_smfmac_f32_16x16x64_bf16 v[24:27], v[44:47], v[64:71], v4 abid:1
ds_read_b128 v[64:67], v6 offset:18432
ds_read_b128 v[68:71], v6 offset:19456
s_waitcnt lgkmcnt(6)
v_smfmac_f32_16x16x64_bf16 v[24:27], v[36:39], v[56:63], v4 abid:1
ds_read_b128 v[56:59], v6 offset:20480
ds_read_b128 v[60:63], v6 offset:21504
v_cvt_pk_bf16_f32 v20, v20, v21
v_bfi_b32 v20, 1, s44, v20
v_cvt_pk_bf16_f32 v22, v22, v23
v_bfi_b32 v22, 1, s44, v22
s_waitcnt lgkmcnt(6)
v_smfmac_f32_16x16x64_bf16 v[24:27], v[12:15], v[48:55], v4 abid:1
buffer_store_dword v20, v1, s[8:11], s50 offen
buffer_store_dword v22, v1, s[8:11], s51 offen
ds_read_b128 v[48:51], v6 offset:22528
ds_read_b128 v[52:55], v6 offset:23552
s_waitcnt lgkmcnt(6)
v_smfmac_f32_16x16x64_bf16 v[28:31], v[44:47], v[72:79], v4 abid:1
v_mov_b32 v21, 0xeeee
v_smfmac_f32_16x16x64_bf16 v[28:31], v[36:39], a[144:151], v4 abid:1
v_cvt_pk_bf16_f32 v24, v24, v25
v_bfi_b32 v24, 1, s44, v24
v_smfmac_f32_16x16x64_bf16 v[28:31], v[12:15], a[152:159], v4 abid:1
buffer_store_dword v24, v1, s[8:11], s52 offen
v_cvt_pk_bf16_f32 v26, v26, v27
v_bfi_b32 v26, 1, s44, v26
s_waitcnt lgkmcnt(4)
v_smfmac_f32_16x16x64_bf16 v[32:35], v[44:47], v[64:71], v4 abid:1
buffer_store_dword v26, v1, s[8:11], s53 offen
s_waitcnt lgkmcnt(2)
v_smfmac_f32_16x16x64_bf16 v[32:35], v[36:39], v[56:63], v4 abid:1
v_cvt_pk_bf16_f32 v28, v28, v29
v_bfi_b32 v28, 1, s44, v28
s_waitcnt lgkmcnt(0)
v_smfmac_f32_16x16x64_bf16 v[32:35], v[12:15], v[48:55], v4 abid:1
buffer_store_dword v28, v1, s[8:11], s54 offen
v_cvt_pk_bf16_f32 v30, v30, v31
v_bfi_b32 v30, 1, s44, v30
v_smfmac_f32_16x16x64_bf16 v[16:19], v[44:47], a[112:119], v21
buffer_store_dword v30, v1, s[8:11], s55 offen
v_smfmac_f32_16x16x64_bf16 v[16:19], v[36:39], a[120:127], v4 abid:1
v_cvt_pk_bf16_f32 v32, v32, v33
v_bfi_b32 v32, 1, s44, v32
v_smfmac_f32_16x16x64_bf16 v[16:19], v[12:15], a[120:127], v21
buffer_store_dword v32, v1, s[8:11], s56 offen
v_cvt_pk_bf16_f32 v34, v34, v35
v_bfi_b32 v34, 1, s44, v34
buffer_store_dword v34, v1, s[8:11], s57 offen
s_nop 3
v_cvt_pk_bf16_f32 v16, v16, v17
v_bfi_b32 v16, 1, s44, v16
buffer_store_dword v16, v1, s[8:11], s58 offen
v_mov_b32 v60, 0x3f80
v_cndmask_b32 v60, v60, 1.0, s[32:33]
v_cndmask_b32 v56, 0, v60, s[24:25]
v_cndmask_b32 v57, 0, v60, s[26:27]
v_cndmask_b32 v58, 0, v60, s[28:29]
v_cndmask_b32 v59, 0, v60, s[30:31]
v_mov_b32 v20, 0
v_mov_b32 v21, 0
v_mov_b32 v22, 0
v_mov_b32 v23, 0
v_mov_b32 v24, 0
v_mov_b32 v25, 0
v_mov_b32 v26, 0
v_mov_b32 v27, 0
v_mov_b32 v28, 0
v_mov_b32 v29, 0
v_mov_b32 v30, 0
v_mov_b32 v31, 0
v_mov_b32 v32, 0
v_mov_b32 v33, 0
v_mov_b32 v34, 0
v_mov_b32 v35, 0
v_mov_b32 v36, 0
v_mov_b32 v37, 0
v_mov_b32 v38, 0
v_mov_b32 v39, 0
v_mov_b32 v17, 0
v_mov_b32 v18, 0
v_mov_b32 v19, 0
v_mov_b32 v16, 0
s_waitcnt vmcnt(3)
buffer_load_dwordx4 v[72:75], v0, s[8:11], s64 offen offset:0 sc1
buffer_load_dwordx4 v[76:79], v0, s[8:11], s64 offen offset:1024 sc1
s_waitcnt vmcnt(2)
buffer_load_dwordx4 v[64:67], v0, s[8:11], s65 offen offset:0 sc1
buffer_load_dwordx4 v[68:71], v0, s[8:11], s65 offen offset:1024 sc1
s_waitcnt vmcnt(3)
v_mfma_f32_16x16x32_bf16 v[60:63], v[56:59], v[72:75], 0
s_waitcnt vmcnt(2)
v_mfma_f32_16x16x32_bf16 v[60:63], v[56:59], v[76:79], v[60:63]
v_bitop3_b32 v12, v72, v73, s44 bitop3:0x7e
v_bitop3_b32 v13, v74, v75, s44 bitop3:0x7e
v_bitop3_b32 v14, v76, v77, s44 bitop3:0x7e
v_bitop3_b32 v15, v78, v79, s44 bitop3:0x7e
v_or3_b32 v12, v12, v13, v14
v_bitop3_b32 v12, v12, v15, 1 bitop3:0xa8
v_cmp_ne_u32 vcc, 0, v12
s_nop 0
v_add_f32_dpp v60, v60, v60 row_ror:4 row_mask:0xf bank_mask:0xf
v_add_f32_dpp v61, v61, v61 row_ror:4 row_mask:0xf bank_mask:0xf
s_cbranch_vccnz C_RR01
C_RT01:
v_add_f32_dpp v60, v60, v60 row_ror:8 row_mask:0xf bank_mask:0xf
v_add_f32_dpp v61, v61, v61 row_ror:8 row_mask:0xf bank_mask:0xf
s_mov_b64 exec, s[60:61]
v_cvt_pk_bf16_f32 v60, v60, v61
v_bfi_b32 v60, 1, s44, v60
buffer_store_dword v60, v2, s[8:11], 0 offen
s_mov_b64 exec, -1
s_waitcnt vmcnt(2)
v_mfma_f32_16x16x32_bf16 v[60:63], v[56:59], v[64:67], 0
s_waitcnt vmcnt(1)
v_mfma_f32_16x16x32_bf16 v[60:63], v[56:59], v[68:71], v[60:63]
v_bitop3_b32 v12, v64, v65, s44 bitop3:0x7e
v_bitop3_b32 v13, v66, v67, s44 bitop3:0x7e
v_bitop3_b32 v14, v68, v69, s44 bitop3:0x7e
v_bitop3_b32 v15, v70, v71, s44 bitop3:0x7e
v_or3_b32 v12, v12, v13, v14
v_bitop3_b32 v12, v12, v15, 1 bitop3:0xa8
v_cmp_ne_u32 vcc, 0, v12
s_nop 0
v_add_f32_dpp v60, v60, v60 row_ror:4 row_mask:0xf bank_mask:0xf
v_add_f32_dpp v61, v61, v61 row_ror:4 row_mask:0xf bank_mask:0xf
s_cbranch_vccnz C_RR11
C_RT11:
v_add_f32_dpp v60, v60, v60 row_ror:8 row_mask:0xf bank_mask:0xf
v_add_f32_dpp v61, v61, v61 row_ror:8 row_mask:0xf bank_mask:0xf
s_mov_b64 exec, s[34:35]
v_cvt_pk_bf16_f32 v60, v60, v61
v_bfi_b32 v60, 1, s44, v60
buffer_store_dword v60, v2, s[8:11], s4 offen
s_mov_b64 exec, -1
s_add_u32 s43, s43, 1
s_cmp_eq_u32 s43, 63
s_cbranch_scc1 C_X1
C_FW1:
v_cmp_ge_u32 vcc, s69, v5
s_cbranch_vccnz C_RF1
s_waitcnt vmcnt(1)
ds_read_b128 v[64:67], v6 offset:24576
ds_read_b128 v[68:71], v6 offset:25600
ds_read_b128 v[72:75], v6 offset:26624
ds_read_b128 v[76:79], v6 offset:27648
s_barrier
buffer_load_dwordx4 v0, s[8:11], s66 offen offset:0 sc1 lds
buffer_load_dwordx4 v0, s[8:11], s66 offen offset:1024 sc1 lds
s_branch C_A1
C_X1:
s_waitcnt vmcnt(0) lgkmcnt(0)
s_branch END
C_RR01:
s_mov_b64 exec, vcc
buffer_load_dwordx4 v[72:75], v0, s[8:11], s64 offen offset:0 sc1
buffer_load_dwordx4 v[76:79], v0, s[8:11], s64 offen offset:1024 sc1
s_mov_b64 exec, -1
buffer_load_dwordx4 v[64:67], v0, s[8:11], s65 offen offset:0 sc1
buffer_load_dwordx4 v[68:71], v0, s[8:11], s65 offen offset:1024 sc1
C_RL01:
s_mov_b64 exec, vcc
buffer_load_dwordx4 v[72:75], v0, s[8:11], s64 offen offset:0 sc1
buffer_load_dwordx4 v[76:79], v0, s[8:11], s64 offen offset:1024 sc1
s_mov_b64 exec, -1
buffer_load_dwordx4 v[64:67], v0, s[8:11], s65 offen offset:0 sc1
buffer_load_dwordx4 v[68:71], v0, s[8:11], s65 offen offset:1024 sc1
s_sub_u32 s45, s45, 1
s_cbranch_scc1 END
s_waitcnt vmcnt(6)
v_bitop3_b32 v12, v72, v73, s44 bitop3:0x7e
v_bitop3_b32 v13, v74, v75, s44 bitop3:0x7e
v_bitop3_b32 v14, v76, v77, s44 bitop3:0x7e
v_bitop3_b32 v15, v78, v79, s44 bitop3:0x7e
v_or3_b32 v12, v12, v13, v14
v_bitop3_b32 v12, v12, v15, 1 bitop3:0xa8
v_cmp_ne_u32 vcc, 0, v12
s_cbranch_vccnz C_RL01
C_RM01:
v_mfma_f32_16x16x32_bf16 v[60:63], v[56:59], v[72:75], 0
v_mfma_f32_16x16x32_bf16 v[60:63], v[56:59], v[76:79], v[60:63]
v_bitop3_b32 v12, v64, v65, s44 bitop3:0x7e
v_bitop3_b32 v13, v66, v67, s44 bitop3:0x7e
v_bitop3_b32 v14, v68, v69, s44 bitop3:0x7e
v_bitop3_b32 v15, v70, v71, s44 bitop3:0x7e
v_or3_b32 v12, v12, v13, v14
v_bitop3_b32 v12, v12, v15, 1 bitop3:0xa8
v_cmp_ne_u32 vcc, 0, v12
s_nop 0
v_add_f32_dpp v60, v60, v60 row_ror:4 row_mask:0xf bank_mask:0xf
v_add_f32_dpp v61, v61, v61 row_ror:4 row_mask:0xf bank_mask:0xf
s_nop 0
v_add_f32_dpp v60, v60, v60 row_ror:8 row_mask:0xf bank_mask:0xf
v_add_f32_dpp v61, v61, v61 row_ror:8 row_mask:0xf bank_mask:0xf
s_mov_b64 exec, s[60:61]
v_cvt_pk_bf16_f32 v60, v60, v61
v_bfi_b32 v60, 1, s44, v60
buffer_store_dword v60, v2, s[8:11], 0 offen
s_mov_b64 exec, -1
s_cbranch_vccz C_RM11
s_branch C_RL11
C_RR11:
s_mov_b64 exec, vcc
buffer_load_dwordx4 v[64:67], v0, s[8:11], s65 offen offset:0 sc1
buffer_load_dwordx4 v[68:71], v0, s[8:11], s65 offen offset:1024 sc1
s_mov_b64 exec, -1
C_RL11:
s_mov_b64 exec, vcc
buffer_load_dwordx4 v[64:67], v0, s[8:11], s65 offen offset:0 sc1
buffer_load_dwordx4 v[68:71], v0, s[8:11], s65 offen offset:1024 sc1
s_mov_b64 exec, -1
s_sub_u32 s45, s45, 1
s_cbranch_scc1 END
s_waitcnt vmcnt(2)
v_bitop3_b32 v12, v64, v65, s44 bitop3:0x7e
v_bitop3_b32 v13, v66, v67, s44 bitop3:0x7e
v_bitop3_b32 v14, v68, v69, s44 bitop3:0x7e
v_bitop3_b32 v15, v70, v71, s44 bitop3:0x7e
v_or3_b32 v12, v12, v13, v14
v_bitop3_b32 v12, v12, v15, 1 bitop3:0xa8
v_cmp_ne_u32 vcc, 0, v12
s_cbranch_vccnz C_RL11
C_RM11:
v_mfma_f32_16x16x32_bf16 v[60:63], v[56:59], v[64:67], 0
v_mfma_f32_16x16x32_bf16 v[60:63], v[56:59], v[68:71], v[60:63]
s_nop 7
v_add_f32_dpp v60, v60, v60 row_ror:4 row_mask:0xf bank_mask:0xf
v_add_f32_dpp v61, v61, v61 row_ror:4 row_mask:0xf bank_mask:0xf
s_branch C_RT11
C_OF01:
s_sub_u32 s45, s45, 1
s_cbranch_scc1 END
s_waitcnt lgkmcnt(0)
s_barrier
s_barrier
ds_read_b128 v[60:63], v0 offset:4096
ds_read_b128 v[64:67], v0 offset:5120
s_waitcnt lgkmcnt(0)
v_bitop3_b32 v7, v60, v64, s44 bitop3:0x7e
v_and_b32 v7, 1, v7
v_cmp_eq_u32 vcc, s59, v7
s_cbranch_vccnz C_OF01
s_branch C_OK01
C_OF11:
s_sub_u32 s45, s45, 1
s_cbranch_scc1 END
s_waitcnt lgkmcnt(0)
s_barrier
s_barrier
ds_read_b128 v[68:71], v0 offset:6144
ds_read_b128 v[72:75], v0 offset:7168
ds_read_b128 v[76:79], v0 offset:8192
s_waitcnt lgkmcnt(0)
v_bitop3_b32 v13, v68, v72, s44 bitop3:0x7e
v_bitop3_b32 v13, v76, v13, s44 bitop3:0xde
v_and_b32 v13, 1, v13
v_cmp_eq_u32 vcc, s59, v13
s_cbranch_vccnz C_OF11
s_branch C_OK11
C_RF1:
s_sub_u32 s45, s45, 1
s_cbranch_scc1 END
buffer_load_dword v5, off, s[8:11], s70 sc1
s_waitcnt vmcnt(0)
s_branch C_FW1
C_FB1:
ds_read_b128 v[28:31], v0 offset:13312
ds_read_b128 v[24:27], v0 offset:10240
ds_read_b128 v[16:19], v0 offset:9216
ds_read_b128 v[40:43], v0 offset:12288
ds_read_b128 v[44:47], v0 offset:11264
v_mov_b32 v20, 0x3f003f00
v_mov_b32 v21, 0x3f003f00
s_waitcnt lgkmcnt(0)
v_pk_add_f32 v[28:29], v[28:29], v[30:31]
v_add_f32 v28, v28, v29
v_mul_f32 v28, s72, v28
v_mul_f32 v24, s72, v24
v_mul_f32 v25, s72, v25
v_mul_f32 v26, s72, v26
v_mul_f32 v27, s72, v27
v_pk_fma_f32 v[24:25], v[16:17], s[72:73], v[24:25]
v_pk_fma_f32 v[26:27], v[18:19], s[72:73], v[26:27]
v_pk_fma_f32 v[24:25], v[40:41], s[72:73], v[24:25]
v_pk_fma_f32 v[26:27], v[42:43], s[72:73], v[26:27]
v_pk_fma_f32 v[24:25], v[44:45], s[72:73], v[24:25]
v_pk_fma_f32 v[26:27], v[46:47], s[72:73], v[26:27]
v_max3_f32 v36, v24, v25, v26
v_max3_f32 v36, v36, v27, v28
s_nop 1
v_max_f32_dpp v36, v36, v36 quad_perm:[2,3,0,1] row_mask:0xf bank_mask:0xf
v_mov_b32 v37, v36
s_nop 1
v_permlane16_swap_b32 v36, v37
v_max_f32 v36, v36, v37
v_mov_b32 v37, v36
s_nop 1
v_permlane32_swap_b32 v36, v37
v_max_f32 v36, v36, v37
v_sub_f32 v24, v24, v36
v_sub_f32 v25, v25, v36
v_sub_f32 v26, v26, v36
v_sub_f32 v27, v27, v36
v_sub_f32 v28, v28, v36
v_exp_f32 v29, v28
s_nop 0
v_cvt_pk_bf16_f32 v30, v29, v29
s_nop 1
v_mov_b32_dpp v31, v30 quad_perm:[2,3,0,1] row_mask:0xf bank_mask:0xf
v_exp_f32 v24, v24
s_nop 0
v_mfma_f32_16x16x16_bf16 v[40:43], v[32:33], v[30:31], 0
v_exp_f32 v25, v25
v_mfma_f32_16x16x16_bf16 v[44:47], v[34:35], v[30:31], 0
v_exp_f32 v26, v26
v_mfma_f32_16x16x16_bf16 v[36:39], v[20:21], v[30:31], 0
v_exp_f32 v27, v27
v_cvt_pk_bf16_f32 v16, v24, v25
v_cvt_pk_bf16_f32 v17, v26, v27
v_mov_b64 v[22:23], 0
v_mov_b32_dpp v18, v16 quad_perm:[2,3,0,1] row_mask:0xf bank_mask:0xf
v_mov_b32_dpp v19, v17 quad_perm:[2,3,0,1] row_mask:0xf bank_mask:0xf
v_mov_b64 v[24:25], 0
v_mov_b64 v[26:27], 0
v_mfma_f32_16x16x32_bf16 v[36:39], v[12:15], v[16:19], v[36:39]
v_mov_b32 v20, 0
v_mov_b32 v21, 0
v_mfma_f32_16x16x32_bf16 v[40:43], v[48:51], v[16:19], v[40:43]
v_mov_b32 v28, 0
v_mov_b32 v29, 0
v_mfma_f32_16x16x32_bf16 v[44:47], v[52:55], v[16:19], v[44:47]
v_rcp_f32 v38, v36
s_nop 2
v_pk_mul_f32 v[40:41], v[40:41], v[38:39] op_sel_hi:[1,0]
v_pk_mul_f32 v[42:43], v[42:43], v[38:39] op_sel_hi:[1,0]
v_cvt_pk_bf16_f32 v40, v40, v41
v_cvt_pk_bf16_f32 v41, v42, v43
v_pk_mul_f32 v[44:45], v[44:45], v[38:39] op_sel_hi:[1,0]
v_pk_mul_f32 v[46:47], v[46:47], v[38:39] op_sel_hi:[1,0]
s_mov_b64 exec, s[62:63]
v_cvt_pk_bf16_f32 v42, v44, v45
v_cvt_pk_bf16_f32 v43, v46, v47
ds_write_b128 v3, v[40:43] offset:512
s_mov_b64 exec, -1
v_mov_b32_dpp v40, v40 quad_perm:[2,3,2,3] row_mask:0xf bank_mask:0xf
v_mov_b32_dpp v41, v41 quad_perm:[2,3,2,3] row_mask:0xf bank_mask:0xf
v_mov_b32_dpp v42, v42 quad_perm:[2,3,2,3] row_mask:0xf bank_mask:0xf
v_mov_b32_dpp v43, v43 quad_perm:[2,3,2,3] row_mask:0xf bank_mask:0xf
s_waitcnt lgkmcnt(0)
s_nop 1
s_branch C_FBOK1
C_RA2:
s_sub_u32 s45, s45, 1
s_cbranch_scc1 END
s_waitcnt vmcnt(0) lgkmcnt(0)
s_barrier
C_ENTRY2:
s_nop 7
v_mov_b32 v16, 0
v_mov_b32 v17, 0
v_mov_b32 v18, 0
v_mov_b32 v19, 0
v_mov_b32 v20, 0
v_mov_b32 v21, 0
v_mov_b32 v22, 0
v_mov_b32 v23, 0
v_mov_b32 v24, 0
v_mov_b32 v25, 0
v_mov_b32 v26, 0
v_mov_b32 v27, 0
v_mov_b32 v28, 0
v_mov_b32 v29, 0
v_mov_b32 v30, 0
v_mov_b32 v31, 0
v_mov_b32 v32, 0
v_mov_b32 v33, 0
v_mov_b32 v34, 0
v_mov_b32 v35, 0
v_mov_b32 v36, 0
v_mov_b32 v37, 0
v_mov_b32 v38, 0
v_mov_b32 v39, 0
ds_read_b128 v[64:67], v6 offset:24576
ds_read_b128 v[68:71], v6 offset:25600
ds_read_b128 v[72:75], v6 offset:26624
ds_read_b128 v[76:79], v6 offset:27648
s_waitcnt vmcnt(0)
C_A2:
s_barrier
ds_read_b128 v[56:59], v0 offset:0
ds_read_b128 v[60:63], v0 offset:1024
buffer_load_dwordx4 v0, s[8:11], s74 offen offset:0 sc1 lds
buffer_load_dwordx4 v0, s[8:11], s74 offen offset:1024 sc1 lds
s_waitcnt lgkmcnt(1)
v_smfmac_f32_16x16x64_bf16 v[16:19], v[56:59], v[80:87], v4
v_smfmac_f32_16x16x64_bf16 v[20:23], v[56:59], v[224:231], v4
v_smfmac_f32_16x16x64_bf16 v[24:27], v[56:59], v[88:95], v4
buffer_load_dwordx4 v[40:43], v0, s[8:11], s67 offen offset:0
v_smfmac_f32_16x16x64_bf16 v[28:31], v[56:59], v[232:239], v4
buffer_load_dwordx4 v[44:47], v0, s[8:11], s67 offen offset:1024
v_lshl_add_u32 v5, v0, 3, s5
v_smfmac_f32_16x16x64_bf16 v[32:35], v[56:59], v[64:71], v4
ds_read_b128 v[64:67], v6 offset:28672
ds_read_b128 v[68:71], v6 offset:29696
v_smfmac_f32_16x16x64_bf16 v[36:39], v[56:59], v[72:79], v4
ds_read_b128 v[72:75], v6 offset:30720
ds_read_b128 v[76:79], v6 offset:31744
s_waitcnt lgkmcnt(4)
v_smfmac_f32_16x16x64_bf16 v[16:19], v[60:63], v[96:103], v4
s_barrier
ds_read_b128 v[12:15], v0 offset:2048
v_smfmac_f32_16x16x64_bf16 v[20:23], v[60:63], v[240:247], v4
ds_read_b128 v[56:59], v0 offset:3072
v_smfmac_f32_16x16x64_bf16 v[24:27], v[60:63], v[104:111], v4
buffer_load_dwordx4 v[48:51], v0, s[8:11], s67 offen offset:2048
v_smfmac_f32_16x16x64_bf16 v[28:31], v[60:63], v[248:255], v4
buffer_load_dwordx4 v[52:55], v0, s[8:11], s67 offen offset:3072
s_waitcnt lgkmcnt(4)
v_smfmac_f32_16x16x64_bf16 v[32:35], v[60:63], v[64:71], v4
ds_read_b128 v[64:67], v6 offset:32768
ds_read_b128 v[68:71], v6 offset:33792
s_waitcnt lgkmcnt(4)
v_smfmac_f32_16x16x64_bf16 v[36:39], v[60:63], v[72:79], v4
ds_read_b128 v[72:75], v6 offset:34816
ds_read_b128 v[76:79], v6 offset:35840
s_waitcnt lgkmcnt(5)
v_smfmac_f32_16x16x64_bf16 v[16:19], v[12:15], v[112:119], v4
s_waitcnt lgkmcnt(4)
v_bitop3_b32 v7, v12, v56, s44 bitop3:0x7e
v_smfmac_f32_16x16x64_bf16 v[20:23], v[12:15], a[0:7], v4
v_and_b32 v7, 1, v7
s_waitcnt lgkmcnt(2)
v_smfmac_f32_16x16x64_bf16 v[32:35], v[12:15], v[64:71], v4
s_waitcnt vmcnt(4)
s_barrier
ds_read_b128 v[60:63], v0 offset:4096
ds_read_b128 v[64:67], v0 offset:5120
v_cmp_eq_u32 vcc, s59, v7
s_waitcnt lgkmcnt(2)
v_smfmac_f32_16x16x64_bf16 v[36:39], v[12:15], v[72:79], v4
v_smfmac_f32_16x16x64_bf16 v[24:27], v[12:15], v[120:127], v4
s_cbranch_vccnz C_RA2
buffer_load_dword v5, v5, s[8:11], s67 offen
v_smfmac_f32_16x16x64_bf16 v[28:31], v[12:15], a[8:15], v4
v_smfmac_f32_16x16x64_bf16 v[16:19], v[56:59], v[128:135], v4
s_waitcnt lgkmcnt(0)
v_bitop3_b32 v7, v60, v64, s44 bitop3:0x7e
v_smfmac_f32_16x16x64_bf16 v[20:23], v[56:59], a[16:23], v4
v_and_b32 v7, 1, v7
v_smfmac_f32_16x16x64_bf16 v[24:27], v[56:59], v[136:143], v4
v_cmp_eq_u32 vcc, s59, v7
v_smfmac_f32_16x16x64_bf16 v[28:31], v[56:59], a[24:31], v4
s_cbranch_vccnz C_OF02
C_OK02:
s_barrier
ds_read_b128 v[68:71], v0 offset:6144
v_smfmac_f32_16x16x64_bf16 v[16:19], v[60:63], v[144:151], v4
ds_read_b128 v[72:75], v0 offset:7168
ds_read_b128 v[76:79], v0 offset:8192
v_smfmac_f32_16x16x64_bf16 v[20:23], v[60:63], a[32:39], v4
v_smfmac_f32_16x16x64_bf16 v[24:27], v[60:63], v[152:159], v4
v_smfmac_f32_16x16x64_bf16 v[28:31], v[60:63], a[40:47], v4
s_waitcnt lgkmcnt(1)
v_bitop3_b32 v13, v68, v72, s44 bitop3:0x7e
v_smfmac_f32_16x16x64_bf16 v[16:19], v[64:67], v[160:167], v4
s_waitcnt lgkmcnt(0)
v_bitop3_b32 v13, v76, v13, s44 bitop3:0xde
v_smfmac_f32_16x16x64_bf16 v[20:23], v[64:67], a[48:55], v4
v_and_b32 v13, 1, v13
v_smfmac_f32_16x16x64_bf16 v[24:27], v[64:67], v[168:175], v4
v_cmp_eq_u32 vcc, s59, v13
v_smfmac_f32_16x16x64_bf16 v[28:31], v[64:67], a[56:63], v4
s_cbranch_vccnz C_OF12
C_OK12:
v_smfmac_f32_16x16x64_bf16 v[16:19], v[68:71], v[176:183], v4
v_smfmac_f32_16x16x64_bf16 v[20:23], v[68:71], a[64:71], v4
s_add_u32 s67, s67, 524288
s_mov_b32 s74, s66
v_smfmac_f32_16x16x64_bf16 v[16:19], v[72:75], v[192:199], v4
v_smfmac_f32_16x16x64_bf16 v[20:23], v[72:75], a[80:87], v4
v_smfmac_f32_16x16x64_bf16 v[16:19], v[76:79], v[208:215], v4
v_smfmac_f32_16x16x64_bf16 v[20:23], v[76:79], a[96:103], v4
s_xor_b32 s44, s44, -1
s_mov_b32 s59, 1
v_smfmac_f32_16x16x64_bf16 v[24:27], v[68:71], v[184:191], v4
v_cvt_pk_bf16_f32 v16, v16, v17
v_smfmac_f32_16x16x64_bf16 v[24:27], v[72:75], v[200:207], v4
v_cvt_pk_bf16_f32 v17, v18, v19
v_smfmac_f32_16x16x64_bf16 v[24:27], v[76:79], v[216:223], v4
v_cvt_pk_bf16_f32 v18, v20, v21
v_smfmac_f32_16x16x64_bf16 v[28:31], v[68:71], a[72:79], v4
v_cvt_pk_bf16_f32 v19, v22, v23
v_smfmac_f32_16x16x64_bf16 v[28:31], v[72:75], a[88:95], v4
v_cvt_pk_bf16_f32 v24, v24, v25
v_smfmac_f32_16x16x64_bf16 v[28:31], v[76:79], a[104:111], v4
v_cvt_pk_bf16_f32 v25, v26, v27
v_mfma_f32_16x16x32_bf16 v[20:23], v[16:19], v[8:11], 0
s_nop 3
v_cvt_pk_bf16_f32 v26, v28, v29
v_cvt_pk_bf16_f32 v27, v30, v31
s_nop 1
v_mfma_f32_16x16x32_bf16 v[28:31], v[24:27], v[8:11], 0
v_cvt_pk_bf16_f32 v16, v20, v21
v_cvt_pk_bf16_f32 v17, v22, v23
v_smfmac_f32_16x16x64_bf16 v[32:35], v[72:75], a[224:231], v4
s_waitcnt vmcnt(3)
s_mov_b64 vcc, s[62:63]
s_nop 1
v_cvt_pk_bf16_f32 v18, v28, v29
v_cvt_pk_bf16_f32 v19, v30, v31
s_nop 1
v_mfma_f32_16x16x32_bf16 v[24:27], v[44:47], v[16:19], 0
v_mfma_f32_16x16x32_bf16 v[20:23], v[40:43], v[16:19], 0
v_mfma_f32_16x16x32_bf16 v[28:31], v[16:19], v[16:19], 0
s_nop 3
v_cndmask_b32_dpp v20, v24, v20, vcc quad_perm:[2,3,2,3] row_mask:0xf bank_mask:0xf
v_cndmask_b32_dpp v21, v25, v21, vcc quad_perm:[2,3,2,3] row_mask:0xf bank_mask:0xf
v_cndmask_b32_dpp v22, v26, v22, vcc quad_perm:[2,3,2,3] row_mask:0xf bank_mask:0xf
v_cndmask_b32_dpp v23, v27, v23, vcc quad_perm:[2,3,2,3] row_mask:0xf bank_mask:0xf
v_smfmac_f32_16x16x64_bf16 v[36:39], v[72:75], a[232:239], v4
ds_write_b128 v0, v[20:23] offset:11264
v_cndmask_b32_dpp v28, v29, v28, vcc quad_perm:[2,3,2,3] row_mask:0xf bank_mask:0xf
v_smfmac_f32_16x16x64_bf16 v[32:35], v[76:79], a[240:247], v4
ds_write_b32 v0, v28 offset:13320
v_mul_f32 v24, s72, v20
v_smfmac_f32_16x16x64_bf16 v[36:39], v[76:79], a[248:255], v4
v_mul_f32 v25, s72, v21
v_smfmac_f32_16x16x64_bf16 v[32:35], v[64:67], a[192:199], v4
v_mul_f32 v26, s72, v22
v_smfmac_f32_16x16x64_bf16 v[36:39], v[64:67], a[200:207], v4
v_mul_f32 v27, s72, v23
v_smfmac_f32_16x16x64_bf16 v[32:35], v[68:71], a[208:215], v4
v_mov_b32 v12, 0x3f803f80
v_smfmac_f32_16x16x64_bf16 v[36:39], v[68:71], a[216:223], v4
s_waitcnt lgkmcnt(0)
s_barrier
ds_read_b128 v[28:31], v0 offset:13312
ds_read_b128 v[16:19], v0 offset:12288
v_smfmac_f32_16x16x64_bf16 v[32:35], v[56:59], a[160:167], v4
ds_read_b128 v[40:43], v0 offset:9216
ds_read_b128 v[44:47], v0 offset:10240
v_mov_b32 v13, 0x3f803f80
v_smfmac_f32_16x16x64_bf16 v[36:39], v[56:59], a[168:175], v4
ds_read_b128 v[72:75], v6 offset:0
ds_read_b128 v[76:79], v6 offset:1024
v_mov_b32 v14, 0x3f803f80
v_smfmac_f32_16x16x64_bf16 v[32:35], v[60:63], a[176:183], v4
ds_read_b128 v[64:67], v6 offset:4096
ds_read_b128 v[68:71], v6 offset:5120
v_mov_b32 v15, 0x3f803f80
v_smfmac_f32_16x16x64_bf16 v[36:39], v[60:63], a[184:191], v4
v_mov_b32 v20, 0x3f003f00
v_mov_b32 v21, 0x3f003f00
s_waitcnt lgkmcnt(7)
v_pk_add_f32 v[28:29], v[28:29], v[30:31]
v_add_f32 v28, v28, v29
v_mul_f32 v28, s72, v28
s_waitcnt lgkmcnt(6)
v_pk_fma_f32 v[24:25], v[16:17], s[72:73], v[24:25]
v_exp_f32 v29, v28
v_pk_fma_f32 v[26:27], v[18:19], s[72:73], v[26:27]
s_waitcnt lgkmcnt(5)
v_pk_fma_f32 v[24:25], v[40:41], s[72:73], v[24:25]
v_cvt_pk_bf16_f32 v30, v29, v29
v_pk_fma_f32 v[26:27], v[42:43], s[72:73], v[26:27]
s_waitcnt lgkmcnt(4)
v_pk_fma_f32 v[24:25], v[44:45], s[72:73], v[24:25]
v_mov_b32_dpp v31, v30 quad_perm:[2,3,0,1] row_mask:0xf bank_mask:0xf
v_pk_fma_f32 v[26:27], v[46:47], s[72:73], v[26:27]
v_cvt_pk_bf16_f32 v32, v32, v33
v_cvt_pk_bf16_f32 v33, v34, v35
v_cvt_pk_bf16_f32 v34, v36, v37
v_cvt_pk_bf16_f32 v35, v38, v39
v_exp_f32 v24, v24
v_mfma_f32_16x16x16_bf16 v[40:43], v[32:33], v[30:31], 0
ds_read_b128 v[56:59], v6 offset:12288
ds_read_b128 v[60:63], v6 offset:13312
v_exp_f32 v25, v25
v_mfma_f32_16x16x16_bf16 v[44:47], v[34:35], v[30:31], 0
s_waitcnt vmcnt(1)
v_exp_f32 v26, v26
v_mfma_f32_16x16x16_bf16 v[36:39], v[20:21], v[30:31], 0
v_exp_f32 v27, v27
v_cvt_pk_bf16_f32 v16, v24, v25
v_cvt_pk_bf16_f32 v17, v26, v27
v_mov_b64 v[22:23], 0
v_mov_b32_dpp v18, v16 quad_perm:[2,3,0,1] row_mask:0xf bank_mask:0xf
v_mov_b32_dpp v19, v17 quad_perm:[2,3,0,1] row_mask:0xf bank_mask:0xf
v_mov_b64 v[24:25], 0
v_mov_b64 v[26:27], 0
v_mfma_f32_16x16x32_bf16 v[36:39], v[12:15], v[16:19], v[36:39]
v_mov_b32 v20, 0
v_mov_b32 v21, 0
v_mfma_f32_16x16x32_bf16 v[40:43], v[48:51], v[16:19], v[40:43]
v_mov_b32 v28, 0
v_mov_b32 v29, 0
v_mfma_f32_16x16x32_bf16 v[44:47], v[52:55], v[16:19], v[44:47]
v_rcp_f32 v38, v36
s_nop 2
v_pk_mul_f32 v[40:41], v[40:41], v[38:39] op_sel_hi:[1,0]
v_pk_mul_f32 v[42:43], v[42:43], v[38:39] op_sel_hi:[1,0]
v_cvt_pk_bf16_f32 v40, v40, v41
v_cvt_pk_bf16_f32 v41, v42, v43
v_pk_mul_f32 v[44:45], v[44:45], v[38:39] op_sel_hi:[1,0]
v_pk_mul_f32 v[46:47], v[46:47], v[38:39] op_sel_hi:[1,0]
s_mov_b64 exec, s[62:63]
v_cvt_pk_bf16_f32 v42, v44, v45
v_cvt_pk_bf16_f32 v43, v46, v47
ds_write_b128 v3, v[40:43] offset:1024
s_mov_b64 exec, -1
v_max_f32 v36, v36, v38
v_cmp_nge_f32 vcc, s47, v36
v_mov_b32_dpp v40, v40 quad_perm:[2,3,2,3] row_mask:0xf bank_mask:0xf
v_mov_b32_dpp v41, v41 quad_perm:[2,3,2,3] row_mask:0xf bank_mask:0xf
v_mov_b32_dpp v42, v42 quad_perm:[2,3,2,3] row_mask:0xf bank_mask:0xf
v_mov_b32_dpp v43, v43 quad_perm:[2,3,2,3] row_mask:0xf bank_mask:0xf
s_cbranch_vccnz C_FB2
C_FBOK2:
v_mov_b64 v[30:31], 0
s_waitcnt lgkmcnt(5)
v_smfmac_f32_16x16x64_bf16 v[20:23], v[40:43], v[72:79], v4 abid:1
ds_read_b128 v[48:51], v6 offset:16384
ds_read_b128 v[52:55], v6 offset:17408
v_mov_b64 v[16:17], 0
s_waitcnt lgkmcnt(5)
v_smfmac_f32_16x16x64_bf16 v[24:27], v[40:43], v[64:71], v4 abid:1
ds_read_b128 v[72:75], v6 offset:2048
ds_read_b128 v[76:79], v6 offset:3072
v_mov_b64 v[18:19], 0
s_waitcnt lgkmcnt(4)
s_barrier
ds_read_b128 v[44:47], v3 offset:1536
ds_read_b128 v[36:39], v3 offset:0
ds_read_b128 v[12:15], v3 offset:512
v_smfmac_f32_16x16x64_bf16 v[28:31], v[40:43], v[56:63], v4 abid:1
ds_read_b128 v[64:67], v6 offset:6144
ds_read_b128 v[68:71], v6 offset:7168
v_mov_b64 v[32:33], 0
v_smfmac_f32_16x16x64_bf16 v[16:19], v[40:43], a[112:119], v4 abid:1
ds_read_b128 v[56:59], v6 offset:8192
ds_read_b128 v[60:63], v6 offset:9216
v_mov_b64 v[34:35], 0
s_waitcnt lgkmcnt(9)
s_nop 0
v_smfmac_f32_16x16x64_bf16 v[32:35], v[40:43], v[48:55], v4 abid:1
ds_read_b128 v[48:51], v6 offset:10240
ds_read_b128 v[52:55], v6 offset:11264
s_waitcnt lgkmcnt(8)
v_smfmac_f32_16x16x64_bf16 v[20:23], v[44:47], v[72:79], v4 abid:1
ds_read_b128 v[72:75], v6 offset:14336
ds_read_b128 v[76:79], v6 offset:15360
s_waitcnt lgkmcnt(9)
v_smfmac_f32_16x16x64_bf16 v[20:23], v[36:39], a[128:135], v4 abid:1
s_waitcnt lgkmcnt(8)
v_smfmac_f32_16x16x64_bf16 v[20:23], v[12:15], a[136:143], v4 abid:1
s_waitcnt lgkmcnt(6)
v_smfmac_f32_16x16x64_bf16 v[24:27], v[44:47], v[64:71], v4 abid:1
ds_read_b128 v[64:67], v6 offset:18432
ds_read_b128 v[68:71], v6 offset:19456
s_waitcnt lgkmcnt(6)
v_smfmac_f32_16x16x64_bf16 v[24:27], v[36:39], v[56:63], v4 abid:1
ds_read_b128 v[56:59], v6 offset:20480
ds_read_b128 v[60:63], v6 offset:21504
v_cvt_pk_bf16_f32 v20, v20, v21
v_bfi_b32 v20, 1, s44, v20
v_cvt_pk_bf16_f32 v22, v22, v23
v_bfi_b32 v22, 1, s44, v22
s_waitcnt lgkmcnt(6)
v_smfmac_f32_16x16x64_bf16 v[24:27], v[12:15], v[48:55], v4 abid:1
buffer_store_dword v20, v1, s[8:11], s50 offen
buffer_store_dword v22, v1, s[8:11], s51 offen
ds_read_b128 v[48:51], v6 offset:22528
ds_read_b128 v[52:55], v6 offset:23552
s_waitcnt lgkmcnt(6)
v_smfmac_f32_16x16x64_bf16 v[28:31], v[44:47], v[72:79], v4 abid:1
v_mov_b32 v21, 0xeeee
v_smfmac_f32_16x16x64_bf16 v[28:31], v[36:39], a[144:151], v4 abid:1
v_cvt_pk_bf16_f32 v24, v24, v25
v_bfi_b32 v24, 1, s44, v24
v_smfmac_f32_16x16x64_bf16 v[28:31], v[12:15], a[152:159], v4 abid:1
buffer_store_dword v24, v1, s[8:11], s52 offen
v_cvt_pk_bf16_f32 v26, v26, v27
v_bfi_b32 v26, 1, s44, v26
s_waitcnt lgkmcnt(4)
v_smfmac_f32_16x16x64_bf16 v[32:35], v[44:47], v[64:71], v4 abid:1
buffer_store_dword v26, v1, s[8:11], s53 offen
s_waitcnt lgkmcnt(2)
v_smfmac_f32_16x16x64_bf16 v[32:35], v[36:39], v[56:63], v4 abid:1
v_cvt_pk_bf16_f32 v28, v28, v29
v_bfi_b32 v28, 1, s44, v28
s_waitcnt lgkmcnt(0)
v_smfmac_f32_16x16x64_bf16 v[32:35], v[12:15], v[48:55], v4 abid:1
buffer_store_dword v28, v1, s[8:11], s54 offen
v_cvt_pk_bf16_f32 v30, v30, v31
v_bfi_b32 v30, 1, s44, v30
v_smfmac_f32_16x16x64_bf16 v[16:19], v[44:47], a[112:119], v21
buffer_store_dword v30, v1, s[8:11], s55 offen
v_smfmac_f32_16x16x64_bf16 v[16:19], v[36:39], a[120:127], v4 abid:1
v_cvt_pk_bf16_f32 v32, v32, v33
v_bfi_b32 v32, 1, s44, v32
v_smfmac_f32_16x16x64_bf16 v[16:19], v[12:15], a[120:127], v21
buffer_store_dword v32, v1, s[8:11], s56 offen
v_cvt_pk_bf16_f32 v34, v34, v35
v_bfi_b32 v34, 1, s44, v34
buffer_store_dword v34, v1, s[8:11], s57 offen
s_nop 3
v_cvt_pk_bf16_f32 v16, v16, v17
v_bfi_b32 v16, 1, s44, v16
buffer_store_dword v16, v1, s[8:11], s58 offen
v_mov_b32 v60, 0x3f80
v_cndmask_b32 v60, v60, 1.0, s[32:33]
v_cndmask_b32 v56, 0, v60, s[24:25]
v_cndmask_b32 v57, 0, v60, s[26:27]
v_cndmask_b32 v58, 0, v60, s[28:29]
v_cndmask_b32 v59, 0, v60, s[30:31]
v_mov_b32 v20, 0
v_mov_b32 v21, 0
v_mov_b32 v22, 0
v_mov_b32 v23, 0
v_mov_b32 v24, 0
v_mov_b32 v25, 0
v_mov_b32 v26, 0
v_mov_b32 v27, 0
v_mov_b32 v28, 0
v_mov_b32 v29, 0
v_mov_b32 v30, 0
v_mov_b32 v31, 0
v_mov_b32 v32, 0
v_mov_b32 v33, 0
v_mov_b32 v34, 0
v_mov_b32 v35, 0
v_mov_b32 v36, 0
v_mov_b32 v37, 0
v_mov_b32 v38, 0
v_mov_b32 v39, 0
v_mov_b32 v17, 0
v_mov_b32 v18, 0
v_mov_b32 v19, 0
v_mov_b32 v16, 0
s_waitcnt vmcnt(1)
buffer_load_dwordx4 v[72:75], v0, s[8:11], s64 offen offset:0 sc1
buffer_load_dwordx4 v[76:79], v0, s[8:11], s64 offen offset:1024 sc1
s_waitcnt vmcnt(1)
v_mfma_f32_16x16x32_bf16 v[60:63], v[56:59], v[72:75], 0
s_waitcnt vmcnt(0)
v_mfma_f32_16x16x32_bf16 v[60:63], v[56:59], v[76:79], v[60:63]
v_bitop3_b32 v12, v72, v73, s44 bitop3:0x7e
v_bitop3_b32 v13, v74, v75, s44 bitop3:0x7e
v_bitop3_b32 v14, v76, v77, s44 bitop3:0x7e
v_bitop3_b32 v15, v78, v79, s44 bitop3:0x7e
v_or3_b32 v12, v12, v13, v14
v_bitop3_b32 v12, v12, v15, 1 bitop3:0xa8
v_cmp_ne_u32 vcc, 0, v12
s_nop 0
v_add_f32_dpp v60, v60, v60 row_ror:4 row_mask:0xf bank_mask:0xf
v_add_f32_dpp v61, v61, v61 row_ror:4 row_mask:0xf bank_mask:0xf
s_cbranch_vccnz C_RR02
C_RT02:
v_add_f32_dpp v60, v60, v60 row_ror:8 row_mask:0xf bank_mask:0xf
v_add_f32_dpp v61, v61, v61 row_ror:8 row_mask:0xf bank_mask:0xf
s_mov_b64 exec, s[60:61]
v_cvt_pk_bf16_f32 v60, v60, v61
v_bfi_b32 v60, 1, s44, v60
buffer_store_dword v60, v2, s[8:11], 0 offen
s_mov_b64 exec, -1
s_add_u32 s43, s43, 1
s_cmp_eq_u32 s43, 63
s_cbranch_scc1 C_X2
s_waitcnt vmcnt(1)
ds_read_b128 v[64:67], v6 offset:24576
ds_read_b128 v[68:71], v6 offset:25600
ds_read_b128 v[72:75], v6 offset:26624
ds_read_b128 v[76:79], v6 offset:27648
s_barrier
s_branch C_A2
C_X2:
s_waitcnt vmcnt(0) lgkmcnt(0)
s_branch END
C_RR02:
s_mov_b64 exec, vcc
buffer_load_dwordx4 v[72:75], v0, s[8:11], s64 offen offset:0 sc1
buffer_load_dwordx4 v[76:79], v0, s[8:11], s64 offen offset:1024 sc1
s_mov_b64 exec, -1
C_RL02:
s_mov_b64 exec, vcc
buffer_load_dwordx4 v[72:75], v0, s[8:11], s64 offen offset:0 sc1
buffer_load_dwordx4 v[76:79], v0, s[8:11], s64 offen offset:1024 sc1
s_mov_b64 exec, -1
s_sub_u32 s45, s45, 1
s_cbranch_scc1 END
s_waitcnt vmcnt(2)
v_bitop3_b32 v12, v72, v73, s44 bitop3:0x7e
v_bitop3_b32 v13, v74, v75, s44 bitop3:0x7e
v_bitop3_b32 v14, v76, v77, s44 bitop3:0x7e
v_bitop3_b32 v15, v78, v79, s44 bitop3:0x7e
v_or3_b32 v12, v12, v13, v14
v_bitop3_b32 v12, v12, v15, 1 bitop3:0xa8
v_cmp_ne_u32 vcc, 0, v12
s_cbranch_vccnz C_RL02
C_RM02:
v_mfma_f32_16x16x32_bf16 v[60:63], v[56:59], v[72:75], 0
v_mfma_f32_16x16x32_bf16 v[60:63], v[56:59], v[76:79], v[60:63]
s_nop 7
v_add_f32_dpp v60, v60, v60 row_ror:4 row_mask:0xf bank_mask:0xf
v_add_f32_dpp v61, v61, v61 row_ror:4 row_mask:0xf bank_mask:0xf
s_branch C_RT02
C_OF02:
s_sub_u32 s45, s45, 1
s_cbranch_scc1 END
s_waitcnt lgkmcnt(0)
s_barrier
buffer_load_dwordx4 v0, s[8:11], s74 offen offset:0 sc1 lds
buffer_load_dwordx4 v0, s[8:11], s74 offen offset:1024 sc1 lds
s_waitcnt vmcnt(0)
s_barrier
ds_read_b128 v[60:63], v0 offset:4096
ds_read_b128 v[64:67], v0 offset:5120
s_waitcnt lgkmcnt(0)
v_bitop3_b32 v7, v60, v64, s44 bitop3:0x7e
v_and_b32 v7, 1, v7
v_cmp_eq_u32 vcc, s59, v7
s_cbranch_vccnz C_OF02
s_branch C_OK02
C_OF12:
s_sub_u32 s45, s45, 1
s_cbranch_scc1 END
s_waitcnt lgkmcnt(0)
s_barrier
s_barrier
ds_read_b128 v[68:71], v0 offset:6144
ds_read_b128 v[72:75], v0 offset:7168
ds_read_b128 v[76:79], v0 offset:8192
s_waitcnt lgkmcnt(0)
v_bitop3_b32 v13, v68, v72, s44 bitop3:0x7e
v_bitop3_b32 v13, v76, v13, s44 bitop3:0xde
v_and_b32 v13, 1, v13
v_cmp_eq_u32 vcc, s59, v13
s_cbranch_vccnz C_OF12
s_branch C_OK12
s_nop 2
C_FB2:
ds_read_b128 v[28:31], v0 offset:13312
ds_read_b128 v[24:27], v0 offset:11264
ds_read_b128 v[16:19], v0 offset:12288
ds_read_b128 v[40:43], v0 offset:9216
ds_read_b128 v[44:47], v0 offset:10240
v_mov_b32 v20, 0x3f003f00
v_mov_b32 v21, 0x3f003f00
s_waitcnt lgkmcnt(0)
v_pk_add_f32 v[28:29], v[28:29], v[30:31]
v_add_f32 v28, v28, v29
v_mul_f32 v28, s72, v28
v_mul_f32 v24, s72, v24
v_mul_f32 v25, s72, v25
v_mul_f32 v26, s72, v26
v_mul_f32 v27, s72, v27
v_pk_fma_f32 v[24:25], v[16:17], s[72:73], v[24:25]
v_pk_fma_f32 v[26:27], v[18:19], s[72:73], v[26:27]
v_pk_fma_f32 v[24:25], v[40:41], s[72:73], v[24:25]
v_pk_fma_f32 v[26:27], v[42:43], s[72:73], v[26:27]
v_pk_fma_f32 v[24:25], v[44:45], s[72:73], v[24:25]
v_pk_fma_f32 v[26:27], v[46:47], s[72:73], v[26:27]
v_max3_f32 v36, v24, v25, v26
v_max3_f32 v36, v36, v27, v28
s_nop 1
v_max_f32_dpp v36, v36, v36 quad_perm:[2,3,0,1] row_mask:0xf bank_mask:0xf
v_mov_b32 v37, v36
s_nop 1
v_permlane16_swap_b32 v36, v37
v_max_f32 v36, v36, v37
v_mov_b32 v37, v36
s_nop 1
v_permlane32_swap_b32 v36, v37
v_max_f32 v36, v36, v37
v_sub_f32 v24, v24, v36
v_sub_f32 v25, v25, v36
v_sub_f32 v26, v26, v36
v_sub_f32 v27, v27, v36
v_sub_f32 v28, v28, v36
v_exp_f32 v29, v28
s_nop 0
v_cvt_pk_bf16_f32 v30, v29, v29
s_nop 1
v_mov_b32_dpp v31, v30 quad_perm:[2,3,0,1] row_mask:0xf bank_mask:0xf
v_exp_f32 v24, v24
s_nop 0
v_mfma_f32_16x16x16_bf16 v[40:43], v[32:33], v[30:31], 0
v_exp_f32 v25, v25
v_mfma_f32_16x16x16_bf16 v[44:47], v[34:35], v[30:31], 0
v_exp_f32 v26, v26
v_mfma_f32_16x16x16_bf16 v[36:39], v[20:21], v[30:31], 0
v_exp_f32 v27, v27
v_cvt_pk_bf16_f32 v16, v24, v25
v_cvt_pk_bf16_f32 v17, v26, v27
v_mov_b64 v[22:23], 0
v_mov_b32_dpp v18, v16 quad_perm:[2,3,0,1] row_mask:0xf bank_mask:0xf
v_mov_b32_dpp v19, v17 quad_perm:[2,3,0,1] row_mask:0xf bank_mask:0xf
v_mov_b64 v[24:25], 0
v_mov_b64 v[26:27], 0
v_mfma_f32_16x16x32_bf16 v[36:39], v[12:15], v[16:19], v[36:39]
v_mov_b32 v20, 0
v_mov_b32 v21, 0
v_mfma_f32_16x16x32_bf16 v[40:43], v[48:51], v[16:19], v[40:43]
v_mov_b32 v28, 0
v_mov_b32 v29, 0
v_mfma_f32_16x16x32_bf16 v[44:47], v[52:55], v[16:19], v[44:47]
v_rcp_f32 v38, v36
s_nop 2
v_pk_mul_f32 v[40:41], v[40:41], v[38:39] op_sel_hi:[1,0]
v_pk_mul_f32 v[42:43], v[42:43], v[38:39] op_sel_hi:[1,0]
v_cvt_pk_bf16_f32 v40, v40, v41
v_cvt_pk_bf16_f32 v41, v42, v43
v_pk_mul_f32 v[44:45], v[44:45], v[38:39] op_sel_hi:[1,0]
v_pk_mul_f32 v[46:47], v[46:47], v[38:39] op_sel_hi:[1,0]
s_mov_b64 exec, s[62:63]
v_cvt_pk_bf16_f32 v42, v44, v45
v_cvt_pk_bf16_f32 v43, v46, v47
ds_write_b128 v3, v[40:43] offset:1024
s_mov_b64 exec, -1
v_mov_b32_dpp v40, v40 quad_perm:[2,3,2,3] row_mask:0xf bank_mask:0xf
v_mov_b32_dpp v41, v41 quad_perm:[2,3,2,3] row_mask:0xf bank_mask:0xf
v_mov_b32_dpp v42, v42 quad_perm:[2,3,2,3] row_mask:0xf bank_mask:0xf
v_mov_b32_dpp v43, v43 quad_perm:[2,3,2,3] row_mask:0xf bank_mask:0xf
s_waitcnt lgkmcnt(0)
s_nop 1
s_branch C_FBOK2
C_RA3:
s_sub_u32 s45, s45, 1
s_cbranch_scc1 END
s_waitcnt vmcnt(0) lgkmcnt(0)
s_barrier
C_ENTRY3:
s_nop 7
v_mov_b32 v16, 0
v_mov_b32 v17, 0
v_mov_b32 v18, 0
v_mov_b32 v19, 0
v_mov_b32 v20, 0
v_mov_b32 v21, 0
v_mov_b32 v22, 0
v_mov_b32 v23, 0
v_mov_b32 v24, 0
v_mov_b32 v25, 0
v_mov_b32 v26, 0
v_mov_b32 v27, 0
v_mov_b32 v28, 0
v_mov_b32 v29, 0
v_mov_b32 v30, 0
v_mov_b32 v31, 0
v_mov_b32 v32, 0
v_mov_b32 v33, 0
v_mov_b32 v34, 0
v_mov_b32 v35, 0
v_mov_b32 v36, 0
v_mov_b32 v37, 0
v_mov_b32 v38, 0
v_mov_b32 v39, 0
ds_read_b128 v[64:67], v6 offset:24576
ds_read_b128 v[68:71], v6 offset:25600
ds_read_b128 v[72:75], v6 offset:26624
ds_read_b128 v[76:79], v6 offset:27648
s_waitcnt vmcnt(0)
C_A3:
s_barrier
ds_read_b128 v[56:59], v0 offset:0
ds_read_b128 v[60:63], v0 offset:1024
s_waitcnt lgkmcnt(1)
v_smfmac_f32_16x16x64_bf16 v[16:19], v[56:59], v[80:87], v4
v_smfmac_f32_16x16x64_bf16 v[20:23], v[56:59], v[224:231], v4
v_smfmac_f32_16x16x64_bf16 v[24:27], v[56:59], v[88:95], v4
buffer_load_dwordx4 v[40:43], v0, s[8:11], s67 offen offset:0
v_smfmac_f32_16x16x64_bf16 v[28:31], v[56:59], v[232:239], v4
buffer_load_dwordx4 v[44:47], v0, s[8:11], s67 offen offset:1024
v_mov_b32 v5, s43
v_smfmac_f32_16x16x64_bf16 v[32:35], v[56:59], v[64:71], v4
ds_read_b128 v[64:67], v6 offset:28672
ds_read_b128 v[68:71], v6 offset:29696
v_smfmac_f32_16x16x64_bf16 v[36:39], v[56:59], v[72:79], v4
buffer_load_dwordx4 v0, s[8:11], s74 offen offset:0 sc1 lds
buffer_load_dwordx4 v0, s[8:11], s74 offen offset:1024 sc1 lds
ds_read_b128 v[72:75], v6 offset:30720
ds_read_b128 v[76:79], v6 offset:31744
s_waitcnt lgkmcnt(4)
v_smfmac_f32_16x16x64_bf16 v[16:19], v[60:63], v[96:103], v4
s_barrier
ds_read_b128 v[12:15], v0 offset:2048
v_smfmac_f32_16x16x64_bf16 v[20:23], v[60:63], v[240:247], v4
ds_read_b128 v[56:59], v0 offset:3072
v_smfmac_f32_16x16x64_bf16 v[24:27], v[60:63], v[104:111], v4
buffer_load_dwordx4 v[48:51], v0, s[8:11], s67 offen offset:2048
v_smfmac_f32_16x16x64_bf16 v[28:31], v[60:63], v[248:255], v4
buffer_load_dwordx4 v[52:55], v0, s[8:11], s67 offen offset:3072
s_waitcnt lgkmcnt(4)
v_smfmac_f32_16x16x64_bf16 v[32:35], v[60:63], v[64:71], v4
ds_read_b128 v[64:67], v6 offset:32768
ds_read_b128 v[68:71], v6 offset:33792
s_waitcnt lgkmcnt(4)
v_smfmac_f32_16x16x64_bf16 v[36:39], v[60:63], v[72:79], v4
ds_read_b128 v[72:75], v6 offset:34816
ds_read_b128 v[76:79], v6 offset:35840
s_waitcnt lgkmcnt(5)
v_smfmac_f32_16x16x64_bf16 v[16:19], v[12:15], v[112:119], v4
s_waitcnt lgkmcnt(4)
v_bitop3_b32 v7, v12, v56, s44 bitop3:0x7e
v_smfmac_f32_16x16x64_bf16 v[20:23], v[12:15], a[0:7], v4
v_and_b32 v7, 1, v7
s_waitcnt lgkmcnt(2)
v_smfmac_f32_16x16x64_bf16 v[32:35], v[12:15], v[64:71], v4
s_barrier
ds_read_b128 v[60:63], v0 offset:4096
ds_read_b128 v[64:67], v0 offset:5120
v_cmp_eq_u32 vcc, s59, v7
s_waitcnt lgkmcnt(2)
v_smfmac_f32_16x16x64_bf16 v[36:39], v[12:15], v[72:79], v4
v_smfmac_f32_16x16x64_bf16 v[24:27], v[12:15], v[120:127], v4
s_cbranch_vccnz C_RA3
v_smfmac_f32_16x16x64_bf16 v[28:31], v[12:15], a[8:15], v4
v_smfmac_f32_16x16x64_bf16 v[16:19], v[56:59], v[128:135], v4
s_waitcnt lgkmcnt(0)
v_bitop3_b32 v7, v60, v64, s44 bitop3:0x7e
v_smfmac_f32_16x16x64_bf16 v[20:23], v[56:59], a[16:23], v4
v_and_b32 v7, 1, v7
v_smfmac_f32_16x16x64_bf16 v[24:27], v[56:59], v[136:143], v4
v_cmp_eq_u32 vcc, s59, v7
v_smfmac_f32_16x16x64_bf16 v[28:31], v[56:59], a[24:31], v4
s_cbranch_vccnz C_OF03
C_OK03:
s_waitcnt vmcnt(2)
s_barrier
ds_read_b128 v[68:71], v0 offset:6144
v_smfmac_f32_16x16x64_bf16 v[16:19], v[60:63], v[144:151], v4
ds_read_b128 v[72:75], v0 offset:7168
ds_read_b128 v[76:79], v0 offset:8192
v_smfmac_f32_16x16x64_bf16 v[20:23], v[60:63], a[32:39], v4
v_smfmac_f32_16x16x64_bf16 v[24:27], v[60:63], v[152:159], v4
v_smfmac_f32_16x16x64_bf16 v[28:31], v[60:63], a[40:47], v4
s_waitcnt lgkmcnt(1)
v_bitop3_b32 v13, v68, v72, s44 bitop3:0x7e
v_smfmac_f32_16x16x64_bf16 v[16:19], v[64:67], v[160:167], v4
s_waitcnt lgkmcnt(0)
v_bitop3_b32 v13, v76, v13, s44 bitop3:0xde
v_smfmac_f32_16x16x64_bf16 v[20:23], v[64:67], a[48:55], v4
v_and_b32 v13, 1, v13
v_smfmac_f32_16x16x64_bf16 v[24:27], v[64:67], v[168:175], v4
v_cmp_eq_u32 vcc, s59, v13
v_smfmac_f32_16x16x64_bf16 v[28:31], v[64:67], a[56:63], v4
s_cbranch_vccnz C_OF13
C_OK13:
v_add_u32 v12, s48, v0
v_smfmac_f32_16x16x64_bf16 v[16:19], v[68:71], v[176:183], v4
ds_read_b128 v[12:15], v12
v_smfmac_f32_16x16x64_bf16 v[20:23], v[68:71], a[64:71], v4
s_add_u32 s67, s67, 524288
s_mov_b32 s74, s66
v_smfmac_f32_16x16x64_bf16 v[16:19], v[72:75], v[192:199], v4
buffer_store_dword v5, off, s[36:39], s49 sc1
v_smfmac_f32_16x16x64_bf16 v[20:23], v[72:75], a[80:87], v4
v_smfmac_f32_16x16x64_bf16 v[16:19], v[76:79], v[208:215], v4
s_waitcnt lgkmcnt(0)
buffer_store_dwordx4 v[12:15], v0, s[36:39], s68 offen sc1
v_smfmac_f32_16x16x64_bf16 v[20:23], v[76:79], a[96:103], v4
s_xor_b32 s44, s44, -1
s_mov_b32 s59, 1
v_smfmac_f32_16x16x64_bf16 v[24:27], v[68:71], v[184:191], v4
s_add_u32 s68, s68, 16384
v_cvt_pk_bf16_f32 v16, v16, v17
v_smfmac_f32_16x16x64_bf16 v[24:27], v[72:75], v[200:207], v4
v_cvt_pk_bf16_f32 v17, v18, v19
v_smfmac_f32_16x16x64_bf16 v[24:27], v[76:79], v[216:223], v4
v_cvt_pk_bf16_f32 v18, v20, v21
v_smfmac_f32_16x16x64_bf16 v[28:31], v[68:71], a[72:79], v4
v_cvt_pk_bf16_f32 v19, v22, v23
v_smfmac_f32_16x16x64_bf16 v[28:31], v[72:75], a[88:95], v4
v_cvt_pk_bf16_f32 v24, v24, v25
v_smfmac_f32_16x16x64_bf16 v[28:31], v[76:79], a[104:111], v4
v_cvt_pk_bf16_f32 v25, v26, v27
v_mfma_f32_16x16x32_bf16 v[20:23], v[16:19], v[8:11], 0
s_nop 3
v_cvt_pk_bf16_f32 v26, v28, v29
v_cvt_pk_bf16_f32 v27, v30, v31
s_nop 1
v_mfma_f32_16x16x32_bf16 v[28:31], v[24:27], v[8:11], 0
v_cvt_pk_bf16_f32 v16, v20, v21
v_cvt_pk_bf16_f32 v17, v22, v23
v_smfmac_f32_16x16x64_bf16 v[32:35], v[72:75], a[224:231], v4
s_mov_b64 vcc, s[62:63]
s_nop 2
v_cvt_pk_bf16_f32 v18, v28, v29
v_cvt_pk_bf16_f32 v19, v30, v31
s_nop 1
v_mfma_f32_16x16x32_bf16 v[24:27], v[44:47], v[16:19], 0
v_mfma_f32_16x16x32_bf16 v[20:23], v[40:43], v[16:19], 0
v_mfma_f32_16x16x32_bf16 v[28:31], v[16:19], v[16:19], 0
s_nop 3
v_cndmask_b32_dpp v20, v24, v20, vcc quad_perm:[2,3,2,3] row_mask:0xf bank_mask:0xf
v_cndmask_b32_dpp v21, v25, v21, vcc quad_perm:[2,3,2,3] row_mask:0xf bank_mask:0xf
v_cndmask_b32_dpp v22, v26, v22, vcc quad_perm:[2,3,2,3] row_mask:0xf bank_mask:0xf
v_cndmask_b32_dpp v23, v27, v23, vcc quad_perm:[2,3,2,3] row_mask:0xf bank_mask:0xf
v_smfmac_f32_16x16x64_bf16 v[36:39], v[72:75], a[232:239], v4
ds_write_b128 v0, v[20:23] offset:12288
v_cndmask_b32_dpp v28, v29, v28, vcc quad_perm:[2,3,2,3] row_mask:0xf bank_mask:0xf
v_smfmac_f32_16x16x64_bf16 v[32:35], v[76:79], a[240:247], v4
ds_write_b32 v0, v28 offset:13324
v_mul_f32 v24, s72, v20
v_smfmac_f32_16x16x64_bf16 v[36:39], v[76:79], a[248:255], v4
v_mul_f32 v25, s72, v21
v_smfmac_f32_16x16x64_bf16 v[32:35], v[64:67], a[192:199], v4
v_mul_f32 v26, s72, v22
v_smfmac_f32_16x16x64_bf16 v[36:39], v[64:67], a[200:207], v4
v_mul_f32 v27, s72, v23
v_smfmac_f32_16x16x64_bf16 v[32:35], v[68:71], a[208:215], v4
v_mov_b32 v12, 0x3f803f80
v_smfmac_f32_16x16x64_bf16 v[36:39], v[68:71], a[216:223], v4
s_waitcnt lgkmcnt(0)
s_barrier
ds_read_b128 v[28:31], v0 offset:13312
ds_read_b128 v[16:19], v0 offset:11264
v_smfmac_f32_16x16x64_bf16 v[32:35], v[56:59], a[160:167], v4
ds_read_b128 v[40:43], v0 offset:10240
ds_read_b128 v[44:47], v0 offset:9216
v_mov_b32 v13, 0x3f803f80
v_smfmac_f32_16x16x64_bf16 v[36:39], v[56:59], a[168:175], v4
ds_read_b128 v[72:75], v6 offset:0
ds_read_b128 v[76:79], v6 offset:1024
v_mov_b32 v14, 0x3f803f80
v_smfmac_f32_16x16x64_bf16 v[32:35], v[60:63], a[176:183], v4
ds_read_b128 v[64:67], v6 offset:4096
ds_read_b128 v[68:71], v6 offset:5120
v_mov_b32 v15, 0x3f803f80
v_smfmac_f32_16x16x64_bf16 v[36:39], v[60:63], a[184:191], v4
v_mov_b32 v20, 0x3f003f00
v_mov_b32 v21, 0x3f003f00
s_waitcnt lgkmcnt(7)
v_pk_add_f32 v[28:29], v[28:29], v[30:31]
v_add_f32 v28, v28, v29
v_mul_f32 v28, s72, v28
s_waitcnt lgkmcnt(6)
v_pk_fma_f32 v[24:25], v[16:17], s[72:73], v[24:25]
v_exp_f32 v29, v28
v_pk_fma_f32 v[26:27], v[18:19], s[72:73], v[26:27]
s_waitcnt lgkmcnt(5)
v_pk_fma_f32 v[24:25], v[40:41], s[72:73], v[24:25]
v_cvt_pk_bf16_f32 v30, v29, v29
v_pk_fma_f32 v[26:27], v[42:43], s[72:73], v[26:27]
s_waitcnt lgkmcnt(4)
v_pk_fma_f32 v[24:25], v[44:45], s[72:73], v[24:25]
v_mov_b32_dpp v31, v30 quad_perm:[2,3,0,1] row_mask:0xf bank_mask:0xf
v_pk_fma_f32 v[26:27], v[46:47], s[72:73], v[26:27]
v_cvt_pk_bf16_f32 v32, v32, v33
v_cvt_pk_bf16_f32 v33, v34, v35
v_cvt_pk_bf16_f32 v34, v36, v37
v_cvt_pk_bf16_f32 v35, v38, v39
v_exp_f32 v24, v24
v_mfma_f32_16x16x16_bf16 v[40:43], v[32:33], v[30:31], 0
ds_read_b128 v[56:59], v6 offset:12288
ds_read_b128 v[60:63], v6 offset:13312
v_exp_f32 v25, v25
v_mfma_f32_16x16x16_bf16 v[44:47], v[34:35], v[30:31], 0
s_waitcnt vmcnt(2)
v_exp_f32 v26, v26
v_mfma_f32_16x16x16_bf16 v[36:39], v[20:21], v[30:31], 0
v_exp_f32 v27, v27
v_cvt_pk_bf16_f32 v16, v24, v25
v_cvt_pk_bf16_f32 v17, v26, v27
v_mov_b64 v[22:23], 0
v_mov_b32_dpp v18, v16 quad_perm:[2,3,0,1] row_mask:0xf bank_mask:0xf
v_mov_b32_dpp v19, v17 quad_perm:[2,3,0,1] row_mask:0xf bank_mask:0xf
v_mov_b64 v[24:25], 0
v_mov_b64 v[26:27], 0
v_mfma_f32_16x16x32_bf16 v[36:39], v[12:15], v[16:19], v[36:39]
v_mov_b32 v20, 0
v_mov_b32 v21, 0
v_mfma_f32_16x16x32_bf16 v[40:43], v[48:51], v[16:19], v[40:43]
v_mov_b32 v28, 0
v_mov_b32 v29, 0
v_mfma_f32_16x16x32_bf16 v[44:47], v[52:55], v[16:19], v[44:47]
v_rcp_f32 v38, v36
s_nop 2
v_pk_mul_f32 v[40:41], v[40:41], v[38:39] op_sel_hi:[1,0]
v_pk_mul_f32 v[42:43], v[42:43], v[38:39] op_sel_hi:[1,0]
v_cvt_pk_bf16_f32 v40, v40, v41
v_cvt_pk_bf16_f32 v41, v42, v43
v_pk_mul_f32 v[44:45], v[44:45], v[38:39] op_sel_hi:[1,0]
v_pk_mul_f32 v[46:47], v[46:47], v[38:39] op_sel_hi:[1,0]
s_mov_b64 exec, s[62:63]
v_cvt_pk_bf16_f32 v42, v44, v45
v_cvt_pk_bf16_f32 v43, v46, v47
ds_write_b128 v3, v[40:43] offset:1536
s_mov_b64 exec, -1
v_max_f32 v36, v36, v38
v_cmp_nge_f32 vcc, s47, v36
v_mov_b32_dpp v40, v40 quad_perm:[2,3,2,3] row_mask:0xf bank_mask:0xf
v_mov_b32_dpp v41, v41 quad_perm:[2,3,2,3] row_mask:0xf bank_mask:0xf
v_mov_b32_dpp v42, v42 quad_perm:[2,3,2,3] row_mask:0xf bank_mask:0xf
v_mov_b32_dpp v43, v43 quad_perm:[2,3,2,3] row_mask:0xf bank_mask:0xf
s_cbranch_vccnz C_FB3
C_FBOK3:
v_mov_b64 v[30:31], 0
s_waitcnt lgkmcnt(5)
v_smfmac_f32_16x16x64_bf16 v[20:23], v[40:43], v[72:79], v4 abid:1
ds_read_b128 v[48:51], v6 offset:16384
ds_read_b128 v[52:55], v6 offset:17408
v_mov_b64 v[16:17], 0
s_waitcnt lgkmcnt(5)
v_smfmac_f32_16x16x64_bf16 v[24:27], v[40:43], v[64:71], v4 abid:1
ds_read_b128 v[72:75], v6 offset:2048
ds_read_b128 v[76:79], v6 offset:3072
v_mov_b64 v[18:19], 0
s_waitcnt lgkmcnt(4)
s_barrier
ds_read_b128 v[44:47], v3 offset:1024
ds_read_b128 v[36:39], v3 offset:512
ds_read_b128 v[12:15], v3 offset:0
v_smfmac_f32_16x16x64_bf16 v[28:31], v[40:43], v[56:63], v4 abid:1
ds_read_b128 v[64:67], v6 offset:6144
ds_read_b128 v[68:71], v6 offset:7168
v_mov_b64 v[32:33], 0
v_smfmac_f32_16x16x64_bf16 v[16:19], v[40:43], a[112:119], v4 abid:1
ds_read_b128 v[56:59], v6 offset:8192
ds_read_b128 v[60:63], v6 offset:9216
v_mov_b64 v[34:35], 0
s_waitcnt lgkmcnt(9)
s_nop 0
v_smfmac_f32_16x16x64_bf16 v[32:35], v[40:43], v[48:55], v4 abid:1
ds_read_b128 v[48:51], v6 offset:10240
ds_read_b128 v[52:55], v6 offset:11264
s_waitcnt lgkmcnt(8)
v_smfmac_f32_16x16x64_bf16 v[20:23], v[44:47], v[72:79], v4 abid:1
ds_read_b128 v[72:75], v6 offset:14336
ds_read_b128 v[76:79], v6 offset:15360
s_waitcnt lgkmcnt(9)
v_smfmac_f32_16x16x64_bf16 v[20:23], v[36:39], a[128:135], v4 abid:1
s_waitcnt lgkmcnt(8)
v_smfmac_f32_16x16x64_bf16 v[20:23], v[12:15], a[136:143], v4 abid:1
s_waitcnt lgkmcnt(6)
v_smfmac_f32_16x16x64_bf16 v[24:27], v[44:47], v[64:71], v4 abid:1
ds_read_b128 v[64:67], v6 offset:18432
ds_read_b128 v[68:71], v6 offset:19456
s_waitcnt lgkmcnt(6)
v_smfmac_f32_16x16x64_bf16 v[24:27], v[36:39], v[56:63], v4 abid:1
ds_read_b128 v[56:59], v6 offset:20480
ds_read_b128 v[60:63], v6 offset:21504
v_cvt_pk_bf16_f32 v20, v20, v21
v_bfi_b32 v20, 1, s44, v20
v_cvt_pk_bf16_f32 v22, v22, v23
v_bfi_b32 v22, 1, s44, v22
s_waitcnt lgkmcnt(6)
v_smfmac_f32_16x16x64_bf16 v[24:27], v[12:15], v[48:55], v4 abid:1
buffer_store_dword v20, v1, s[8:11], s50 offen
buffer_store_dword v22, v1, s[8:11], s51 offen
ds_read_b128 v[48:51], v6 offset:22528
ds_read_b128 v[52:55], v6 offset:23552
s_waitcnt lgkmcnt(6)
v_smfmac_f32_16x16x64_bf16 v[28:31], v[44:47], v[72:79], v4 abid:1
v_mov_b32 v21, 0xeeee
v_smfmac_f32_16x16x64_bf16 v[28:31], v[36:39], a[144:151], v4 abid:1
v_cvt_pk_bf16_f32 v24, v24, v25
v_bfi_b32 v24, 1, s44, v24
v_smfmac_f32_16x16x64_bf16 v[28:31], v[12:15], a[152:159], v4 abid:1
buffer_store_dword v24, v1, s[8:11], s52 offen
v_cvt_pk_bf16_f32 v26, v26, v27
v_bfi_b32 v26, 1, s44, v26
s_waitcnt lgkmcnt(4)
v_smfmac_f32_16x16x64_bf16 v[32:35], v[44:47], v[64:71], v4 abid:1
buffer_store_dword v26, v1, s[8:11], s53 offen
s_waitcnt lgkmcnt(2)
v_smfmac_f32_16x16x64_bf16 v[32:35], v[36:39], v[56:63], v4 abid:1
v_cvt_pk_bf16_f32 v28, v28, v29
v_bfi_b32 v28, 1, s44, v28
s_waitcnt lgkmcnt(0)
v_smfmac_f32_16x16x64_bf16 v[32:35], v[12:15], v[48:55], v4 abid:1
buffer_store_dword v28, v1, s[8:11], s54 offen
v_cvt_pk_bf16_f32 v30, v30, v31
v_bfi_b32 v30, 1, s44, v30
v_smfmac_f32_16x16x64_bf16 v[16:19], v[44:47], a[112:119], v21
buffer_store_dword v30, v1, s[8:11], s55 offen
v_smfmac_f32_16x16x64_bf16 v[16:19], v[36:39], a[120:127], v4 abid:1
v_cvt_pk_bf16_f32 v32, v32, v33
v_bfi_b32 v32, 1, s44, v32
v_smfmac_f32_16x16x64_bf16 v[16:19], v[12:15], a[120:127], v21
buffer_store_dword v32, v1, s[8:11], s56 offen
v_cvt_pk_bf16_f32 v34, v34, v35
v_bfi_b32 v34, 1, s44, v34
buffer_store_dword v34, v1, s[8:11], s57 offen
s_nop 3
v_cvt_pk_bf16_f32 v16, v16, v17
v_bfi_b32 v16, 1, s44, v16
buffer_store_dword v16, v1, s[8:11], s58 offen
v_mov_b32 v60, 0x3f80
v_cndmask_b32 v60, v60, 1.0, s[32:33]
v_cndmask_b32 v56, 0, v60, s[24:25]
v_cndmask_b32 v57, 0, v60, s[26:27]
v_cndmask_b32 v58, 0, v60, s[28:29]
v_cndmask_b32 v59, 0, v60, s[30:31]
v_mov_b32 v20, 0
v_mov_b32 v21, 0
v_mov_b32 v22, 0
v_mov_b32 v23, 0
v_mov_b32 v24, 0
v_mov_b32 v25, 0
v_mov_b32 v26, 0
v_mov_b32 v27, 0
v_mov_b32 v28, 0
v_mov_b32 v29, 0
v_mov_b32 v30, 0
v_mov_b32 v31, 0
v_mov_b32 v32, 0
v_mov_b32 v33, 0
v_mov_b32 v34, 0
v_mov_b32 v35, 0
v_mov_b32 v36, 0
v_mov_b32 v37, 0
v_mov_b32 v38, 0
v_mov_b32 v39, 0
v_mov_b32 v17, 0
v_mov_b32 v18, 0
v_mov_b32 v19, 0
v_mov_b32 v16, 0
s_waitcnt vmcnt(0)
buffer_load_dwordx4 v[72:75], v0, s[8:11], s64 offen offset:0 sc1
buffer_load_dwordx4 v[76:79], v0, s[8:11], s64 offen offset:1024 sc1
s_waitcnt vmcnt(1)
v_mfma_f32_16x16x32_bf16 v[60:63], v[56:59], v[72:75], 0
s_waitcnt vmcnt(0)
v_mfma_f32_16x16x32_bf16 v[60:63], v[56:59], v[76:79], v[60:63]
v_bitop3_b32 v12, v72, v73, s44 bitop3:0x7e
v_bitop3_b32 v13, v74, v75, s44 bitop3:0x7e
v_bitop3_b32 v14, v76, v77, s44 bitop3:0x7e
v_bitop3_b32 v15, v78, v79, s44 bitop3:0x7e
v_or3_b32 v12, v12, v13, v14
v_bitop3_b32 v12, v12, v15, 1 bitop3:0xa8
v_cmp_ne_u32 vcc, 0, v12
s_nop 0
v_add_f32_dpp v60, v60, v60 row_ror:4 row_mask:0xf bank_mask:0xf
v_add_f32_dpp v61, v61, v61 row_ror:4 row_mask:0xf bank_mask:0xf
s_cbranch_vccnz C_RR03
C_RT03:
v_add_f32_dpp v60, v60, v60 row_ror:8 row_mask:0xf bank_mask:0xf
v_add_f32_dpp v61, v61, v61 row_ror:8 row_mask:0xf bank_mask:0xf
s_mov_b64 exec, s[60:61]
v_cvt_pk_bf16_f32 v60, v60, v61
v_bfi_b32 v60, 1, s44, v60
buffer_store_dword v60, v2, s[8:11], 0 offen
s_mov_b64 exec, -1
s_add_u32 s43, s43, 1
s_cmp_eq_u32 s43, 63
s_cbranch_scc1 C_X3
s_waitcnt vmcnt(1)
ds_read_b128 v[64:67], v6 offset:24576
ds_read_b128 v[68:71], v6 offset:25600
ds_read_b128 v[72:75], v6 offset:26624
ds_read_b128 v[76:79], v6 offset:27648
s_barrier
s_branch C_A3
C_X3:
s_waitcnt vmcnt(0) lgkmcnt(0)
s_cmp_lt_u32 s41, 9
s_cbranch_scc0 END
v_mov_b32 v7, s43
s_add_u32 s3, s48, 114688
buffer_store_dword v7, off, s[8:11], s49 sc1
C_FL3:
s_sub_u32 s45, s45, 1
s_cbranch_scc1 END
buffer_load_dwordx4 v[64:67], v0, s[8:11], s3 offen sc1
s_waitcnt vmcnt(0)
v_bitop3_b32 v40, v64, v65, s44 bitop3:0x7e
v_bitop3_b32 v41, v66, v67, s44 bitop3:0x7e
v_bitop3_b32 v40, v40, v41, 1 bitop3:0xa8
v_cmp_ne_u32 vcc, 0, v40
s_cbranch_vccnz C_FL3
buffer_store_dwordx4 v[64:67], v0, s[8:11], s68 offen sc1
v_mov_b32 v36, 64
s_waitcnt vmcnt(0)
buffer_store_dword v36, off, s[8:11], s49 sc1
s_branch END
C_RR03:
s_mov_b64 exec, vcc
buffer_load_dwordx4 v[72:75], v0, s[8:11], s64 offen offset:0 sc1
buffer_load_dwordx4 v[76:79], v0, s[8:11], s64 offen offset:1024 sc1
s_mov_b64 exec, -1
C_RL03:
s_mov_b64 exec, vcc
buffer_load_dwordx4 v[72:75], v0, s[8:11], s64 offen offset:0 sc1
buffer_load_dwordx4 v[76:79], v0, s[8:11], s64 offen offset:1024 sc1
s_mov_b64 exec, -1
s_sub_u32 s45, s45, 1
s_cbranch_scc1 END
s_waitcnt vmcnt(2)
v_bitop3_b32 v12, v72, v73, s44 bitop3:0x7e
v_bitop3_b32 v13, v74, v75, s44 bitop3:0x7e
v_bitop3_b32 v14, v76, v77, s44 bitop3:0x7e
v_bitop3_b32 v15, v78, v79, s44 bitop3:0x7e
v_or3_b32 v12, v12, v13, v14
v_bitop3_b32 v12, v12, v15, 1 bitop3:0xa8
v_cmp_ne_u32 vcc, 0, v12
s_cbranch_vccnz C_RL03
C_RM03:
v_mfma_f32_16x16x32_bf16 v[60:63], v[56:59], v[72:75], 0
v_mfma_f32_16x16x32_bf16 v[60:63], v[56:59], v[76:79], v[60:63]
s_nop 7
v_add_f32_dpp v60, v60, v60 row_ror:4 row_mask:0xf bank_mask:0xf
v_add_f32_dpp v61, v61, v61 row_ror:4 row_mask:0xf bank_mask:0xf
s_branch C_RT03
C_OF03:
s_sub_u32 s45, s45, 1
s_cbranch_scc1 END
s_waitcnt lgkmcnt(0)
s_barrier
s_barrier
ds_read_b128 v[60:63], v0 offset:4096
ds_read_b128 v[64:67], v0 offset:5120
s_waitcnt lgkmcnt(0)
v_bitop3_b32 v7, v60, v64, s44 bitop3:0x7e
v_and_b32 v7, 1, v7
v_cmp_eq_u32 vcc, s59, v7
s_cbranch_vccnz C_OF03
s_branch C_OK03
C_OF13:
s_sub_u32 s45, s45, 1
s_cbranch_scc1 END
s_waitcnt lgkmcnt(0)
s_barrier
buffer_load_dwordx4 v0, s[8:11], s74 offen offset:0 sc1 lds
buffer_load_dwordx4 v0, s[8:11], s74 offen offset:1024 sc1 lds
s_waitcnt vmcnt(0)
s_barrier
ds_read_b128 v[68:71], v0 offset:6144
ds_read_b128 v[72:75], v0 offset:7168
ds_read_b128 v[76:79], v0 offset:8192
s_waitcnt lgkmcnt(0)
v_bitop3_b32 v13, v68, v72, s44 bitop3:0x7e
v_bitop3_b32 v13, v76, v13, s44 bitop3:0xde
v_and_b32 v13, 1, v13
v_cmp_eq_u32 vcc, s59, v13
s_cbranch_vccnz C_OF13
s_branch C_OK13
s_nop 2
C_FB3:
ds_read_b128 v[28:31], v0 offset:13312
ds_read_b128 v[24:27], v0 offset:12288
ds_read_b128 v[16:19], v0 offset:11264
ds_read_b128 v[40:43], v0 offset:10240
ds_read_b128 v[44:47], v0 offset:9216
v_mov_b32 v20, 0x3f003f00
v_mov_b32 v21, 0x3f003f00
s_waitcnt lgkmcnt(0)
v_pk_add_f32 v[28:29], v[28:29], v[30:31]
v_add_f32 v28, v28, v29
v_mul_f32 v28, s72, v28
v_mul_f32 v24, s72, v24
v_mul_f32 v25, s72, v25
v_mul_f32 v26, s72, v26
v_mul_f32 v27, s72, v27
v_pk_fma_f32 v[24:25], v[16:17], s[72:73], v[24:25]
v_pk_fma_f32 v[26:27], v[18:19], s[72:73], v[26:27]
v_pk_fma_f32 v[24:25], v[40:41], s[72:73], v[24:25]
v_pk_fma_f32 v[26:27], v[42:43], s[72:73], v[26:27]
v_pk_fma_f32 v[24:25], v[44:45], s[72:73], v[24:25]
v_pk_fma_f32 v[26:27], v[46:47], s[72:73], v[26:27]
v_max3_f32 v36, v24, v25, v26
v_max3_f32 v36, v36, v27, v28
s_nop 1
v_max_f32_dpp v36, v36, v36 quad_perm:[2,3,0,1] row_mask:0xf bank_mask:0xf
v_mov_b32 v37, v36
s_nop 1
v_permlane16_swap_b32 v36, v37
v_max_f32 v36, v36, v37
v_mov_b32 v37, v36
s_nop 1
v_permlane32_swap_b32 v36, v37
v_max_f32 v36, v36, v37
v_sub_f32 v24, v24, v36
v_sub_f32 v25, v25, v36
v_sub_f32 v26, v26, v36
v_sub_f32 v27, v27, v36
v_sub_f32 v28, v28, v36
v_exp_f32 v29, v28
s_nop 0
v_cvt_pk_bf16_f32 v30, v29, v29
s_nop 1
v_mov_b32_dpp v31, v30 quad_perm:[2,3,0,1] row_mask:0xf bank_mask:0xf
v_exp_f32 v24, v24
s_nop 0
v_mfma_f32_16x16x16_bf16 v[40:43], v[32:33], v[30:31], 0
v_exp_f32 v25, v25
v_mfma_f32_16x16x16_bf16 v[44:47], v[34:35], v[30:31], 0
v_exp_f32 v26, v26
v_mfma_f32_16x16x16_bf16 v[36:39], v[20:21], v[30:31], 0
v_exp_f32 v27, v27
v_cvt_pk_bf16_f32 v16, v24, v25
v_cvt_pk_bf16_f32 v17, v26, v27
v_mov_b64 v[22:23], 0
v_mov_b32_dpp v18, v16 quad_perm:[2,3,0,1] row_mask:0xf bank_mask:0xf
v_mov_b32_dpp v19, v17 quad_perm:[2,3,0,1] row_mask:0xf bank_mask:0xf
v_mov_b64 v[24:25], 0
v_mov_b64 v[26:27], 0
v_mfma_f32_16x16x32_bf16 v[36:39], v[12:15], v[16:19], v[36:39]
v_mov_b32 v20, 0
v_mov_b32 v21, 0
v_mfma_f32_16x16x32_bf16 v[40:43], v[48:51], v[16:19], v[40:43]
v_mov_b32 v28, 0
v_mov_b32 v29, 0
v_mfma_f32_16x16x32_bf16 v[44:47], v[52:55], v[16:19], v[44:47]
v_rcp_f32 v38, v36
s_nop 2
v_pk_mul_f32 v[40:41], v[40:41], v[38:39] op_sel_hi:[1,0]
v_pk_mul_f32 v[42:43], v[42:43], v[38:39] op_sel_hi:[1,0]
v_cvt_pk_bf16_f32 v40, v40, v41
v_cvt_pk_bf16_f32 v41, v42, v43
v_pk_mul_f32 v[44:45], v[44:45], v[38:39] op_sel_hi:[1,0]
v_pk_mul_f32 v[46:47], v[46:47], v[38:39] op_sel_hi:[1,0]
s_mov_b64 exec, s[62:63]
v_cvt_pk_bf16_f32 v42, v44, v45
v_cvt_pk_bf16_f32 v43, v46, v47
ds_write_b128 v3, v[40:43] offset:1536
s_mov_b64 exec, -1
v_mov_b32_dpp v40, v40 quad_perm:[2,3,2,3] row_mask:0xf bank_mask:0xf
v_mov_b32_dpp v41, v41 quad_perm:[2,3,2,3] row_mask:0xf bank_mask:0xf
v_mov_b32_dpp v42, v42 quad_perm:[2,3,2,3] row_mask:0xf bank_mask:0xf
v_mov_b32_dpp v43, v43 quad_perm:[2,3,2,3] row_mask:0xf bank_mask:0xf
s_waitcnt lgkmcnt(0)
s_nop 1
s_branch C_FBOK3
C_RA4:
s_sub_u32 s45, s45, 1
s_cbranch_scc1 END
s_waitcnt vmcnt(0) lgkmcnt(0)
s_barrier
C_ENTRY4:
s_nop 7
v_mov_b32 v16, 0
v_mov_b32 v17, 0
v_mov_b32 v18, 0
v_mov_b32 v19, 0
v_mov_b32 v20, 0
v_mov_b32 v21, 0
v_mov_b32 v22, 0
v_mov_b32 v23, 0
v_mov_b32 v24, 0
v_mov_b32 v25, 0
v_mov_b32 v26, 0
v_mov_b32 v27, 0
v_mov_b32 v28, 0
v_mov_b32 v29, 0
v_mov_b32 v30, 0
v_mov_b32 v31, 0
v_mov_b32 v32, 0
v_mov_b32 v33, 0
v_mov_b32 v34, 0
v_mov_b32 v35, 0
v_mov_b32 v36, 0
v_mov_b32 v37, 0
v_mov_b32 v38, 0
v_mov_b32 v39, 0
ds_read_b128 v[64:67], v6 offset:24576
ds_read_b128 v[68:71], v6 offset:25600
ds_read_b128 v[72:75], v6 offset:26624
ds_read_b128 v[76:79], v6 offset:27648
s_waitcnt vmcnt(0)
C_A4:
s_waitcnt lgkmcnt(0)
s_barrier
ds_read_b128 v[56:59], v0 offset:0
ds_read_b128 v[60:63], v0 offset:1024
s_waitcnt lgkmcnt(1)
v_smfmac_f32_16x16x64_bf16 v[16:19], v[56:59], v[80:87], v4
v_smfmac_f32_16x16x64_bf16 v[20:23], v[56:59], v[224:231], v4
v_smfmac_f32_16x16x64_bf16 v[24:27], v[56:59], v[88:95], v4
buffer_load_dwordx4 v[40:43], v0, s[8:11], s67 offen offset:0
v_smfmac_f32_16x16x64_bf16 v[28:31], v[56:59], v[232:239], v4
buffer_load_dwordx4 v[44:47], v0, s[8:11], s67 offen offset:1024
v_smfmac_f32_16x16x64_bf16 v[32:35], v[56:59], v[64:71], v4
ds_read_b128 v[64:67], v6 offset:28672
ds_read_b128 v[68:71], v6 offset:29696
v_smfmac_f32_16x16x64_bf16 v[36:39], v[56:59], v[72:79], v4
buffer_load_dwordx4 v0, s[8:11], s74 offen offset:0 sc1 lds
ds_read_b128 v[72:75], v6 offset:30720
ds_read_b128 v[76:79], v6 offset:31744
s_waitcnt lgkmcnt(4)
v_smfmac_f32_16x16x64_bf16 v[16:19], v[60:63], v[96:103], v4
s_waitcnt vmcnt(3)
s_barrier
ds_read_b128 v[12:15], v0 offset:2048
v_smfmac_f32_16x16x64_bf16 v[20:23], v[60:63], v[240:247], v4
ds_read_b128 v[56:59], v0 offset:3072
v_smfmac_f32_16x16x64_bf16 v[24:27], v[60:63], v[104:111], v4
buffer_load_dwordx4 v[48:51], v0, s[8:11], s67 offen offset:2048
v_smfmac_f32_16x16x64_bf16 v[28:31], v[60:63], v[248:255], v4
buffer_load_dwordx4 v[52:55], v0, s[8:11], s67 offen offset:3072
s_waitcnt lgkmcnt(4)
v_smfmac_f32_16x16x64_bf16 v[32:35], v[60:63], v[64:71], v4
ds_read_b128 v[64:67], v6 offset:32768
ds_read_b128 v[68:71], v6 offset:33792
s_waitcnt lgkmcnt(4)
v_smfmac_f32_16x16x64_bf16 v[36:39], v[60:63], v[72:79], v4
ds_read_b128 v[72:75], v6 offset:34816
ds_read_b128 v[76:79], v6 offset:35840
s_waitcnt lgkmcnt(5)
v_smfmac_f32_16x16x64_bf16 v[16:19], v[12:15], v[112:119], v4
s_waitcnt lgkmcnt(4)
v_bitop3_b32 v7, v12, v13, s44 bitop3:0x7e
v_bitop3_b32 v7, v14, v7, s44 bitop3:0xde
v_bitop3_b32 v7, v15, v7, s44 bitop3:0xde
v_bitop3_b32 v7, v56, v7, s44 bitop3:0xde
v_bitop3_b32 v7, v57, v7, s44 bitop3:0xde
v_bitop3_b32 v7, v58, v7, s44 bitop3:0xde
v_bitop3_b32 v7, v59, v7, s44 bitop3:0xde
v_smfmac_f32_16x16x64_bf16 v[20:23], v[12:15], a[0:7], v4
v_and_b32 v7, 1, v7
s_waitcnt lgkmcnt(2)
v_smfmac_f32_16x16x64_bf16 v[32:35], v[12:15], v[64:71], v4
s_barrier
ds_read_b128 v[60:63], v0 offset:4096
ds_read_b128 v[64:67], v0 offset:5120
v_cmp_eq_u32 vcc, s59, v7
s_waitcnt lgkmcnt(2)
v_smfmac_f32_16x16x64_bf16 v[36:39], v[12:15], v[72:79], v4
v_smfmac_f32_16x16x64_bf16 v[24:27], v[12:15], v[120:127], v4
s_cbranch_vccnz C_RA4
v_smfmac_f32_16x16x64_bf16 v[28:31], v[12:15], a[8:15], v4
v_smfmac_f32_16x16x64_bf16 v[16:19], v[56:59], v[128:135], v4
s_waitcnt lgkmcnt(0)
v_bitop3_b32 v7, v60, v61, s44 bitop3:0x7e
v_bitop3_b32 v7, v62, v7, s44 bitop3:0xde
v_bitop3_b32 v7, v63, v7, s44 bitop3:0xde
v_bitop3_b32 v7, v64, v7, s44 bitop3:0xde
v_bitop3_b32 v7, v65, v7, s44 bitop3:0xde
v_bitop3_b32 v7, v66, v7, s44 bitop3:0xde
v_bitop3_b32 v7, v67, v7, s44 bitop3:0xde
v_smfmac_f32_16x16x64_bf16 v[20:23], v[56:59], a[16:23], v4
v_and_b32 v7, 1, v7
v_smfmac_f32_16x16x64_bf16 v[24:27], v[56:59], v[136:143], v4
v_cmp_eq_u32 vcc, s59, v7
v_smfmac_f32_16x16x64_bf16 v[28:31], v[56:59], a[24:31], v4
s_cbranch_vccnz C_OF04
C_OK04:
s_waitcnt vmcnt(2)
s_barrier
ds_read_b128 v[68:71], v0 offset:6144
v_smfmac_f32_16x16x64_bf16 v[16:19], v[60:63], v[144:151], v4
ds_read_b128 v[72:75], v0 offset:7168
ds_read_b128 v[76:79], v0 offset:8192
v_smfmac_f32_16x16x64_bf16 v[20:23], v[60:63], a[32:39], v4
v_smfmac_f32_16x16x64_bf16 v[24:27], v[60:63], v[152:159], v4
v_smfmac_f32_16x16x64_bf16 v[28:31], v[60:63], a[40:47], v4
s_waitcnt lgkmcnt(1)
s_waitcnt lgkmcnt(0)
v_bitop3_b32 v13, v68, v69, s44 bitop3:0x7e
v_bitop3_b32 v13, v70, v13, s44 bitop3:0xde
v_bitop3_b32 v13, v71, v13, s44 bitop3:0xde
v_bitop3_b32 v13, v72, v13, s44 bitop3:0xde
v_bitop3_b32 v13, v73, v13, s44 bitop3:0xde
v_bitop3_b32 v13, v74, v13, s44 bitop3:0xde
v_bitop3_b32 v13, v75, v13, s44 bitop3:0xde
v_bitop3_b32 v13, v76, v13, s44 bitop3:0xde
v_bitop3_b32 v13, v77, v13, s44 bitop3:0xde
v_bitop3_b32 v13, v78, v13, s44 bitop3:0xde
v_smfmac_f32_16x16x64_bf16 v[16:19], v[64:67], v[160:167], v4
v_bitop3_b32 v13, v79, v13, s44 bitop3:0xde
v_smfmac_f32_16x16x64_bf16 v[20:23], v[64:67], a[48:55], v4
v_and_b32 v13, 1, v13
v_smfmac_f32_16x16x64_bf16 v[24:27], v[64:67], v[168:175], v4
v_cmp_eq_u32 vcc, s59, v13
v_smfmac_f32_16x16x64_bf16 v[28:31], v[64:67], a[56:63], v4
s_cbranch_vccnz C_OF14
C_OK14:
v_smfmac_f32_16x16x64_bf16 v[16:19], v[68:71], v[176:183], v4
v_smfmac_f32_16x16x64_bf16 v[20:23], v[68:71], a[64:71], v4
s_add_u32 s67, s67, 524288
s_mov_b32 s74, s6
v_smfmac_f32_16x16x64_bf16 v[16:19], v[72:75], v[192:199], v4
v_smfmac_f32_16x16x64_bf16 v[20:23], v[72:75], a[80:87], v4
v_smfmac_f32_16x16x64_bf16 v[16:19], v[76:79], v[208:215], v4
v_smfmac_f32_16x16x64_bf16 v[20:23], v[76:79], a[96:103], v4
s_xor_b32 s44, s44, -1
s_mov_b32 s59, 1
v_smfmac_f32_16x16x64_bf16 v[24:27], v[68:71], v[184:191], v4
v_cvt_pk_bf16_f32 v16, v16, v17
v_smfmac_f32_16x16x64_bf16 v[24:27], v[72:75], v[200:207], v4
v_cvt_pk_bf16_f32 v17, v18, v19
v_smfmac_f32_16x16x64_bf16 v[24:27], v[76:79], v[216:223], v4
v_cvt_pk_bf16_f32 v18, v20, v21
v_smfmac_f32_16x16x64_bf16 v[28:31], v[68:71], a[72:79], v4
v_cvt_pk_bf16_f32 v19, v22, v23
v_smfmac_f32_16x16x64_bf16 v[28:31], v[72:75], a[88:95], v4
v_cvt_pk_bf16_f32 v24, v24, v25
v_smfmac_f32_16x16x64_bf16 v[28:31], v[76:79], a[104:111], v4
v_cvt_pk_bf16_f32 v25, v26, v27
v_mfma_f32_16x16x32_bf16 v[20:23], v[16:19], v[8:11], 0
s_nop 3
v_cvt_pk_bf16_f32 v26, v28, v29
v_cvt_pk_bf16_f32 v27, v30, v31
s_nop 1
v_mfma_f32_16x16x32_bf16 v[28:31], v[24:27], v[8:11], 0
v_cvt_pk_bf16_f32 v16, v20, v21
v_cvt_pk_bf16_f32 v17, v22, v23
v_smfmac_f32_16x16x64_bf16 v[32:35], v[72:75], a[224:231], v4
s_mov_b64 vcc, s[62:63]
s_nop 2
v_cvt_pk_bf16_f32 v18, v28, v29
v_cvt_pk_bf16_f32 v19, v30, v31
s_nop 1
v_mfma_f32_16x16x32_bf16 v[24:27], v[44:47], v[16:19], 0
v_mfma_f32_16x16x32_bf16 v[20:23], v[40:43], v[16:19], 0
v_mfma_f32_16x16x32_bf16 v[28:31], v[16:19], v[16:19], 0
s_nop 3
v_cndmask_b32_dpp v20, v24, v20, vcc quad_perm:[2,3,2,3] row_mask:0xf bank_mask:0xf
v_cndmask_b32_dpp v21, v25, v21, vcc quad_perm:[2,3,2,3] row_mask:0xf bank_mask:0xf
v_cndmask_b32_dpp v22, v26, v22, vcc quad_perm:[2,3,2,3] row_mask:0xf bank_mask:0xf
v_cndmask_b32_dpp v23, v27, v23, vcc quad_perm:[2,3,2,3] row_mask:0xf bank_mask:0xf
v_smfmac_f32_16x16x64_bf16 v[36:39], v[72:75], a[232:239], v4
ds_write_b128 v0, v[20:23] offset:9216
v_cndmask_b32_dpp v28, v29, v28, vcc quad_perm:[2,3,2,3] row_mask:0xf bank_mask:0xf
v_smfmac_f32_16x16x64_bf16 v[32:35], v[76:79], a[240:247], v4
ds_write_b32 v0, v28 offset:13312
v_mul_f32 v24, s72, v20
v_smfmac_f32_16x16x64_bf16 v[36:39], v[76:79], a[248:255], v4
v_mul_f32 v25, s72, v21
v_smfmac_f32_16x16x64_bf16 v[32:35], v[64:67], a[192:199], v4
v_mul_f32 v26, s72, v22
v_smfmac_f32_16x16x64_bf16 v[36:39], v[64:67], a[200:207], v4
v_mul_f32 v27, s72, v23
v_smfmac_f32_16x16x64_bf16 v[32:35], v[68:71], a[208:215], v4
v_mov_b32 v12, 0x3f803f80
v_smfmac_f32_16x16x64_bf16 v[36:39], v[68:71], a[216:223], v4
s_waitcnt lgkmcnt(0)
s_barrier
ds_read_b128 v[28:31], v0 offset:13312
ds_read_b128 v[16:19], v0 offset:10240
v_smfmac_f32_16x16x64_bf16 v[32:35], v[56:59], a[160:167], v4
ds_read_b128 v[40:43], v0 offset:11264
ds_read_b128 v[44:47], v0 offset:12288
v_mov_b32 v13, 0x3f803f80
v_smfmac_f32_16x16x64_bf16 v[36:39], v[56:59], a[168:175], v4
ds_read_b128 v[72:75], v6 offset:0
ds_read_b128 v[76:79], v6 offset:1024
v_mov_b32 v14, 0x3f803f80
v_smfmac_f32_16x16x64_bf16 v[32:35], v[60:63], a[176:183], v4
ds_read_b128 v[64:67], v6 offset:4096
ds_read_b128 v[68:71], v6 offset:5120
v_mov_b32 v15, 0x3f803f80
v_smfmac_f32_16x16x64_bf16 v[36:39], v[60:63], a[184:191], v4
v_mov_b32 v20, 0x3f003f00
v_mov_b32 v21, 0x3f003f00
s_waitcnt lgkmcnt(7)
v_pk_add_f32 v[28:29], v[28:29], v[30:31]
v_add_f32 v28, v28, v29
v_mul_f32 v28, s72, v28
s_waitcnt lgkmcnt(6)
v_pk_fma_f32 v[24:25], v[16:17], s[72:73], v[24:25]
v_exp_f32 v29, v28
v_pk_fma_f32 v[26:27], v[18:19], s[72:73], v[26:27]
s_waitcnt lgkmcnt(5)
v_pk_fma_f32 v[24:25], v[40:41], s[72:73], v[24:25]
v_cvt_pk_bf16_f32 v30, v29, v29
v_pk_fma_f32 v[26:27], v[42:43], s[72:73], v[26:27]
s_waitcnt lgkmcnt(4)
v_pk_fma_f32 v[24:25], v[44:45], s[72:73], v[24:25]
v_mov_b32_dpp v31, v30 quad_perm:[2,3,0,1] row_mask:0xf bank_mask:0xf
v_pk_fma_f32 v[26:27], v[46:47], s[72:73], v[26:27]
v_cvt_pk_bf16_f32 v32, v32, v33
v_cvt_pk_bf16_f32 v33, v34, v35
v_cvt_pk_bf16_f32 v34, v36, v37
v_cvt_pk_bf16_f32 v35, v38, v39
v_exp_f32 v24, v24
v_mfma_f32_16x16x16_bf16 v[40:43], v[32:33], v[30:31], 0
ds_read_b128 v[56:59], v6 offset:12288
ds_read_b128 v[60:63], v6 offset:13312
v_exp_f32 v25, v25
v_mfma_f32_16x16x16_bf16 v[44:47], v[34:35], v[30:31], 0
s_waitcnt vmcnt(0)
v_exp_f32 v26, v26
v_mfma_f32_16x16x16_bf16 v[36:39], v[20:21], v[30:31], 0
v_exp_f32 v27, v27
v_cvt_pk_bf16_f32 v16, v24, v25
v_cvt_pk_bf16_f32 v17, v26, v27
v_mov_b64 v[22:23], 0
v_mov_b32_dpp v18, v16 quad_perm:[2,3,0,1] row_mask:0xf bank_mask:0xf
v_mov_b32_dpp v19, v17 quad_perm:[2,3,0,1] row_mask:0xf bank_mask:0xf
v_mov_b64 v[24:25], 0
v_mov_b64 v[26:27], 0
v_mfma_f32_16x16x32_bf16 v[36:39], v[12:15], v[16:19], v[36:39]
v_mov_b32 v20, 0
v_mov_b32 v21, 0
v_mfma_f32_16x16x32_bf16 v[40:43], v[48:51], v[16:19], v[40:43]
v_mov_b32 v28, 0
v_mov_b32 v29, 0
v_mfma_f32_16x16x32_bf16 v[44:47], v[52:55], v[16:19], v[44:47]
v_rcp_f32 v38, v36
s_nop 2
v_pk_mul_f32 v[40:41], v[40:41], v[38:39] op_sel_hi:[1,0]
v_pk_mul_f32 v[42:43], v[42:43], v[38:39] op_sel_hi:[1,0]
v_cvt_pk_bf16_f32 v40, v40, v41
v_cvt_pk_bf16_f32 v41, v42, v43
v_pk_mul_f32 v[44:45], v[44:45], v[38:39] op_sel_hi:[1,0]
v_pk_mul_f32 v[46:47], v[46:47], v[38:39] op_sel_hi:[1,0]
s_mov_b64 exec, s[62:63]
v_cvt_pk_bf16_f32 v42, v44, v45
v_cvt_pk_bf16_f32 v43, v46, v47
ds_write_b128 v3, v[40:43] offset:0
s_mov_b64 exec, -1
v_max_f32 v36, v36, v38
v_cmp_nge_f32 vcc, s47, v36
v_mov_b32_dpp v40, v40 quad_perm:[2,3,2,3] row_mask:0xf bank_mask:0xf
v_mov_b32_dpp v41, v41 quad_perm:[2,3,2,3] row_mask:0xf bank_mask:0xf
v_mov_b32_dpp v42, v42 quad_perm:[2,3,2,3] row_mask:0xf bank_mask:0xf
v_mov_b32_dpp v43, v43 quad_perm:[2,3,2,3] row_mask:0xf bank_mask:0xf
s_cbranch_vccnz C_FB4
C_FBOK4:
v_mov_b64 v[30:31], 0
s_waitcnt lgkmcnt(5)
v_smfmac_f32_16x16x64_bf16 v[20:23], v[40:43], v[72:79], v4 abid:1
ds_read_b128 v[48:51], v6 offset:16384
ds_read_b128 v[52:55], v6 offset:17408
v_mov_b64 v[16:17], 0
s_waitcnt lgkmcnt(5)
v_smfmac_f32_16x16x64_bf16 v[24:27], v[40:43], v[64:71], v4 abid:1
ds_read_b128 v[72:75], v6 offset:2048
ds_read_b128 v[76:79], v6 offset:3072
v_mov_b64 v[18:19], 0
s_waitcnt lgkmcnt(4)
s_barrier
ds_read_b128 v[44:47], v3 offset:512
ds_read_b128 v[36:39], v3 offset:1024
ds_read_b128 v[12:15], v3 offset:1536
v_smfmac_f32_16x16x64_bf16 v[28:31], v[40:43], v[56:63], v4 abid:1
ds_read_b128 v[64:67], v6 offset:6144
ds_read_b128 v[68:71], v6 offset:7168
v_mov_b64 v[32:33], 0
v_smfmac_f32_16x16x64_bf16 v[16:19], v[40:43], a[112:119], v4 abid:1
ds_read_b128 v[56:59], v6 offset:8192
ds_read_b128 v[60:63], v6 offset:9216
v_mov_b64 v[34:35], 0
s_waitcnt lgkmcnt(9)
s_nop 0
v_smfmac_f32_16x16x64_bf16 v[32:35], v[40:43], v[48:55], v4 abid:1
ds_read_b128 v[48:51], v6 offset:10240
ds_read_b128 v[52:55], v6 offset:11264
s_waitcnt lgkmcnt(8)
v_smfmac_f32_16x16x64_bf16 v[20:23], v[44:47], v[72:79], v4 abid:1
ds_read_b128 v[72:75], v6 offset:14336
ds_read_b128 v[76:79], v6 offset:15360
s_waitcnt lgkmcnt(9)
v_smfmac_f32_16x16x64_bf16 v[20:23], v[36:39], a[128:135], v4 abid:1
s_waitcnt lgkmcnt(8)
v_smfmac_f32_16x16x64_bf16 v[20:23], v[12:15], a[136:143], v4 abid:1
s_waitcnt lgkmcnt(6)
v_smfmac_f32_16x16x64_bf16 v[24:27], v[44:47], v[64:71], v4 abid:1
ds_read_b128 v[64:67], v6 offset:18432
ds_read_b128 v[68:71], v6 offset:19456
s_waitcnt lgkmcnt(6)
v_smfmac_f32_16x16x64_bf16 v[24:27], v[36:39], v[56:63], v4 abid:1
ds_read_b128 v[56:59], v6 offset:20480
ds_read_b128 v[60:63], v6 offset:21504
v_cvt_pk_bf16_f32 v20, v20, v21
v_bfi_b32 v20, 1, s44, v20
v_cvt_pk_bf16_f32 v22, v22, v23
v_bfi_b32 v22, 1, s44, v22
s_waitcnt lgkmcnt(6)
v_smfmac_f32_16x16x64_bf16 v[24:27], v[12:15], v[48:55], v4 abid:1
buffer_store_dword v20, v1, s[8:11], s50 offen sc1
buffer_store_dword v22, v1, s[8:11], s51 offen sc1
ds_read_b128 v[48:51], v6 offset:22528
ds_read_b128 v[52:55], v6 offset:23552
s_waitcnt lgkmcnt(6)
v_smfmac_f32_16x16x64_bf16 v[28:31], v[44:47], v[72:79], v4 abid:1
v_mov_b32 v21, 0xeeee
v_smfmac_f32_16x16x64_bf16 v[28:31], v[36:39], a[144:151], v4 abid:1
v_cvt_pk_bf16_f32 v24, v24, v25
v_bfi_b32 v24, 1, s44, v24
v_smfmac_f32_16x16x64_bf16 v[28:31], v[12:15], a[152:159], v4 abid:1
buffer_store_dword v24, v1, s[8:11], s52 offen sc1
v_cvt_pk_bf16_f32 v26, v26, v27
v_bfi_b32 v26, 1, s44, v26
s_waitcnt lgkmcnt(4)
v_smfmac_f32_16x16x64_bf16 v[32:35], v[44:47], v[64:71], v4 abid:1
buffer_store_dword v26, v1, s[8:11], s53 offen sc1
s_waitcnt lgkmcnt(2)
v_smfmac_f32_16x16x64_bf16 v[32:35], v[36:39], v[56:63], v4 abid:1
v_cvt_pk_bf16_f32 v28, v28, v29
v_bfi_b32 v28, 1, s44, v28
s_waitcnt lgkmcnt(0)
v_smfmac_f32_16x16x64_bf16 v[32:35], v[12:15], v[48:55], v4 abid:1
buffer_store_dword v28, v1, s[8:11], s54 offen sc1
v_cvt_pk_bf16_f32 v30, v30, v31
v_bfi_b32 v30, 1, s44, v30
v_smfmac_f32_16x16x64_bf16 v[16:19], v[44:47], a[112:119], v21
buffer_store_dword v30, v1, s[8:11], s55 offen sc1
buffer_load_dwordx4 v[72:75], v0, s[8:11], s64 offen offset:0 sc1
buffer_load_dwordx4 v[76:79], v0, s[8:11], s64 offen offset:1024 sc1
v_smfmac_f32_16x16x64_bf16 v[16:19], v[36:39], a[120:127], v4 abid:1
v_cvt_pk_bf16_f32 v32, v32, v33
v_bfi_b32 v32, 1, s44, v32
v_smfmac_f32_16x16x64_bf16 v[16:19], v[12:15], a[120:127], v21
buffer_store_dword v32, v1, s[8:11], s56 offen sc1
v_cvt_pk_bf16_f32 v34, v34, v35
v_bfi_b32 v34, 1, s44, v34
buffer_store_dword v34, v1, s[8:11], s57 offen sc1
s_nop 3
v_cvt_pk_bf16_f32 v16, v16, v17
v_bfi_b32 v16, 1, s44, v16
buffer_store_dword v16, v1, s[8:11], s58 offen sc1
v_mov_b32 v60, 0x3f80
v_cndmask_b32 v60, v60, 1.0, s[32:33]
v_cndmask_b32 v56, 0, v60, s[24:25]
v_cndmask_b32 v57, 0, v60, s[26:27]
v_cndmask_b32 v58, 0, v60, s[28:29]
v_cndmask_b32 v59, 0, v60, s[30:31]
buffer_load_dwordx4 v[64:67], v0, s[8:11], s64 offen offset:0 sc1
buffer_load_dwordx4 v[68:71], v0, s[8:11], s64 offen offset:1024 sc1
s_waitcnt vmcnt(8)
buffer_load_dwordx4 v[48:51], v0, s[8:11], s64 offen offset:0 sc1
buffer_load_dwordx4 v[52:55], v0, s[8:11], s64 offen offset:1024 sc1
s_waitcnt vmcnt(8)
v_mfma_f32_16x16x32_bf16 v[60:63], v[56:59], v[72:75], 0
s_waitcnt vmcnt(7)
v_mfma_f32_16x16x32_bf16 v[60:63], v[56:59], v[76:79], v[60:63]
v_bitop3_b32 v12, v72, v73, s44 bitop3:0x7e
v_bitop3_b32 v13, v74, v75, s44 bitop3:0x7e
v_bitop3_b32 v14, v76, v77, s44 bitop3:0x7e
v_bitop3_b32 v15, v78, v79, s44 bitop3:0x7e
v_or3_b32 v12, v12, v13, v14
v_bitop3_b32 v12, v12, v15, 1 bitop3:0xa8
v_cmp_ne_u32 vcc, 0, v12
s_nop 0
v_add_f32_dpp v60, v60, v60 row_ror:4 row_mask:0xf bank_mask:0xf
v_add_f32_dpp v61, v61, v61 row_ror:4 row_mask:0xf bank_mask:0xf
s_cbranch_vccnz C_RR04
C_RT04:
v_add_f32_dpp v60, v60, v60 row_ror:8 row_mask:0xf bank_mask:0xf
v_add_f32_dpp v61, v61, v61 row_ror:8 row_mask:0xf bank_mask:0xf
s_mov_b64 exec, s[60:61]
v_cvt_pk_bf16_f32 v60, v60, v61
v_bfi_b32 v60, 1, s44, v60
buffer_store_dword v60, v2, s[8:11], 0 offen sc1
s_mov_b64 exec, -1
s_add_u32 s43, s43, 1
s_cmp_eq_u32 s43, 63
s_cbranch_scc1 C_X4
v_mov_b32 v20, 0
v_mov_b32 v21, 0
v_mov_b32 v22, 0
v_mov_b32 v23, 0
v_mov_b32 v24, 0
v_mov_b32 v25, 0
v_mov_b32 v26, 0
v_mov_b32 v27, 0
v_mov_b32 v28, 0
v_mov_b32 v29, 0
v_mov_b32 v30, 0
v_mov_b32 v31, 0
v_mov_b32 v32, 0
v_mov_b32 v33, 0
v_mov_b32 v34, 0
v_mov_b32 v35, 0
v_mov_b32 v36, 0
v_mov_b32 v37, 0
v_mov_b32 v38, 0
v_mov_b32 v39, 0
buffer_load_dwordx4 v[56:59], v0, s[8:11], s66 offen offset:0 sc1
buffer_load_dwordx4 v[60:63], v0, s[8:11], s66 offen offset:1024 sc1
v_mov_b32 v17, 0
v_mov_b32 v18, 0
v_mov_b32 v19, 0
v_mov_b32 v16, 0
buffer_load_dwordx4 v[40:43], v0, s[8:11], s66 offen offset:0 sc1
buffer_load_dwordx4 v[44:47], v0, s[8:11], s66 offen offset:1024 sc1
s_waitcnt vmcnt(5)
ds_read_b128 v[64:67], v6 offset:24576
ds_read_b128 v[68:71], v6 offset:25600
ds_read_b128 v[72:75], v6 offset:26624
ds_read_b128 v[76:79], v6 offset:27648
s_waitcnt vmcnt(4)
buffer_load_dwordx4 v[48:51], v0, s[8:11], s66 offen offset:0 sc1
buffer_load_dwordx4 v[52:55], v0, s[8:11], s66 offen offset:1024 sc1
C_G04:
s_waitcnt vmcnt(4)
v_bitop3_b32 v12, v56, v57, s44 bitop3:0x7e
v_bitop3_b32 v13, v58, v59, s44 bitop3:0x7e
v_bitop3_b32 v14, v60, v61, s44 bitop3:0x7e
v_bitop3_b32 v15, v62, v63, s44 bitop3:0x7e
v_or3_b32 v12, v12, v13, v14
v_bitop3_b32 v12, v12, v15, 1 bitop3:0xa8
v_cmp_ne_u32 vcc, 0, v12
ds_write_b128 v0, v[56:59]
s_cbranch_vccnz C_H04
s_barrier
ds_write_b128 v0, v[60:63] offset:1024
s_branch C_A4
C_H04:
buffer_load_dwordx4 v[56:59], v0, s[8:11], s66 offen offset:0 sc1
buffer_load_dwordx4 v[60:63], v0, s[8:11], s66 offen offset:1024 sc1
C_G14:
s_waitcnt vmcnt(4)
v_bitop3_b32 v12, v40, v41, s44 bitop3:0x7e
v_bitop3_b32 v13, v42, v43, s44 bitop3:0x7e
v_bitop3_b32 v14, v44, v45, s44 bitop3:0x7e
v_bitop3_b32 v15, v46, v47, s44 bitop3:0x7e
v_or3_b32 v12, v12, v13, v14
v_bitop3_b32 v12, v12, v15, 1 bitop3:0xa8
v_cmp_ne_u32 vcc, 0, v12
ds_write_b128 v0, v[40:43]
s_cbranch_vccnz C_H14
s_barrier
ds_write_b128 v0, v[44:47] offset:1024
s_branch C_A4
C_H14:
buffer_load_dwordx4 v[40:43], v0, s[8:11], s66 offen offset:0 sc1
buffer_load_dwordx4 v[44:47], v0, s[8:11], s66 offen offset:1024 sc1
C_G24:
s_waitcnt vmcnt(4)
v_bitop3_b32 v12, v48, v49, s44 bitop3:0x7e
v_bitop3_b32 v13, v50, v51, s44 bitop3:0x7e
v_bitop3_b32 v14, v52, v53, s44 bitop3:0x7e
v_bitop3_b32 v15, v54, v55, s44 bitop3:0x7e
v_or3_b32 v12, v12, v13, v14
v_bitop3_b32 v12, v12, v15, 1 bitop3:0xa8
v_cmp_ne_u32 vcc, 0, v12
ds_write_b128 v0, v[48:51]
s_cbranch_vccnz C_H24
s_barrier
ds_write_b128 v0, v[52:55] offset:1024
s_branch C_A4
C_H24:
buffer_load_dwordx4 v[48:51], v0, s[8:11], s66 offen offset:0 sc1
buffer_load_dwordx4 v[52:55], v0, s[8:11], s66 offen offset:1024 sc1
s_sub_u32 s45, s45, 1
s_cbranch_scc1 END
s_branch C_G04
C_X4:
s_waitcnt vmcnt(0) lgkmcnt(0)
s_branch END
C_RR04:
buffer_load_dwordx4 v[72:75], v0, s[8:11], s64 offen offset:0 sc1
buffer_load_dwordx4 v[76:79], v0, s[8:11], s64 offen offset:1024 sc1
s_waitcnt vmcnt(5)
v_mfma_f32_16x16x32_bf16 v[60:63], v[56:59], v[64:67], 0
s_waitcnt vmcnt(4)
v_mfma_f32_16x16x32_bf16 v[60:63], v[56:59], v[68:71], v[60:63]
v_bitop3_b32 v12, v64, v65, s44 bitop3:0x7e
v_bitop3_b32 v13, v66, v67, s44 bitop3:0x7e
v_bitop3_b32 v14, v68, v69, s44 bitop3:0x7e
v_bitop3_b32 v15, v70, v71, s44 bitop3:0x7e
v_or3_b32 v12, v12, v13, v14
v_bitop3_b32 v12, v12, v15, 1 bitop3:0xa8
v_cmp_ne_u32 vcc, 0, v12
s_nop 0
v_add_f32_dpp v60, v60, v60 row_ror:4 row_mask:0xf bank_mask:0xf
v_add_f32_dpp v61, v61, v61 row_ror:4 row_mask:0xf bank_mask:0xf
s_cbranch_vccz C_RT04
buffer_load_dwordx4 v[64:67], v0, s[8:11], s64 offen offset:0 sc1
buffer_load_dwordx4 v[68:71], v0, s[8:11], s64 offen offset:1024 sc1
s_waitcnt vmcnt(5)
v_mfma_f32_16x16x32_bf16 v[60:63], v[56:59], v[48:51], 0
s_waitcnt vmcnt(4)
v_mfma_f32_16x16x32_bf16 v[60:63], v[56:59], v[52:55], v[60:63]
v_bitop3_b32 v12, v48, v49, s44 bitop3:0x7e
v_bitop3_b32 v13, v50, v51, s44 bitop3:0x7e
v_bitop3_b32 v14, v52, v53, s44 bitop3:0x7e
v_bitop3_b32 v15, v54, v55, s44 bitop3:0x7e
v_or3_b32 v12, v12, v13, v14
v_bitop3_b32 v12, v12, v15, 1 bitop3:0xa8
v_cmp_ne_u32 vcc, 0, v12
s_nop 0
v_add_f32_dpp v60, v60, v60 row_ror:4 row_mask:0xf bank_mask:0xf
v_add_f32_dpp v61, v61, v61 row_ror:4 row_mask:0xf bank_mask:0xf
s_cbranch_vccz C_RT04
buffer_load_dwordx4 v[48:51], v0, s[8:11], s64 offen offset:0 sc1
buffer_load_dwordx4 v[52:55], v0, s[8:11], s64 offen offset:1024 sc1
s_sub_u32 s45, s45, 1
s_cbranch_scc1 END
s_waitcnt vmcnt(5)
v_mfma_f32_16x16x32_bf16 v[60:63], v[56:59], v[72:75], 0
s_waitcnt vmcnt(4)
v_mfma_f32_16x16x32_bf16 v[60:63], v[56:59], v[76:79], v[60:63]
v_bitop3_b32 v12, v72, v73, s44 bitop3:0x7e
v_bitop3_b32 v13, v74, v75, s44 bitop3:0x7e
v_bitop3_b32 v14, v76, v77, s44 bitop3:0x7e
v_bitop3_b32 v15, v78, v79, s44 bitop3:0x7e
v_or3_b32 v12, v12, v13, v14
v_bitop3_b32 v12, v12, v15, 1 bitop3:0xa8
v_cmp_ne_u32 vcc, 0, v12
s_nop 0
v_add_f32_dpp v60, v60, v60 row_ror:4 row_mask:0xf bank_mask:0xf
v_add_f32_dpp v61, v61, v61 row_ror:4 row_mask:0xf bank_mask:0xf
s_cbranch_vccz C_RT04
s_branch C_RR04
C_OF04:
s_sub_u32 s45, s45, 1
s_cbranch_scc1 END
s_waitcnt lgkmcnt(0)
s_barrier
s_barrier
ds_read_b128 v[60:63], v0 offset:4096
ds_read_b128 v[64:67], v0 offset:5120
s_waitcnt lgkmcnt(0)
v_bitop3_b32 v7, v60, v61, s44 bitop3:0x7e
v_bitop3_b32 v7, v62, v7, s44 bitop3:0xde
v_bitop3_b32 v7, v63, v7, s44 bitop3:0xde
v_bitop3_b32 v7, v64, v7, s44 bitop3:0xde
v_bitop3_b32 v7, v65, v7, s44 bitop3:0xde
v_bitop3_b32 v7, v66, v7, s44 bitop3:0xde
v_bitop3_b32 v7, v67, v7, s44 bitop3:0xde
v_and_b32 v7, 1, v7
v_cmp_eq_u32 vcc, s59, v7
s_cbranch_vccnz C_OF04
s_branch C_OK04
C_OF14:
s_sub_u32 s45, s45, 1
s_cbranch_scc1 END
s_waitcnt lgkmcnt(0)
s_barrier
buffer_load_dwordx4 v0, s[8:11], s74 offen offset:0 sc1 lds
s_waitcnt vmcnt(0)
s_barrier
ds_read_b128 v[68:71], v0 offset:6144
ds_read_b128 v[72:75], v0 offset:7168
ds_read_b128 v[76:79], v0 offset:8192
s_waitcnt lgkmcnt(0)
v_bitop3_b32 v13, v68, v69, s44 bitop3:0x7e
v_bitop3_b32 v13, v70, v13, s44 bitop3:0xde
v_bitop3_b32 v13, v71, v13, s44 bitop3:0xde
v_bitop3_b32 v13, v72, v13, s44 bitop3:0xde
v_bitop3_b32 v13, v73, v13, s44 bitop3:0xde
v_bitop3_b32 v13, v74, v13, s44 bitop3:0xde
v_bitop3_b32 v13, v75, v13, s44 bitop3:0xde
v_bitop3_b32 v13, v76, v13, s44 bitop3:0xde
v_bitop3_b32 v13, v77, v13, s44 bitop3:0xde
v_bitop3_b32 v13, v78, v13, s44 bitop3:0xde
v_bitop3_b32 v13, v79, v13, s44 bitop3:0xde
v_and_b32 v13, 1, v13
v_cmp_eq_u32 vcc, s59, v13
s_cbranch_vccnz C_OF14
s_branch C_OK14
s_nop 2
C_FB4:
ds_read_b128 v[28:31], v0 offset:13312
ds_read_b128 v[24:27], v0 offset:9216
ds_read_b128 v[16:19], v0 offset:10240
ds_read_b128 v[40:43], v0 offset:11264
ds_read_b128 v[44:47], v0 offset:12288
v_mov_b32 v20, 0x3f003f00
v_mov_b32 v21, 0x3f003f00
s_waitcnt lgkmcnt(0)
v_pk_add_f32 v[28:29], v[28:29], v[30:31]
v_add_f32 v28, v28, v29
v_mul_f32 v28, s72, v28
v_mul_f32 v24, s72, v24
v_mul_f32 v25, s72, v25
v_mul_f32 v26, s72, v26
v_mul_f32 v27, s72, v27
v_pk_fma_f32 v[24:25], v[16:17], s[72:73], v[24:25]
v_pk_fma_f32 v[26:27], v[18:19], s[72:73], v[26:27]
v_pk_fma_f32 v[24:25], v[40:41], s[72:73], v[24:25]
v_pk_fma_f32 v[26:27], v[42:43], s[72:73], v[26:27]
v_pk_fma_f32 v[24:25], v[44:45], s[72:73], v[24:25]
v_pk_fma_f32 v[26:27], v[46:47], s[72:73], v[26:27]
v_max3_f32 v36, v24, v25, v26
v_max3_f32 v36, v36, v27, v28
s_nop 1
v_max_f32_dpp v36, v36, v36 quad_perm:[2,3,0,1] row_mask:0xf bank_mask:0xf
v_mov_b32 v37, v36
s_nop 1
v_permlane16_swap_b32 v36, v37
v_max_f32 v36, v36, v37
v_mov_b32 v37, v36
s_nop 1
v_permlane32_swap_b32 v36, v37
v_max_f32 v36, v36, v37
v_sub_f32 v24, v24, v36
v_sub_f32 v25, v25, v36
v_sub_f32 v26, v26, v36
v_sub_f32 v27, v27, v36
v_sub_f32 v28, v28, v36
v_exp_f32 v29, v28
s_nop 0
v_cvt_pk_bf16_f32 v30, v29, v29
s_nop 1
v_mov_b32_dpp v31, v30 quad_perm:[2,3,0,1] row_mask:0xf bank_mask:0xf
v_exp_f32 v24, v24
s_nop 0
v_mfma_f32_16x16x16_bf16 v[40:43], v[32:33], v[30:31], 0
v_exp_f32 v25, v25
v_mfma_f32_16x16x16_bf16 v[44:47], v[34:35], v[30:31], 0
v_exp_f32 v26, v26
v_mfma_f32_16x16x16_bf16 v[36:39], v[20:21], v[30:31], 0
v_exp_f32 v27, v27
v_cvt_pk_bf16_f32 v16, v24, v25
v_cvt_pk_bf16_f32 v17, v26, v27
v_mov_b64 v[22:23], 0
v_mov_b32_dpp v18, v16 quad_perm:[2,3,0,1] row_mask:0xf bank_mask:0xf
v_mov_b32_dpp v19, v17 quad_perm:[2,3,0,1] row_mask:0xf bank_mask:0xf
v_mov_b64 v[24:25], 0
v_mov_b64 v[26:27], 0
v_mfma_f32_16x16x32_bf16 v[36:39], v[12:15], v[16:19], v[36:39]
v_mov_b32 v20, 0
v_mov_b32 v21, 0
v_mfma_f32_16x16x32_bf16 v[40:43], v[48:51], v[16:19], v[40:43]
v_mov_b32 v28, 0
v_mov_b32 v29, 0
v_mfma_f32_16x16x32_bf16 v[44:47], v[52:55], v[16:19], v[44:47]
v_rcp_f32 v38, v36
s_nop 2
v_pk_mul_f32 v[40:41], v[40:41], v[38:39] op_sel_hi:[1,0]
v_pk_mul_f32 v[42:43], v[42:43], v[38:39] op_sel_hi:[1,0]
v_cvt_pk_bf16_f32 v40, v40, v41
v_cvt_pk_bf16_f32 v41, v42, v43
v_pk_mul_f32 v[44:45], v[44:45], v[38:39] op_sel_hi:[1,0]
v_pk_mul_f32 v[46:47], v[46:47], v[38:39] op_sel_hi:[1,0]
s_mov_b64 exec, s[62:63]
v_cvt_pk_bf16_f32 v42, v44, v45
v_cvt_pk_bf16_f32 v43, v46, v47
ds_write_b128 v3, v[40:43] offset:0
s_mov_b64 exec, -1
v_mov_b32_dpp v40, v40 quad_perm:[2,3,2,3] row_mask:0xf bank_mask:0xf
v_mov_b32_dpp v41, v41 quad_perm:[2,3,2,3] row_mask:0xf bank_mask:0xf
v_mov_b32_dpp v42, v42 quad_perm:[2,3,2,3] row_mask:0xf bank_mask:0xf
v_mov_b32_dpp v43, v43 quad_perm:[2,3,2,3] row_mask:0xf bank_mask:0xf
s_waitcnt lgkmcnt(0)
s_nop 1
s_branch C_FBOK4
C_RA5:
s_sub_u32 s45, s45, 1
s_cbranch_scc1 END
s_waitcnt vmcnt(0) lgkmcnt(0)
s_barrier
buffer_load_dwordx4 v0, s[8:11], s66 offen offset:0 sc1 lds
buffer_load_dwordx4 v0, s[8:11], s66 offen offset:1024 sc1 lds
C_ENTRY5:
s_nop 7
v_mov_b32 v16, 0
v_mov_b32 v17, 0
v_mov_b32 v18, 0
v_mov_b32 v19, 0
v_mov_b32 v20, 0
v_mov_b32 v21, 0
v_mov_b32 v22, 0
v_mov_b32 v23, 0
v_mov_b32 v24, 0
v_mov_b32 v25, 0
v_mov_b32 v26, 0
v_mov_b32 v27, 0
v_mov_b32 v28, 0
v_mov_b32 v29, 0
v_mov_b32 v30, 0
v_mov_b32 v31, 0
v_mov_b32 v32, 0
v_mov_b32 v33, 0
v_mov_b32 v34, 0
v_mov_b32 v35, 0
v_mov_b32 v36, 0
v_mov_b32 v37, 0
v_mov_b32 v38, 0
v_mov_b32 v39, 0
ds_read_b128 v[64:67], v6 offset:24576
ds_read_b128 v[68:71], v6 offset:25600
ds_read_b128 v[72:75], v6 offset:26624
ds_read_b128 v[76:79], v6 offset:27648
s_waitcnt vmcnt(0)
C_A5:
s_barrier
ds_read_b128 v[56:59], v0 offset:0
ds_read_b128 v[60:63], v0 offset:1024
s_waitcnt lgkmcnt(1)
v_smfmac_f32_16x16x64_bf16 v[16:19], v[56:59], v[80:87], v4
s_add_u32 s2, s43, 2
s_min_u32 s2, s2, 63
v_smfmac_f32_16x16x64_bf16 v[20:23], v[56:59], v[224:231], v4
s_lshr_b32 s69, s2, 2
s_and_b32 s2, s2, 3
v_smfmac_f32_16x16x64_bf16 v[24:27], v[56:59], v[88:95], v4
buffer_load_dwordx4 v[40:43], v0, s[8:11], s67 offen offset:0
s_lshl_b32 s70, s41, 5
v_smfmac_f32_16x16x64_bf16 v[28:31], v[56:59], v[232:239], v4
buffer_load_dwordx4 v[44:47], v0, s[8:11], s67 offen offset:1024
s_add_u32 s70, s70, s2
v_lshl_add_u32 v5, v0, 3, s5
v_smfmac_f32_16x16x64_bf16 v[32:35], v[56:59], v[64:71], v4
ds_read_b128 v[64:67], v6 offset:28672
ds_read_b128 v[68:71], v6 offset:29696
v_smfmac_f32_16x16x64_bf16 v[36:39], v[56:59], v[72:79], v4
ds_read_b128 v[72:75], v6 offset:30720
ds_read_b128 v[76:79], v6 offset:31744
s_waitcnt lgkmcnt(4)
v_smfmac_f32_16x16x64_bf16 v[16:19], v[60:63], v[96:103], v4
s_waitcnt vmcnt(2)
s_barrier
ds_read_b128 v[12:15], v0 offset:2048
v_smfmac_f32_16x16x64_bf16 v[20:23], v[60:63], v[240:247], v4
ds_read_b128 v[56:59], v0 offset:3072
v_smfmac_f32_16x16x64_bf16 v[24:27], v[60:63], v[104:111], v4
buffer_load_dwordx4 v[48:51], v0, s[8:11], s67 offen offset:2048
s_lshl_b32 s70, s70, 2
v_smfmac_f32_16x16x64_bf16 v[28:31], v[60:63], v[248:255], v4
buffer_load_dwordx4 v[52:55], v0, s[8:11], s67 offen offset:3072
s_waitcnt lgkmcnt(4)
v_smfmac_f32_16x16x64_bf16 v[32:35], v[60:63], v[64:71], v4
ds_read_b128 v[64:67], v6 offset:32768
ds_read_b128 v[68:71], v6 offset:33792
s_waitcnt lgkmcnt(4)
v_smfmac_f32_16x16x64_bf16 v[36:39], v[60:63], v[72:79], v4
ds_read_b128 v[72:75], v6 offset:34816
ds_read_b128 v[76:79], v6 offset:35840
s_waitcnt lgkmcnt(5)
v_smfmac_f32_16x16x64_bf16 v[16:19], v[12:15], v[112:119], v4
s_waitcnt lgkmcnt(4)
v_bitop3_b32 v7, v12, v13, s44 bitop3:0x7e
v_bitop3_b32 v7, v14, v7, s44 bitop3:0xde
v_bitop3_b32 v7, v15, v7, s44 bitop3:0xde
v_bitop3_b32 v7, v56, v7, s44 bitop3:0xde
v_bitop3_b32 v7, v57, v7, s44 bitop3:0xde
v_bitop3_b32 v7, v58, v7, s44 bitop3:0xde
v_bitop3_b32 v7, v59, v7, s44 bitop3:0xde
v_smfmac_f32_16x16x64_bf16 v[20:23], v[12:15], a[0:7], v4
v_and_b32 v7, 1, v7
s_waitcnt lgkmcnt(2)
v_smfmac_f32_16x16x64_bf16 v[32:35], v[12:15], v[64:71], v4
s_barrier
ds_read_b128 v[60:63], v0 offset:4096
ds_read_b128 v[64:67], v0 offset:5120
v_cmp_eq_u32 vcc, s59, v7
s_waitcnt lgkmcnt(2)
v_smfmac_f32_16x16x64_bf16 v[36:39], v[12:15], v[72:79], v4
v_smfmac_f32_16x16x64_bf16 v[24:27], v[12:15], v[120:127], v4
s_cbranch_vccnz C_RA5
buffer_load_dword v5, v5, s[8:11], s67 offen
v_smfmac_f32_16x16x64_bf16 v[28:31], v[12:15], a[8:15], v4
buffer_load_dword v5, off, s[8:11], s70 sc1
v_smfmac_f32_16x16x64_bf16 v[16:19], v[56:59], v[128:135], v4
s_waitcnt lgkmcnt(0)
v_bitop3_b32 v7, v60, v61, s44 bitop3:0x7e
v_bitop3_b32 v7, v62, v7, s44 bitop3:0xde
v_bitop3_b32 v7, v63, v7, s44 bitop3:0xde
v_bitop3_b32 v7, v64, v7, s44 bitop3:0xde
v_bitop3_b32 v7, v65, v7, s44 bitop3:0xde
v_bitop3_b32 v7, v66, v7, s44 bitop3:0xde
v_bitop3_b32 v7, v67, v7, s44 bitop3:0xde
v_smfmac_f32_16x16x64_bf16 v[20:23], v[56:59], a[16:23], v4
v_and_b32 v7, 1, v7
v_smfmac_f32_16x16x64_bf16 v[24:27], v[56:59], v[136:143], v4
v_cmp_eq_u32 vcc, s59, v7
v_smfmac_f32_16x16x64_bf16 v[28:31], v[56:59], a[24:31], v4
s_cbranch_vccnz C_OF05
C_OK05:
s_barrier
ds_read_b128 v[68:71], v0 offset:6144
v_smfmac_f32_16x16x64_bf16 v[16:19], v[60:63], v[144:151], v4
ds_read_b128 v[72:75], v0 offset:7168
ds_read_b128 v[76:79], v0 offset:8192
v_smfmac_f32_16x16x64_bf16 v[20:23], v[60:63], a[32:39], v4
v_smfmac_f32_16x16x64_bf16 v[24:27], v[60:63], v[152:159], v4
v_smfmac_f32_16x16x64_bf16 v[28:31], v[60:63], a[40:47], v4
s_waitcnt lgkmcnt(1)
s_waitcnt lgkmcnt(0)
v_bitop3_b32 v13, v68, v69, s44 bitop3:0x7e
v_bitop3_b32 v13, v70, v13, s44 bitop3:0xde
v_bitop3_b32 v13, v71, v13, s44 bitop3:0xde
v_bitop3_b32 v13, v72, v13, s44 bitop3:0xde
v_bitop3_b32 v13, v73, v13, s44 bitop3:0xde
v_bitop3_b32 v13, v74, v13, s44 bitop3:0xde
v_bitop3_b32 v13, v75, v13, s44 bitop3:0xde
v_bitop3_b32 v13, v76, v13, s44 bitop3:0xde
v_bitop3_b32 v13, v77, v13, s44 bitop3:0xde
v_bitop3_b32 v13, v78, v13, s44 bitop3:0xde
v_smfmac_f32_16x16x64_bf16 v[16:19], v[64:67], v[160:167], v4
v_bitop3_b32 v13, v79, v13, s44 bitop3:0xde
v_smfmac_f32_16x16x64_bf16 v[20:23], v[64:67], a[48:55], v4
v_and_b32 v13, 1, v13
v_smfmac_f32_16x16x64_bf16 v[24:27], v[64:67], v[168:175], v4
v_cmp_eq_u32 vcc, s59, v13
v_smfmac_f32_16x16x64_bf16 v[28:31], v[64:67], a[56:63], v4
s_cbranch_vccnz C_OF15
C_OK15:
v_smfmac_f32_16x16x64_bf16 v[16:19], v[68:71], v[176:183], v4
v_smfmac_f32_16x16x64_bf16 v[20:23], v[68:71], a[64:71], v4
s_add_u32 s67, s67, 524288
s_mov_b32 s74, s66
v_smfmac_f32_16x16x64_bf16 v[16:19], v[72:75], v[192:199], v4
v_smfmac_f32_16x16x64_bf16 v[20:23], v[72:75], a[80:87], v4
v_smfmac_f32_16x16x64_bf16 v[16:19], v[76:79], v[208:215], v4
v_smfmac_f32_16x16x64_bf16 v[20:23], v[76:79], a[96:103], v4
s_xor_b32 s44, s44, -1
s_mov_b32 s59, 1
v_smfmac_f32_16x16x64_bf16 v[24:27], v[68:71], v[184:191], v4
v_cvt_pk_bf16_f32 v16, v16, v17
v_smfmac_f32_16x16x64_bf16 v[24:27], v[72:75], v[200:207], v4
v_cvt_pk_bf16_f32 v17, v18, v19
v_smfmac_f32_16x16x64_bf16 v[24:27], v[76:79], v[216:223], v4
v_cvt_pk_bf16_f32 v18, v20, v21
v_smfmac_f32_16x16x64_bf16 v[28:31], v[68:71], a[72:79], v4
v_cvt_pk_bf16_f32 v19, v22, v23
v_smfmac_f32_16x16x64_bf16 v[28:31], v[72:75], a[88:95], v4
v_cvt_pk_bf16_f32 v24, v24, v25
v_smfmac_f32_16x16x64_bf16 v[28:31], v[76:79], a[104:111], v4
v_cvt_pk_bf16_f32 v25, v26, v27
v_mfma_f32_16x16x32_bf16 v[20:23], v[16:19], v[8:11], 0
s_nop 3
v_cvt_pk_bf16_f32 v26, v28, v29
v_cvt_pk_bf16_f32 v27, v30, v31
s_nop 1
v_mfma_f32_16x16x32_bf16 v[28:31], v[24:27], v[8:11], 0
v_cvt_pk_bf16_f32 v16, v20, v21
v_cvt_pk_bf16_f32 v17, v22, v23
v_smfmac_f32_16x16x64_bf16 v[32:35], v[72:75], a[224:231], v4
s_waitcnt vmcnt(4)
s_mov_b64 vcc, s[62:63]
s_nop 1
v_cvt_pk_bf16_f32 v18, v28, v29
v_cvt_pk_bf16_f32 v19, v30, v31
s_nop 1
v_mfma_f32_16x16x32_bf16 v[24:27], v[44:47], v[16:19], 0
v_mfma_f32_16x16x32_bf16 v[20:23], v[40:43], v[16:19], 0
v_mfma_f32_16x16x32_bf16 v[28:31], v[16:19], v[16:19], 0
s_nop 3
v_cndmask_b32_dpp v20, v24, v20, vcc quad_perm:[2,3,2,3] row_mask:0xf bank_mask:0xf
v_cndmask_b32_dpp v21, v25, v21, vcc quad_perm:[2,3,2,3] row_mask:0xf bank_mask:0xf
v_cndmask_b32_dpp v22, v26, v22, vcc quad_perm:[2,3,2,3] row_mask:0xf bank_mask:0xf
v_cndmask_b32_dpp v23, v27, v23, vcc quad_perm:[2,3,2,3] row_mask:0xf bank_mask:0xf
v_smfmac_f32_16x16x64_bf16 v[36:39], v[72:75], a[232:239], v4
ds_write_b128 v0, v[20:23] offset:10240
v_cndmask_b32_dpp v28, v29, v28, vcc quad_perm:[2,3,2,3] row_mask:0xf bank_mask:0xf
v_smfmac_f32_16x16x64_bf16 v[32:35], v[76:79], a[240:247], v4
ds_write_b32 v0, v28 offset:13316
v_mul_f32 v24, s72, v20
v_smfmac_f32_16x16x64_bf16 v[36:39], v[76:79], a[248:255], v4
v_mul_f32 v25, s72, v21
v_smfmac_f32_16x16x64_bf16 v[32:35], v[64:67], a[192:199], v4
v_mul_f32 v26, s72, v22
v_smfmac_f32_16x16x64_bf16 v[36:39], v[64:67], a[200:207], v4
v_mul_f32 v27, s72, v23
v_smfmac_f32_16x16x64_bf16 v[32:35], v[68:71], a[208:215], v4
v_mov_b32 v12, 0x3f803f80
v_smfmac_f32_16x16x64_bf16 v[36:39], v[68:71], a[216:223], v4
s_waitcnt lgkmcnt(0)
s_barrier
ds_read_b128 v[28:31], v0 offset:13312
ds_read_b128 v[16:19], v0 offset:9216
v_smfmac_f32_16x16x64_bf16 v[32:35], v[56:59], a[160:167], v4
ds_read_b128 v[40:43], v0 offset:12288
ds_read_b128 v[44:47], v0 offset:11264
v_mov_b32 v13, 0x3f803f80
v_smfmac_f32_16x16x64_bf16 v[36:39], v[56:59], a[168:175], v4
ds_read_b128 v[72:75], v6 offset:0
ds_read_b128 v[76:79], v6 offset:1024
v_mov_b32 v14, 0x3f803f80
v_smfmac_f32_16x16x64_bf16 v[32:35], v[60:63], a[176:183], v4
ds_read_b128 v[64:67], v6 offset:4096
ds_read_b128 v[68:71], v6 offset:5120
v_mov_b32 v15, 0x3f803f80
v_smfmac_f32_16x16x64_bf16 v[36:39], v[60:63], a[184:191], v4
v_mov_b32 v20, 0x3f003f00
v_mov_b32 v21, 0x3f003f00
s_waitcnt lgkmcnt(7)
v_pk_add_f32 v[28:29], v[28:29], v[30:31]
v_add_f32 v28, v28, v29
v_mul_f32 v28, s72, v28
s_waitcnt lgkmcnt(6)
v_pk_fma_f32 v[24:25], v[16:17], s[72:73], v[24:25]
v_exp_f32 v29, v28
v_pk_fma_f32 v[26:27], v[18:19], s[72:73], v[26:27]
s_waitcnt lgkmcnt(5)
v_pk_fma_f32 v[24:25], v[40:41], s[72:73], v[24:25]
v_cvt_pk_bf16_f32 v30, v29, v29
v_pk_fma_f32 v[26:27], v[42:43], s[72:73], v[26:27]
s_waitcnt lgkmcnt(4)
v_pk_fma_f32 v[24:25], v[44:45], s[72:73], v[24:25]
v_mov_b32_dpp v31, v30 quad_perm:[2,3,0,1] row_mask:0xf bank_mask:0xf
v_pk_fma_f32 v[26:27], v[46:47], s[72:73], v[26:27]
v_cvt_pk_bf16_f32 v32, v32, v33
v_cvt_pk_bf16_f32 v33, v34, v35
v_cvt_pk_bf16_f32 v34, v36, v37
v_cvt_pk_bf16_f32 v35, v38, v39
v_exp_f32 v24, v24
v_mfma_f32_16x16x16_bf16 v[40:43], v[32:33], v[30:31], 0
ds_read_b128 v[56:59], v6 offset:12288
ds_read_b128 v[60:63], v6 offset:13312
v_exp_f32 v25, v25
v_mfma_f32_16x16x16_bf16 v[44:47], v[34:35], v[30:31], 0
s_waitcnt vmcnt(2)
v_exp_f32 v26, v26
v_mfma_f32_16x16x16_bf16 v[36:39], v[20:21], v[30:31], 0
v_exp_f32 v27, v27
v_cvt_pk_bf16_f32 v16, v24, v25
v_cvt_pk_bf16_f32 v17, v26, v27
v_mov_b64 v[22:23], 0
v_mov_b32_dpp v18, v16 quad_perm:[2,3,0,1] row_mask:0xf bank_mask:0xf
v_mov_b32_dpp v19, v17 quad_perm:[2,3,0,1] row_mask:0xf bank_mask:0xf
v_mov_b64 v[24:25], 0
v_mov_b64 v[26:27], 0
v_mfma_f32_16x16x32_bf16 v[36:39], v[12:15], v[16:19], v[36:39]
v_mov_b32 v20, 0
v_mov_b32 v21, 0
v_mfma_f32_16x16x32_bf16 v[40:43], v[48:51], v[16:19], v[40:43]
v_mov_b32 v28, 0
v_mov_b32 v29, 0
v_mfma_f32_16x16x32_bf16 v[44:47], v[52:55], v[16:19], v[44:47]
v_rcp_f32 v38, v36
s_nop 2
v_pk_mul_f32 v[40:41], v[40:41], v[38:39] op_sel_hi:[1,0]
v_pk_mul_f32 v[42:43], v[42:43], v[38:39] op_sel_hi:[1,0]
v_cvt_pk_bf16_f32 v40, v40, v41
v_cvt_pk_bf16_f32 v41, v42, v43
v_pk_mul_f32 v[44:45], v[44:45], v[38:39] op_sel_hi:[1,0]
v_pk_mul_f32 v[46:47], v[46:47], v[38:39] op_sel_hi:[1,0]
s_mov_b64 exec, s[62:63]
v_cvt_pk_bf16_f32 v42, v44, v45
v_cvt_pk_bf16_f32 v43, v46, v47
ds_write_b128 v3, v[40:43] offset:512
s_mov_b64 exec, -1
v_max_f32 v36, v36, v38
v_cmp_nge_f32 vcc, s47, v36
v_mov_b32_dpp v40, v40 quad_perm:[2,3,2,3] row_mask:0xf bank_mask:0xf
v_mov_b32_dpp v41, v41 quad_perm:[2,3,2,3] row_mask:0xf bank_mask:0xf
v_mov_b32_dpp v42, v42 quad_perm:[2,3,2,3] row_mask:0xf bank_mask:0xf
v_mov_b32_dpp v43, v43 quad_perm:[2,3,2,3] row_mask:0xf bank_mask:0xf
s_cbranch_vccnz C_FB5
C_FBOK5:
v_mov_b64 v[30:31], 0
s_waitcnt lgkmcnt(5)
v_smfmac_f32_16x16x64_bf16 v[20:23], v[40:43], v[72:79], v4 abid:1
ds_read_b128 v[48:51], v6 offset:16384
ds_read_b128 v[52:55], v6 offset:17408
v_mov_b64 v[16:17], 0
s_waitcnt lgkmcnt(5)
v_smfmac_f32_16x16x64_bf16 v[24:27], v[40:43], v[64:71], v4 abid:1
ds_read_b128 v[72:75], v6 offset:2048
ds_read_b128 v[76:79], v6 offset:3072
v_mov_b64 v[18:19], 0
s_waitcnt lgkmcnt(4)
s_barrier
ds_read_b128 v[44:47], v3 offset:0
ds_read_b128 v[36:39], v3 offset:1536
ds_read_b128 v[12:15], v3 offset:1024
v_smfmac_f32_16x16x64_bf16 v[28:31], v[40:43], v[56:63], v4 abid:1
ds_read_b128 v[64:67], v6 offset:6144
ds_read_b128 v[68:71], v6 offset:7168
v_mov_b64 v[32:33], 0
v_smfmac_f32_16x16x64_bf16 v[16:19], v[40:43], a[112:119], v4 abid:1
ds_read_b128 v[56:59], v6 offset:8192
ds_read_b128 v[60:63], v6 offset:9216
v_mov_b64 v[34:35], 0
s_waitcnt lgkmcnt(9)
s_nop 0
v_smfmac_f32_16x16x64_bf16 v[32:35], v[40:43], v[48:55], v4 abid:1
ds_read_b128 v[48:51], v6 offset:10240
ds_read_b128 v[52:55], v6 offset:11264
s_waitcnt lgkmcnt(8)
v_smfmac_f32_16x16x64_bf16 v[20:23], v[44:47], v[72:79], v4 abid:1
ds_read_b128 v[72:75], v6 offset:14336
ds_read_b128 v[76:79], v6 offset:15360
s_waitcnt lgkmcnt(9)
v_smfmac_f32_16x16x64_bf16 v[20:23], v[36:39], a[128:135], v4 abid:1
s_waitcnt lgkmcnt(8)
v_smfmac_f32_16x16x64_bf16 v[20:23], v[12:15], a[136:143], v4 abid:1
s_waitcnt lgkmcnt(6)
v_smfmac_f32_16x16x64_bf16 v[24:27], v[44:47], v[64:71], v4 abid:1
ds_read_b128 v[64:67], v6 offset:18432
ds_read_b128 v[68:71], v6 offset:19456
s_waitcnt lgkmcnt(6)
v_smfmac_f32_16x16x64_bf16 v[24:27], v[36:39], v[56:63], v4 abid:1
ds_read_b128 v[56:59], v6 offset:20480
ds_read_b128 v[60:63], v6 offset:21504
v_cvt_pk_bf16_f32 v20, v20, v21
v_bfi_b32 v20, 1, s44, v20
v_cvt_pk_bf16_f32 v22, v22, v23
v_bfi_b32 v22, 1, s44, v22
s_waitcnt lgkmcnt(6)
v_smfmac_f32_16x16x64_bf16 v[24:27], v[12:15], v[48:55], v4 abid:1
buffer_store_dword v20, v1, s[8:11], s50 offen sc1
buffer_store_dword v22, v1, s[8:11], s51 offen sc1
ds_read_b128 v[48:51], v6 offset:22528
ds_read_b128 v[52:55], v6 offset:23552
s_waitcnt lgkmcnt(6)
v_smfmac_f32_16x16x64_bf16 v[28:31], v[44:47], v[72:79], v4 abid:1
v_mov_b32 v21, 0xeeee
v_smfmac_f32_16x16x64_bf16 v[28:31], v[36:39], a[144:151], v4 abid:1
v_cvt_pk_bf16_f32 v24, v24, v25
v_bfi_b32 v24, 1, s44, v24
v_smfmac_f32_16x16x64_bf16 v[28:31], v[12:15], a[152:159], v4 abid:1
buffer_store_dword v24, v1, s[8:11], s52 offen sc1
v_cvt_pk_bf16_f32 v26, v26, v27
v_bfi_b32 v26, 1, s44, v26
s_waitcnt lgkmcnt(4)
v_smfmac_f32_16x16x64_bf16 v[32:35], v[44:47], v[64:71], v4 abid:1
buffer_store_dword v26, v1, s[8:11], s53 offen sc1
s_waitcnt lgkmcnt(2)
v_smfmac_f32_16x16x64_bf16 v[32:35], v[36:39], v[56:63], v4 abid:1
v_cvt_pk_bf16_f32 v28, v28, v29
v_bfi_b32 v28, 1, s44, v28
s_waitcnt lgkmcnt(0)
v_smfmac_f32_16x16x64_bf16 v[32:35], v[12:15], v[48:55], v4 abid:1
buffer_store_dword v28, v1, s[8:11], s54 offen sc1
v_cvt_pk_bf16_f32 v30, v30, v31
v_bfi_b32 v30, 1, s44, v30
v_smfmac_f32_16x16x64_bf16 v[16:19], v[44:47], a[112:119], v21
buffer_store_dword v30, v1, s[8:11], s55 offen sc1
v_smfmac_f32_16x16x64_bf16 v[16:19], v[36:39], a[120:127], v4 abid:1
v_cvt_pk_bf16_f32 v32, v32, v33
v_bfi_b32 v32, 1, s44, v32
v_smfmac_f32_16x16x64_bf16 v[16:19], v[12:15], a[120:127], v21
buffer_store_dword v32, v1, s[8:11], s56 offen sc1
v_cvt_pk_bf16_f32 v34, v34, v35
v_bfi_b32 v34, 1, s44, v34
buffer_store_dword v34, v1, s[8:11], s57 offen sc1
s_nop 3
v_cvt_pk_bf16_f32 v16, v16, v17
v_bfi_b32 v16, 1, s44, v16
buffer_store_dword v16, v1, s[8:11], s58 offen sc1
v_mov_b32 v60, 0x3f80
v_cndmask_b32 v60, v60, 1.0, s[32:33]
v_cndmask_b32 v56, 0, v60, s[24:25]
v_cndmask_b32 v57, 0, v60, s[26:27]
v_cndmask_b32 v58, 0, v60, s[28:29]
v_cndmask_b32 v59, 0, v60, s[30:31]
v_mov_b32 v20, 0
v_mov_b32 v21, 0
v_mov_b32 v22, 0
v_mov_b32 v23, 0
v_mov_b32 v24, 0
v_mov_b32 v25, 0
v_mov_b32 v26, 0
v_mov_b32 v27, 0
v_mov_b32 v28, 0
v_mov_b32 v29, 0
v_mov_b32 v30, 0
v_mov_b32 v31, 0
v_mov_b32 v32, 0
v_mov_b32 v33, 0
v_mov_b32 v34, 0
v_mov_b32 v35, 0
v_mov_b32 v36, 0
v_mov_b32 v37, 0
v_mov_b32 v38, 0
v_mov_b32 v39, 0
v_mov_b32 v17, 0
v_mov_b32 v18, 0
v_mov_b32 v19, 0
v_mov_b32 v16, 0
s_waitcnt vmcnt(3)
buffer_load_dwordx4 v[72:75], v0, s[8:11], s64 offen offset:0 sc1
buffer_load_dwordx4 v[76:79], v0, s[8:11], s64 offen offset:1024 sc1
s_waitcnt vmcnt(2)
buffer_load_dwordx4 v[64:67], v0, s[8:11], s65 offen offset:0 sc1
buffer_load_dwordx4 v[68:71], v0, s[8:11], s65 offen offset:1024 sc1
s_waitcnt vmcnt(3)
v_mfma_f32_16x16x32_bf16 v[60:63], v[56:59], v[72:75], 0
s_waitcnt vmcnt(2)
v_mfma_f32_16x16x32_bf16 v[60:63], v[56:59], v[76:79], v[60:63]
v_bitop3_b32 v12, v72, v73, s44 bitop3:0x7e
v_bitop3_b32 v13, v74, v75, s44 bitop3:0x7e
v_bitop3_b32 v14, v76, v77, s44 bitop3:0x7e
v_bitop3_b32 v15, v78, v79, s44 bitop3:0x7e
v_or3_b32 v12, v12, v13, v14
v_bitop3_b32 v12, v12, v15, 1 bitop3:0xa8
v_cmp_ne_u32 vcc, 0, v12
s_nop 0
v_add_f32_dpp v60, v60, v60 row_ror:4 row_mask:0xf bank_mask:0xf
v_add_f32_dpp v61, v61, v61 row_ror:4 row_mask:0xf bank_mask:0xf
s_cbranch_vccnz C_RR05
C_RT05:
v_add_f32_dpp v60, v60, v60 row_ror:8 row_mask:0xf bank_mask:0xf
v_add_f32_dpp v61, v61, v61 row_ror:8 row_mask:0xf bank_mask:0xf
s_mov_b64 exec, s[60:61]
v_cvt_pk_bf16_f32 v60, v60, v61
v_bfi_b32 v60, 1, s44, v60
buffer_store_dword v60, v2, s[8:11], 0 offen sc1
s_mov_b64 exec, -1
s_waitcnt vmcnt(2)
v_mfma_f32_16x16x32_bf16 v[60:63], v[56:59], v[64:67], 0
s_waitcnt vmcnt(1)
v_mfma_f32_16x16x32_bf16 v[60:63], v[56:59], v[68:71], v[60:63]
v_bitop3_b32 v12, v64, v65, s44 bitop3:0x7e
v_bitop3_b32 v13, v66, v67, s44 bitop3:0x7e
v_bitop3_b32 v14, v68, v69, s44 bitop3:0x7e
v_bitop3_b32 v15, v70, v71, s44 bitop3:0x7e
v_or3_b32 v12, v12, v13, v14
v_bitop3_b32 v12, v12, v15, 1 bitop3:0xa8
v_cmp_ne_u32 vcc, 0, v12
s_nop 0
v_add_f32_dpp v60, v60, v60 row_ror:4 row_mask:0xf bank_mask:0xf
v_add_f32_dpp v61, v61, v61 row_ror:4 row_mask:0xf bank_mask:0xf
s_cbranch_vccnz C_RR15
C_RT15:
v_add_f32_dpp v60, v60, v60 row_ror:8 row_mask:0xf bank_mask:0xf
v_add_f32_dpp v61, v61, v61 row_ror:8 row_mask:0xf bank_mask:0xf
s_mov_b64 exec, s[34:35]
v_cvt_pk_bf16_f32 v60, v60, v61
v_bfi_b32 v60, 1, s44, v60
buffer_store_dword v60, v2, s[8:11], s4 offen sc1
s_mov_b64 exec, -1
s_add_u32 s43, s43, 1
s_cmp_eq_u32 s43, 63
s_cbranch_scc1 C_X5
C_FW5:
v_cmp_ge_u32 vcc, s69, v5
s_cbranch_vccnz C_RF5
s_waitcnt vmcnt(1)
ds_read_b128 v[64:67], v6 offset:24576
ds_read_b128 v[68:71], v6 offset:25600
ds_read_b128 v[72:75], v6 offset:26624
ds_read_b128 v[76:79], v6 offset:27648
s_barrier
buffer_load_dwordx4 v0, s[8:11], s66 offen offset:0 sc1 lds
buffer_load_dwordx4 v0, s[8:11], s66 offen offset:1024 sc1 lds
s_branch C_A5
C_X5:
s_waitcnt vmcnt(0) lgkmcnt(0)
s_branch END
C_RR05:
s_mov_b64 exec, vcc
buffer_load_dwordx4 v[72:75], v0, s[8:11], s64 offen offset:0 sc1
buffer_load_dwordx4 v[76:79], v0, s[8:11], s64 offen offset:1024 sc1
s_mov_b64 exec, -1
buffer_load_dwordx4 v[64:67], v0, s[8:11], s65 offen offset:0 sc1
buffer_load_dwordx4 v[68:71], v0, s[8:11], s65 offen offset:1024 sc1
C_RL05:
s_mov_b64 exec, vcc
buffer_load_dwordx4 v[72:75], v0, s[8:11], s64 offen offset:0 sc1
buffer_load_dwordx4 v[76:79], v0, s[8:11], s64 offen offset:1024 sc1
s_mov_b64 exec, -1
buffer_load_dwordx4 v[64:67], v0, s[8:11], s65 offen offset:0 sc1
buffer_load_dwordx4 v[68:71], v0, s[8:11], s65 offen offset:1024 sc1
s_sub_u32 s45, s45, 1
s_cbranch_scc1 END
s_waitcnt vmcnt(6)
v_bitop3_b32 v12, v72, v73, s44 bitop3:0x7e
v_bitop3_b32 v13, v74, v75, s44 bitop3:0x7e
v_bitop3_b32 v14, v76, v77, s44 bitop3:0x7e
v_bitop3_b32 v15, v78, v79, s44 bitop3:0x7e
v_or3_b32 v12, v12, v13, v14
v_bitop3_b32 v12, v12, v15, 1 bitop3:0xa8
v_cmp_ne_u32 vcc, 0, v12
s_cbranch_vccnz C_RL05
C_RM05:
v_mfma_f32_16x16x32_bf16 v[60:63], v[56:59], v[72:75], 0
v_mfma_f32_16x16x32_bf16 v[60:63], v[56:59], v[76:79], v[60:63]
v_bitop3_b32 v12, v64, v65, s44 bitop3:0x7e
v_bitop3_b32 v13, v66, v67, s44 bitop3:0x7e
v_bitop3_b32 v14, v68, v69, s44 bitop3:0x7e
v_bitop3_b32 v15, v70, v71, s44 bitop3:0x7e
v_or3_b32 v12, v12, v13, v14
v_bitop3_b32 v12, v12, v15, 1 bitop3:0xa8
v_cmp_ne_u32 vcc, 0, v12
s_nop 0
v_add_f32_dpp v60, v60, v60 row_ror:4 row_mask:0xf bank_mask:0xf
v_add_f32_dpp v61, v61, v61 row_ror:4 row_mask:0xf bank_mask:0xf
s_nop 0
v_add_f32_dpp v60, v60, v60 row_ror:8 row_mask:0xf bank_mask:0xf
v_add_f32_dpp v61, v61, v61 row_ror:8 row_mask:0xf bank_mask:0xf
s_mov_b64 exec, s[60:61]
v_cvt_pk_bf16_f32 v60, v60, v61
v_bfi_b32 v60, 1, s44, v60
buffer_store_dword v60, v2, s[8:11], 0 offen sc1
s_mov_b64 exec, -1
s_cbranch_vccz C_RM15
s_branch C_RL15
C_RR15:
s_mov_b64 exec, vcc
buffer_load_dwordx4 v[64:67], v0, s[8:11], s65 offen offset:0 sc1
buffer_load_dwordx4 v[68:71], v0, s[8:11], s65 offen offset:1024 sc1
s_mov_b64 exec, -1
C_RL15:
s_mov_b64 exec, vcc
buffer_load_dwordx4 v[64:67], v0, s[8:11], s65 offen offset:0 sc1
buffer_load_dwordx4 v[68:71], v0, s[8:11], s65 offen offset:1024 sc1
s_mov_b64 exec, -1
s_sub_u32 s45, s45, 1
s_cbranch_scc1 END
s_waitcnt vmcnt(2)
v_bitop3_b32 v12, v64, v65, s44 bitop3:0x7e
v_bitop3_b32 v13, v66, v67, s44 bitop3:0x7e
v_bitop3_b32 v14, v68, v69, s44 bitop3:0x7e
v_bitop3_b32 v15, v70, v71, s44 bitop3:0x7e
v_or3_b32 v12, v12, v13, v14
v_bitop3_b32 v12, v12, v15, 1 bitop3:0xa8
v_cmp_ne_u32 vcc, 0, v12
s_cbranch_vccnz C_RL15
C_RM15:
v_mfma_f32_16x16x32_bf16 v[60:63], v[56:59], v[64:67], 0
v_mfma_f32_16x16x32_bf16 v[60:63], v[56:59], v[68:71], v[60:63]
s_nop 7
v_add_f32_dpp v60, v60, v60 row_ror:4 row_mask:0xf bank_mask:0xf
v_add_f32_dpp v61, v61, v61 row_ror:4 row_mask:0xf bank_mask:0xf
s_branch C_RT15
C_OF05:
s_sub_u32 s45, s45, 1
s_cbranch_scc1 END
s_waitcnt lgkmcnt(0)
s_barrier
s_barrier
ds_read_b128 v[60:63], v0 offset:4096
ds_read_b128 v[64:67], v0 offset:5120
s_waitcnt lgkmcnt(0)
v_bitop3_b32 v7, v60, v61, s44 bitop3:0x7e
v_bitop3_b32 v7, v62, v7, s44 bitop3:0xde
v_bitop3_b32 v7, v63, v7, s44 bitop3:0xde
v_bitop3_b32 v7, v64, v7, s44 bitop3:0xde
v_bitop3_b32 v7, v65, v7, s44 bitop3:0xde
v_bitop3_b32 v7, v66, v7, s44 bitop3:0xde
v_bitop3_b32 v7, v67, v7, s44 bitop3:0xde
v_and_b32 v7, 1, v7
v_cmp_eq_u32 vcc, s59, v7
s_cbranch_vccnz C_OF05
s_branch C_OK05
C_OF15:
s_sub_u32 s45, s45, 1
s_cbranch_scc1 END
s_waitcnt lgkmcnt(0)
s_barrier
s_barrier
ds_read_b128 v[68:71], v0 offset:6144
ds_read_b128 v[72:75], v0 offset:7168
ds_read_b128 v[76:79], v0 offset:8192
s_waitcnt lgkmcnt(0)
v_bitop3_b32 v13, v68, v69, s44 bitop3:0x7e
v_bitop3_b32 v13, v70, v13, s44 bitop3:0xde
v_bitop3_b32 v13, v71, v13, s44 bitop3:0xde
v_bitop3_b32 v13, v72, v13, s44 bitop3:0xde
v_bitop3_b32 v13, v73, v13, s44 bitop3:0xde
v_bitop3_b32 v13, v74, v13, s44 bitop3:0xde
v_bitop3_b32 v13, v75, v13, s44 bitop3:0xde
v_bitop3_b32 v13, v76, v13, s44 bitop3:0xde
v_bitop3_b32 v13, v77, v13, s44 bitop3:0xde
v_bitop3_b32 v13, v78, v13, s44 bitop3:0xde
v_bitop3_b32 v13, v79, v13, s44 bitop3:0xde
v_and_b32 v13, 1, v13
v_cmp_eq_u32 vcc, s59, v13
s_cbranch_vccnz C_OF15
s_branch C_OK15
C_RF5:
s_sub_u32 s45, s45, 1
s_cbranch_scc1 END
buffer_load_dword v5, off, s[8:11], s70 sc1
s_waitcnt vmcnt(0)
s_branch C_FW5
C_FB5:
ds_read_b128 v[28:31], v0 offset:13312
ds_read_b128 v[24:27], v0 offset:10240
ds_read_b128 v[16:19], v0 offset:9216
ds_read_b128 v[40:43], v0 offset:12288
ds_read_b128 v[44:47], v0 offset:11264
v_mov_b32 v20, 0x3f003f00
v_mov_b32 v21, 0x3f003f00
s_waitcnt lgkmcnt(0)
v_pk_add_f32 v[28:29], v[28:29], v[30:31]
v_add_f32 v28, v28, v29
v_mul_f32 v28, s72, v28
v_mul_f32 v24, s72, v24
v_mul_f32 v25, s72, v25
v_mul_f32 v26, s72, v26
v_mul_f32 v27, s72, v27
v_pk_fma_f32 v[24:25], v[16:17], s[72:73], v[24:25]
v_pk_fma_f32 v[26:27], v[18:19], s[72:73], v[26:27]
v_pk_fma_f32 v[24:25], v[40:41], s[72:73], v[24:25]
v_pk_fma_f32 v[26:27], v[42:43], s[72:73], v[26:27]
v_pk_fma_f32 v[24:25], v[44:45], s[72:73], v[24:25]
v_pk_fma_f32 v[26:27], v[46:47], s[72:73], v[26:27]
v_max3_f32 v36, v24, v25, v26
v_max3_f32 v36, v36, v27, v28
s_nop 1
v_max_f32_dpp v36, v36, v36 quad_perm:[2,3,0,1] row_mask:0xf bank_mask:0xf
v_mov_b32 v37, v36
s_nop 1
v_permlane16_swap_b32 v36, v37
v_max_f32 v36, v36, v37
v_mov_b32 v37, v36
s_nop 1
v_permlane32_swap_b32 v36, v37
v_max_f32 v36, v36, v37
v_sub_f32 v24, v24, v36
v_sub_f32 v25, v25, v36
v_sub_f32 v26, v26, v36
v_sub_f32 v27, v27, v36
v_sub_f32 v28, v28, v36
v_exp_f32 v29, v28
s_nop 0
v_cvt_pk_bf16_f32 v30, v29, v29
s_nop 1
v_mov_b32_dpp v31, v30 quad_perm:[2,3,0,1] row_mask:0xf bank_mask:0xf
v_exp_f32 v24, v24
s_nop 0
v_mfma_f32_16x16x16_bf16 v[40:43], v[32:33], v[30:31], 0
v_exp_f32 v25, v25
v_mfma_f32_16x16x16_bf16 v[44:47], v[34:35], v[30:31], 0
v_exp_f32 v26, v26
v_mfma_f32_16x16x16_bf16 v[36:39], v[20:21], v[30:31], 0
v_exp_f32 v27, v27
v_cvt_pk_bf16_f32 v16, v24, v25
v_cvt_pk_bf16_f32 v17, v26, v27
v_mov_b64 v[22:23], 0
v_mov_b32_dpp v18, v16 quad_perm:[2,3,0,1] row_mask:0xf bank_mask:0xf
v_mov_b32_dpp v19, v17 quad_perm:[2,3,0,1] row_mask:0xf bank_mask:0xf
v_mov_b64 v[24:25], 0
v_mov_b64 v[26:27], 0
v_mfma_f32_16x16x32_bf16 v[36:39], v[12:15], v[16:19], v[36:39]
v_mov_b32 v20, 0
v_mov_b32 v21, 0
v_mfma_f32_16x16x32_bf16 v[40:43], v[48:51], v[16:19], v[40:43]
v_mov_b32 v28, 0
v_mov_b32 v29, 0
v_mfma_f32_16x16x32_bf16 v[44:47], v[52:55], v[16:19], v[44:47]
v_rcp_f32 v38, v36
s_nop 2
v_pk_mul_f32 v[40:41], v[40:41], v[38:39] op_sel_hi:[1,0]
v_pk_mul_f32 v[42:43], v[42:43], v[38:39] op_sel_hi:[1,0]
v_cvt_pk_bf16_f32 v40, v40, v41
v_cvt_pk_bf16_f32 v41, v42, v43
v_pk_mul_f32 v[44:45], v[44:45], v[38:39] op_sel_hi:[1,0]
v_pk_mul_f32 v[46:47], v[46:47], v[38:39] op_sel_hi:[1,0]
s_mov_b64 exec, s[62:63]
v_cvt_pk_bf16_f32 v42, v44, v45
v_cvt_pk_bf16_f32 v43, v46, v47
ds_write_b128 v3, v[40:43] offset:512
s_mov_b64 exec, -1
v_mov_b32_dpp v40, v40 quad_perm:[2,3,2,3] row_mask:0xf bank_mask:0xf
v_mov_b32_dpp v41, v41 quad_perm:[2,3,2,3] row_mask:0xf bank_mask:0xf
v_mov_b32_dpp v42, v42 quad_perm:[2,3,2,3] row_mask:0xf bank_mask:0xf
v_mov_b32_dpp v43, v43 quad_perm:[2,3,2,3] row_mask:0xf bank_mask:0xf
s_waitcnt lgkmcnt(0)
s_nop 1
s_branch C_FBOK5
C_RA6:
s_sub_u32 s45, s45, 1
s_cbranch_scc1 END
s_waitcnt vmcnt(0) lgkmcnt(0)
s_barrier
C_ENTRY6:
s_nop 7
v_mov_b32 v16, 0
v_mov_b32 v17, 0
v_mov_b32 v18, 0
v_mov_b32 v19, 0
v_mov_b32 v20, 0
v_mov_b32 v21, 0
v_mov_b32 v22, 0
v_mov_b32 v23, 0
v_mov_b32 v24, 0
v_mov_b32 v25, 0
v_mov_b32 v26, 0
v_mov_b32 v27, 0
v_mov_b32 v28, 0
v_mov_b32 v29, 0
v_mov_b32 v30, 0
v_mov_b32 v31, 0
v_mov_b32 v32, 0
v_mov_b32 v33, 0
v_mov_b32 v34, 0
v_mov_b32 v35, 0
v_mov_b32 v36, 0
v_mov_b32 v37, 0
v_mov_b32 v38, 0
v_mov_b32 v39, 0
ds_read_b128 v[64:67], v6 offset:24576
ds_read_b128 v[68:71], v6 offset:25600
ds_read_b128 v[72:75], v6 offset:26624
ds_read_b128 v[76:79], v6 offset:27648
s_waitcnt vmcnt(0)
C_A6:
s_barrier
ds_read_b128 v[56:59], v0 offset:0
ds_read_b128 v[60:63], v0 offset:1024
buffer_load_dwordx4 v0, s[8:11], s74 offen offset:0 sc1 lds
buffer_load_dwordx4 v0, s[8:11], s74 offen offset:1024 sc1 lds
s_waitcnt lgkmcnt(1)
v_smfmac_f32_16x16x64_bf16 v[16:19], v[56:59], v[80:87], v4
v_smfmac_f32_16x16x64_bf16 v[20:23], v[56:59], v[224:231], v4
v_smfmac_f32_16x16x64_bf16 v[24:27], v[56:59], v[88:95], v4
buffer_load_dwordx4 v[40:43], v0, s[8:11], s67 offen offset:0
v_smfmac_f32_16x16x64_bf16 v[28:31], v[56:59], v[232:239], v4
buffer_load_dwordx4 v[44:47], v0, s[8:11], s67 offen offset:1024
v_lshl_add_u32 v5, v0, 3, s5
v_smfmac_f32_16x16x64_bf16 v[32:35], v[56:59], v[64:71], v4
ds_read_b128 v[64:67], v6 offset:28672
ds_read_b128 v[68:71], v6 offset:29696
v_smfmac_f32_16x16x64_bf16 v[36:39], v[56:59], v[72:79], v4
ds_read_b128 v[72:75], v6 offset:30720
ds_read_b128 v[76:79], v6 offset:31744
s_waitcnt lgkmcnt(4)
v_smfmac_f32_16x16x64_bf16 v[16:19], v[60:63], v[96:103], v4
s_barrier
ds_read_b128 v[12:15], v0 offset:2048
v_smfmac_f32_16x16x64_bf16 v[20:23], v[60:63], v[240:247], v4
ds_read_b128 v[56:59], v0 offset:3072
v_smfmac_f32_16x16x64_bf16 v[24:27], v[60:63], v[104:111], v4
buffer_load_dwordx4 v[48:51], v0, s[8:11], s67 offen offset:2048
v_smfmac_f32_16x16x64_bf16 v[28:31], v[60:63], v[248:255], v4
buffer_load_dwordx4 v[52:55], v0, s[8:11], s67 offen offset:3072
s_waitcnt lgkmcnt(4)
v_smfmac_f32_16x16x64_bf16 v[32:35], v[60:63], v[64:71], v4
ds_read_b128 v[64:67], v6 offset:32768
ds_read_b128 v[68:71], v6 offset:33792
s_waitcnt lgkmcnt(4)
v_smfmac_f32_16x16x64_bf16 v[36:39], v[60:63], v[72:79], v4
ds_read_b128 v[72:75], v6 offset:34816
ds_read_b128 v[76:79], v6 offset:35840
s_waitcnt lgkmcnt(5)
v_smfmac_f32_16x16x64_bf16 v[16:19], v[12:15], v[112:119], v4
s_waitcnt lgkmcnt(4)
v_bitop3_b32 v7, v12, v13, s44 bitop3:0x7e
v_bitop3_b32 v7, v14, v7, s44 bitop3:0xde
v_bitop3_b32 v7, v15, v7, s44 bitop3:0xde
v_bitop3_b32 v7, v56, v7, s44 bitop3:0xde
v_bitop3_b32 v7, v57, v7, s44 bitop3:0xde
v_bitop3_b32 v7, v58, v7, s44 bitop3:0xde
v_bitop3_b32 v7, v59, v7, s44 bitop3:0xde
v_smfmac_f32_16x16x64_bf16 v[20:23], v[12:15], a[0:7], v4
v_and_b32 v7, 1, v7
s_waitcnt lgkmcnt(2)
v_smfmac_f32_16x16x64_bf16 v[32:35], v[12:15], v[64:71], v4
s_waitcnt vmcnt(4)
s_barrier
ds_read_b128 v[60:63], v0 offset:4096
ds_read_b128 v[64:67], v0 offset:5120
v_cmp_eq_u32 vcc, s59, v7
s_waitcnt lgkmcnt(2)
v_smfmac_f32_16x16x64_bf16 v[36:39], v[12:15], v[72:79], v4
v_smfmac_f32_16x16x64_bf16 v[24:27], v[12:15], v[120:127], v4
s_cbranch_vccnz C_RA6
buffer_load_dword v5, v5, s[8:11], s67 offen
v_smfmac_f32_16x16x64_bf16 v[28:31], v[12:15], a[8:15], v4
v_smfmac_f32_16x16x64_bf16 v[16:19], v[56:59], v[128:135], v4
s_waitcnt lgkmcnt(0)
v_bitop3_b32 v7, v60, v61, s44 bitop3:0x7e
v_bitop3_b32 v7, v62, v7, s44 bitop3:0xde
v_bitop3_b32 v7, v63, v7, s44 bitop3:0xde
v_bitop3_b32 v7, v64, v7, s44 bitop3:0xde
v_bitop3_b32 v7, v65, v7, s44 bitop3:0xde
v_bitop3_b32 v7, v66, v7, s44 bitop3:0xde
v_bitop3_b32 v7, v67, v7, s44 bitop3:0xde
v_smfmac_f32_16x16x64_bf16 v[20:23], v[56:59], a[16:23], v4
v_and_b32 v7, 1, v7
v_smfmac_f32_16x16x64_bf16 v[24:27], v[56:59], v[136:143], v4
v_cmp_eq_u32 vcc, s59, v7
v_smfmac_f32_16x16x64_bf16 v[28:31], v[56:59], a[24:31], v4
s_cbranch_vccnz C_OF06
C_OK06:
s_barrier
ds_read_b128 v[68:71], v0 offset:6144
v_smfmac_f32_16x16x64_bf16 v[16:19], v[60:63], v[144:151], v4
ds_read_b128 v[72:75], v0 offset:7168
ds_read_b128 v[76:79], v0 offset:8192
v_smfmac_f32_16x16x64_bf16 v[20:23], v[60:63], a[32:39], v4
v_smfmac_f32_16x16x64_bf16 v[24:27], v[60:63], v[152:159], v4
v_smfmac_f32_16x16x64_bf16 v[28:31], v[60:63], a[40:47], v4
s_waitcnt lgkmcnt(1)
s_waitcnt lgkmcnt(0)
v_bitop3_b32 v13, v68, v69, s44 bitop3:0x7e
v_bitop3_b32 v13, v70, v13, s44 bitop3:0xde
v_bitop3_b32 v13, v71, v13, s44 bitop3:0xde
v_bitop3_b32 v13, v72, v13, s44 bitop3:0xde
v_bitop3_b32 v13, v73, v13, s44 bitop3:0xde
v_bitop3_b32 v13, v74, v13, s44 bitop3:0xde
v_bitop3_b32 v13, v75, v13, s44 bitop3:0xde
v_bitop3_b32 v13, v76, v13, s44 bitop3:0xde
v_bitop3_b32 v13, v77, v13, s44 bitop3:0xde
v_bitop3_b32 v13, v78, v13, s44 bitop3:0xde
v_smfmac_f32_16x16x64_bf16 v[16:19], v[64:67], v[160:167], v4
v_bitop3_b32 v13, v79, v13, s44 bitop3:0xde
v_smfmac_f32_16x16x64_bf16 v[20:23], v[64:67], a[48:55], v4
v_and_b32 v13, 1, v13
v_smfmac_f32_16x16x64_bf16 v[24:27], v[64:67], v[168:175], v4
v_cmp_eq_u32 vcc, s59, v13
v_smfmac_f32_16x16x64_bf16 v[28:31], v[64:67], a[56:63], v4
s_cbranch_vccnz C_OF16
C_OK16:
v_smfmac_f32_16x16x64_bf16 v[16:19], v[68:71], v[176:183], v4
v_smfmac_f32_16x16x64_bf16 v[20:23], v[68:71], a[64:71], v4
s_add_u32 s67, s67, 524288
s_mov_b32 s74, s66
v_smfmac_f32_16x16x64_bf16 v[16:19], v[72:75], v[192:199], v4
v_smfmac_f32_16x16x64_bf16 v[20:23], v[72:75], a[80:87], v4
v_smfmac_f32_16x16x64_bf16 v[16:19], v[76:79], v[208:215], v4
v_smfmac_f32_16x16x64_bf16 v[20:23], v[76:79], a[96:103], v4
s_xor_b32 s44, s44, -1
s_mov_b32 s59, 1
v_smfmac_f32_16x16x64_bf16 v[24:27], v[68:71], v[184:191], v4
v_cvt_pk_bf16_f32 v16, v16, v17
v_smfmac_f32_16x16x64_bf16 v[24:27], v[72:75], v[200:207], v4
v_cvt_pk_bf16_f32 v17, v18, v19
v_smfmac_f32_16x16x64_bf16 v[24:27], v[76:79], v[216:223], v4
v_cvt_pk_bf16_f32 v18, v20, v21
v_smfmac_f32_16x16x64_bf16 v[28:31], v[68:71], a[72:79], v4
v_cvt_pk_bf16_f32 v19, v22, v23
v_smfmac_f32_16x16x64_bf16 v[28:31], v[72:75], a[88:95], v4
v_cvt_pk_bf16_f32 v24, v24, v25
v_smfmac_f32_16x16x64_bf16 v[28:31], v[76:79], a[104:111], v4
v_cvt_pk_bf16_f32 v25, v26, v27
v_mfma_f32_16x16x32_bf16 v[20:23], v[16:19], v[8:11], 0
s_nop 3
v_cvt_pk_bf16_f32 v26, v28, v29
v_cvt_pk_bf16_f32 v27, v30, v31
s_nop 1
v_mfma_f32_16x16x32_bf16 v[28:31], v[24:27], v[8:11], 0
v_cvt_pk_bf16_f32 v16, v20, v21
v_cvt_pk_bf16_f32 v17, v22, v23
v_smfmac_f32_16x16x64_bf16 v[32:35], v[72:75], a[224:231], v4
s_waitcnt vmcnt(3)
s_mov_b64 vcc, s[62:63]
s_nop 1
v_cvt_pk_bf16_f32 v18, v28, v29
v_cvt_pk_bf16_f32 v19, v30, v31
s_nop 1
v_mfma_f32_16x16x32_bf16 v[24:27], v[44:47], v[16:19], 0
v_mfma_f32_16x16x32_bf16 v[20:23], v[40:43], v[16:19], 0
v_mfma_f32_16x16x32_bf16 v[28:31], v[16:19], v[16:19], 0
s_nop 3
v_cndmask_b32_dpp v20, v24, v20, vcc quad_perm:[2,3,2,3] row_mask:0xf bank_mask:0xf
v_cndmask_b32_dpp v21, v25, v21, vcc quad_perm:[2,3,2,3] row_mask:0xf bank_mask:0xf
v_cndmask_b32_dpp v22, v26, v22, vcc quad_perm:[2,3,2,3] row_mask:0xf bank_mask:0xf
v_cndmask_b32_dpp v23, v27, v23, vcc quad_perm:[2,3,2,3] row_mask:0xf bank_mask:0xf
v_smfmac_f32_16x16x64_bf16 v[36:39], v[72:75], a[232:239], v4
ds_write_b128 v0, v[20:23] offset:11264
v_cndmask_b32_dpp v28, v29, v28, vcc quad_perm:[2,3,2,3] row_mask:0xf bank_mask:0xf
v_smfmac_f32_16x16x64_bf16 v[32:35], v[76:79], a[240:247], v4
ds_write_b32 v0, v28 offset:13320
v_mul_f32 v24, s72, v20
v_smfmac_f32_16x16x64_bf16 v[36:39], v[76:79], a[248:255], v4
v_mul_f32 v25, s72, v21
v_smfmac_f32_16x16x64_bf16 v[32:35], v[64:67], a[192:199], v4
v_mul_f32 v26, s72, v22
v_smfmac_f32_16x16x64_bf16 v[36:39], v[64:67], a[200:207], v4
v_mul_f32 v27, s72, v23
v_smfmac_f32_16x16x64_bf16 v[32:35], v[68:71], a[208:215], v4
v_mov_b32 v12, 0x3f803f80
v_smfmac_f32_16x16x64_bf16 v[36:39], v[68:71], a[216:223], v4
s_waitcnt lgkmcnt(0)
s_barrier
ds_read_b128 v[28:31], v0 offset:13312
ds_read_b128 v[16:19], v0 offset:12288
v_smfmac_f32_16x16x64_bf16 v[32:35], v[56:59], a[160:167], v4
ds_read_b128 v[40:43], v0 offset:9216
ds_read_b128 v[44:47], v0 offset:10240
v_mov_b32 v13, 0x3f803f80
v_smfmac_f32_16x16x64_bf16 v[36:39], v[56:59], a[168:175], v4
ds_read_b128 v[72:75], v6 offset:0
ds_read_b128 v[76:79], v6 offset:1024
v_mov_b32 v14, 0x3f803f80
v_smfmac_f32_16x16x64_bf16 v[32:35], v[60:63], a[176:183], v4
ds_read_b128 v[64:67], v6 offset:4096
ds_read_b128 v[68:71], v6 offset:5120
v_mov_b32 v15, 0x3f803f80
v_smfmac_f32_16x16x64_bf16 v[36:39], v[60:63], a[184:191], v4
v_mov_b32 v20, 0x3f003f00
v_mov_b32 v21, 0x3f003f00
s_waitcnt lgkmcnt(7)
v_pk_add_f32 v[28:29], v[28:29], v[30:31]
v_add_f32 v28, v28, v29
v_mul_f32 v28, s72, v28
s_waitcnt lgkmcnt(6)
v_pk_fma_f32 v[24:25], v[16:17], s[72:73], v[24:25]
v_exp_f32 v29, v28
v_pk_fma_f32 v[26:27], v[18:19], s[72:73], v[26:27]
s_waitcnt lgkmcnt(5)
v_pk_fma_f32 v[24:25], v[40:41], s[72:73], v[24:25]
v_cvt_pk_bf16_f32 v30, v29, v29
v_pk_fma_f32 v[26:27], v[42:43], s[72:73], v[26:27]
s_waitcnt lgkmcnt(4)
v_pk_fma_f32 v[24:25], v[44:45], s[72:73], v[24:25]
v_mov_b32_dpp v31, v30 quad_perm:[2,3,0,1] row_mask:0xf bank_mask:0xf
v_pk_fma_f32 v[26:27], v[46:47], s[72:73], v[26:27]
v_cvt_pk_bf16_f32 v32, v32, v33
v_cvt_pk_bf16_f32 v33, v34, v35
v_cvt_pk_bf16_f32 v34, v36, v37
v_cvt_pk_bf16_f32 v35, v38, v39
v_exp_f32 v24, v24
v_mfma_f32_16x16x16_bf16 v[40:43], v[32:33], v[30:31], 0
ds_read_b128 v[56:59], v6 offset:12288
ds_read_b128 v[60:63], v6 offset:13312
v_exp_f32 v25, v25
v_mfma_f32_16x16x16_bf16 v[44:47], v[34:35], v[30:31], 0
s_waitcnt vmcnt(1)
v_exp_f32 v26, v26
v_mfma_f32_16x16x16_bf16 v[36:39], v[20:21], v[30:31], 0
v_exp_f32 v27, v27
v_cvt_pk_bf16_f32 v16, v24, v25
v_cvt_pk_bf16_f32 v17, v26, v27
v_mov_b64 v[22:23], 0
v_mov_b32_dpp v18, v16 quad_perm:[2,3,0,1] row_mask:0xf bank_mask:0xf
v_mov_b32_dpp v19, v17 quad_perm:[2,3,0,1] row_mask:0xf bank_mask:0xf
v_mov_b64 v[24:25], 0
v_mov_b64 v[26:27], 0
v_mfma_f32_16x16x32_bf16 v[36:39], v[12:15], v[16:19], v[36:39]
v_mov_b32 v20, 0
v_mov_b32 v21, 0
v_mfma_f32_16x16x32_bf16 v[40:43], v[48:51], v[16:19], v[40:43]
v_mov_b32 v28, 0
v_mov_b32 v29, 0
v_mfma_f32_16x16x32_bf16 v[44:47], v[52:55], v[16:19], v[44:47]
v_rcp_f32 v38, v36
s_nop 2
v_pk_mul_f32 v[40:41], v[40:41], v[38:39] op_sel_hi:[1,0]
v_pk_mul_f32 v[42:43], v[42:43], v[38:39] op_sel_hi:[1,0]
v_cvt_pk_bf16_f32 v40, v40, v41
v_cvt_pk_bf16_f32 v41, v42, v43
v_pk_mul_f32 v[44:45], v[44:45], v[38:39] op_sel_hi:[1,0]
v_pk_mul_f32 v[46:47], v[46:47], v[38:39] op_sel_hi:[1,0]
s_mov_b64 exec, s[62:63]
v_cvt_pk_bf16_f32 v42, v44, v45
v_cvt_pk_bf16_f32 v43, v46, v47
ds_write_b128 v3, v[40:43] offset:1024
s_mov_b64 exec, -1
v_max_f32 v36, v36, v38
v_cmp_nge_f32 vcc, s47, v36
v_mov_b32_dpp v40, v40 quad_perm:[2,3,2,3] row_mask:0xf bank_mask:0xf
v_mov_b32_dpp v41, v41 quad_perm:[2,3,2,3] row_mask:0xf bank_mask:0xf
v_mov_b32_dpp v42, v42 quad_perm:[2,3,2,3] row_mask:0xf bank_mask:0xf
v_mov_b32_dpp v43, v43 quad_perm:[2,3,2,3] row_mask:0xf bank_mask:0xf
s_cbranch_vccnz C_FB6
C_FBOK6:
v_mov_b64 v[30:31], 0
s_waitcnt lgkmcnt(5)
v_smfmac_f32_16x16x64_bf16 v[20:23], v[40:43], v[72:79], v4 abid:1
ds_read_b128 v[48:51], v6 offset:16384
ds_read_b128 v[52:55], v6 offset:17408
v_mov_b64 v[16:17], 0
s_waitcnt lgkmcnt(5)
v_smfmac_f32_16x16x64_bf16 v[24:27], v[40:43], v[64:71], v4 abid:1
ds_read_b128 v[72:75], v6 offset:2048
ds_read_b128 v[76:79], v6 offset:3072
v_mov_b64 v[18:19], 0
s_waitcnt lgkmcnt(4)
s_barrier
ds_read_b128 v[44:47], v3 offset:1536
ds_read_b128 v[36:39], v3 offset:0
ds_read_b128 v[12:15], v3 offset:512
v_smfmac_f32_16x16x64_bf16 v[28:31], v[40:43], v[56:63], v4 abid:1
ds_read_b128 v[64:67], v6 offset:6144
ds_read_b128 v[68:71], v6 offset:7168
v_mov_b64 v[32:33], 0
v_smfmac_f32_16x16x64_bf16 v[16:19], v[40:43], a[112:119], v4 abid:1
ds_read_b128 v[56:59], v6 offset:8192
ds_read_b128 v[60:63], v6 offset:9216
v_mov_b64 v[34:35], 0
s_waitcnt lgkmcnt(9)
s_nop 0
v_smfmac_f32_16x16x64_bf16 v[32:35], v[40:43], v[48:55], v4 abid:1
ds_read_b128 v[48:51], v6 offset:10240
ds_read_b128 v[52:55], v6 offset:11264
s_waitcnt lgkmcnt(8)
v_smfmac_f32_16x16x64_bf16 v[20:23], v[44:47], v[72:79], v4 abid:1
ds_read_b128 v[72:75], v6 offset:14336
ds_read_b128 v[76:79], v6 offset:15360
s_waitcnt lgkmcnt(9)
v_smfmac_f32_16x16x64_bf16 v[20:23], v[36:39], a[128:135], v4 abid:1
s_waitcnt lgkmcnt(8)
v_smfmac_f32_16x16x64_bf16 v[20:23], v[12:15], a[136:143], v4 abid:1
s_waitcnt lgkmcnt(6)
v_smfmac_f32_16x16x64_bf16 v[24:27], v[44:47], v[64:71], v4 abid:1
ds_read_b128 v[64:67], v6 offset:18432
ds_read_b128 v[68:71], v6 offset:19456
s_waitcnt lgkmcnt(6)
v_smfmac_f32_16x16x64_bf16 v[24:27], v[36:39], v[56:63], v4 abid:1
ds_read_b128 v[56:59], v6 offset:20480
ds_read_b128 v[60:63], v6 offset:21504
v_cvt_pk_bf16_f32 v20, v20, v21
v_bfi_b32 v20, 1, s44, v20
v_cvt_pk_bf16_f32 v22, v22, v23
v_bfi_b32 v22, 1, s44, v22
s_waitcnt lgkmcnt(6)
v_smfmac_f32_16x16x64_bf16 v[24:27], v[12:15], v[48:55], v4 abid:1
buffer_store_dword v20, v1, s[8:11], s50 offen sc1
buffer_store_dword v22, v1, s[8:11], s51 offen sc1
ds_read_b128 v[48:51], v6 offset:22528
ds_read_b128 v[52:55], v6 offset:23552
s_waitcnt lgkmcnt(6)
v_smfmac_f32_16x16x64_bf16 v[28:31], v[44:47], v[72:79], v4 abid:1
v_mov_b32 v21, 0xeeee
v_smfmac_f32_16x16x64_bf16 v[28:31], v[36:39], a[144:151], v4 abid:1
v_cvt_pk_bf16_f32 v24, v24, v25
v_bfi_b32 v24, 1, s44, v24
v_smfmac_f32_16x16x64_bf16 v[28:31], v[12:15], a[152:159], v4 abid:1
buffer_store_dword v24, v1, s[8:11], s52 offen sc1
v_cvt_pk_bf16_f32 v26, v26, v27
v_bfi_b32 v26, 1, s44, v26
s_waitcnt lgkmcnt(4)
v_smfmac_f32_16x16x64_bf16 v[32:35], v[44:47], v[64:71], v4 abid:1
buffer_store_dword v26, v1, s[8:11], s53 offen sc1
s_waitcnt lgkmcnt(2)
v_smfmac_f32_16x16x64_bf16 v[32:35], v[36:39], v[56:63], v4 abid:1
v_cvt_pk_bf16_f32 v28, v28, v29
v_bfi_b32 v28, 1, s44, v28
s_waitcnt lgkmcnt(0)
v_smfmac_f32_16x16x64_bf16 v[32:35], v[12:15], v[48:55], v4 abid:1
buffer_store_dword v28, v1, s[8:11], s54 offen sc1
v_cvt_pk_bf16_f32 v30, v30, v31
v_bfi_b32 v30, 1, s44, v30
v_smfmac_f32_16x16x64_bf16 v[16:19], v[44:47], a[112:119], v21
buffer_store_dword v30, v1, s[8:11], s55 offen sc1
v_smfmac_f32_16x16x64_bf16 v[16:19], v[36:39], a[120:127], v4 abid:1
v_cvt_pk_bf16_f32 v32, v32, v33
v_bfi_b32 v32, 1, s44, v32
v_smfmac_f32_16x16x64_bf16 v[16:19], v[12:15], a[120:127], v21
buffer_store_dword v32, v1, s[8:11], s56 offen sc1
v_cvt_pk_bf16_f32 v34, v34, v35
v_bfi_b32 v34, 1, s44, v34
buffer_store_dword v34, v1, s[8:11], s57 offen sc1
s_nop 3
v_cvt_pk_bf16_f32 v16, v16, v17
v_bfi_b32 v16, 1, s44, v16
buffer_store_dword v16, v1, s[8:11], s58 offen sc1
v_mov_b32 v60, 0x3f80
v_cndmask_b32 v60, v60, 1.0, s[32:33]
v_cndmask_b32 v56, 0, v60, s[24:25]
v_cndmask_b32 v57, 0, v60, s[26:27]
v_cndmask_b32 v58, 0, v60, s[28:29]
v_cndmask_b32 v59, 0, v60, s[30:31]
v_mov_b32 v20, 0
v_mov_b32 v21, 0
v_mov_b32 v22, 0
v_mov_b32 v23, 0
v_mov_b32 v24, 0
v_mov_b32 v25, 0
v_mov_b32 v26, 0
v_mov_b32 v27, 0
v_mov_b32 v28, 0
v_mov_b32 v29, 0
v_mov_b32 v30, 0
v_mov_b32 v31, 0
v_mov_b32 v32, 0
v_mov_b32 v33, 0
v_mov_b32 v34, 0
v_mov_b32 v35, 0
v_mov_b32 v36, 0
v_mov_b32 v37, 0
v_mov_b32 v38, 0
v_mov_b32 v39, 0
v_mov_b32 v17, 0
v_mov_b32 v18, 0
v_mov_b32 v19, 0
v_mov_b32 v16, 0
s_waitcnt vmcnt(1)
buffer_load_dwordx4 v[72:75], v0, s[8:11], s64 offen offset:0 sc1
buffer_load_dwordx4 v[76:79], v0, s[8:11], s64 offen offset:1024 sc1
s_waitcnt vmcnt(1)
v_mfma_f32_16x16x32_bf16 v[60:63], v[56:59], v[72:75], 0
s_waitcnt vmcnt(0)
v_mfma_f32_16x16x32_bf16 v[60:63], v[56:59], v[76:79], v[60:63]
v_bitop3_b32 v12, v72, v73, s44 bitop3:0x7e
v_bitop3_b32 v13, v74, v75, s44 bitop3:0x7e
v_bitop3_b32 v14, v76, v77, s44 bitop3:0x7e
v_bitop3_b32 v15, v78, v79, s44 bitop3:0x7e
v_or3_b32 v12, v12, v13, v14
v_bitop3_b32 v12, v12, v15, 1 bitop3:0xa8
v_cmp_ne_u32 vcc, 0, v12
s_nop 0
v_add_f32_dpp v60, v60, v60 row_ror:4 row_mask:0xf bank_mask:0xf
v_add_f32_dpp v61, v61, v61 row_ror:4 row_mask:0xf bank_mask:0xf
s_cbranch_vccnz C_RR06
C_RT06:
v_add_f32_dpp v60, v60, v60 row_ror:8 row_mask:0xf bank_mask:0xf
v_add_f32_dpp v61, v61, v61 row_ror:8 row_mask:0xf bank_mask:0xf
s_mov_b64 exec, s[60:61]
v_cvt_pk_bf16_f32 v60, v60, v61
v_bfi_b32 v60, 1, s44, v60
buffer_store_dword v60, v2, s[8:11], 0 offen sc1
s_mov_b64 exec, -1
s_add_u32 s43, s43, 1
s_cmp_eq_u32 s43, 63
s_cbranch_scc1 C_X6
s_waitcnt vmcnt(1)
ds_read_b128 v[64:67], v6 offset:24576
ds_read_b128 v[68:71], v6 offset:25600
ds_read_b128 v[72:75], v6 offset:26624
ds_read_b128 v[76:79], v6 offset:27648
s_barrier
s_branch C_A6
C_X6:
s_waitcnt vmcnt(0) lgkmcnt(0)
s_branch END
C_RR06:
s_mov_b64 exec, vcc
buffer_load_dwordx4 v[72:75], v0, s[8:11], s64 offen offset:0 sc1
buffer_load_dwordx4 v[76:79], v0, s[8:11], s64 offen offset:1024 sc1
s_mov_b64 exec, -1
C_RL06:
s_mov_b64 exec, vcc
buffer_load_dwordx4 v[72:75], v0, s[8:11], s64 offen offset:0 sc1
buffer_load_dwordx4 v[76:79], v0, s[8:11], s64 offen offset:1024 sc1
s_mov_b64 exec, -1
s_sub_u32 s45, s45, 1
s_cbranch_scc1 END
s_waitcnt vmcnt(2)
v_bitop3_b32 v12, v72, v73, s44 bitop3:0x7e
v_bitop3_b32 v13, v74, v75, s44 bitop3:0x7e
v_bitop3_b32 v14, v76, v77, s44 bitop3:0x7e
v_bitop3_b32 v15, v78, v79, s44 bitop3:0x7e
v_or3_b32 v12, v12, v13, v14
v_bitop3_b32 v12, v12, v15, 1 bitop3:0xa8
v_cmp_ne_u32 vcc, 0, v12
s_cbranch_vccnz C_RL06
C_RM06:
v_mfma_f32_16x16x32_bf16 v[60:63], v[56:59], v[72:75], 0
v_mfma_f32_16x16x32_bf16 v[60:63], v[56:59], v[76:79], v[60:63]
s_nop 7
v_add_f32_dpp v60, v60, v60 row_ror:4 row_mask:0xf bank_mask:0xf
v_add_f32_dpp v61, v61, v61 row_ror:4 row_mask:0xf bank_mask:0xf
s_branch C_RT06
C_OF06:
s_sub_u32 s45, s45, 1
s_cbranch_scc1 END
s_waitcnt lgkmcnt(0)
s_barrier
buffer_load_dwordx4 v0, s[8:11], s74 offen offset:0 sc1 lds
buffer_load_dwordx4 v0, s[8:11], s74 offen offset:1024 sc1 lds
s_waitcnt vmcnt(0)
s_barrier
ds_read_b128 v[60:63], v0 offset:4096
ds_read_b128 v[64:67], v0 offset:5120
s_waitcnt lgkmcnt(0)
v_bitop3_b32 v7, v60, v61, s44 bitop3:0x7e
v_bitop3_b32 v7, v62, v7, s44 bitop3:0xde
v_bitop3_b32 v7, v63, v7, s44 bitop3:0xde
v_bitop3_b32 v7, v64, v7, s44 bitop3:0xde
v_bitop3_b32 v7, v65, v7, s44 bitop3:0xde
v_bitop3_b32 v7, v66, v7, s44 bitop3:0xde
v_bitop3_b32 v7, v67, v7, s44 bitop3:0xde
v_and_b32 v7, 1, v7
v_cmp_eq_u32 vcc, s59, v7
s_cbranch_vccnz C_OF06
s_branch C_OK06
C_OF16:
s_sub_u32 s45, s45, 1
s_cbranch_scc1 END
s_waitcnt lgkmcnt(0)
s_barrier
s_barrier
ds_read_b128 v[68:71], v0 offset:6144
ds_read_b128 v[72:75], v0 offset:7168
ds_read_b128 v[76:79], v0 offset:8192
s_waitcnt lgkmcnt(0)
v_bitop3_b32 v13, v68, v69, s44 bitop3:0x7e
v_bitop3_b32 v13, v70, v13, s44 bitop3:0xde
v_bitop3_b32 v13, v71, v13, s44 bitop3:0xde
v_bitop3_b32 v13, v72, v13, s44 bitop3:0xde
v_bitop3_b32 v13, v73, v13, s44 bitop3:0xde
v_bitop3_b32 v13, v74, v13, s44 bitop3:0xde
v_bitop3_b32 v13, v75, v13, s44 bitop3:0xde
v_bitop3_b32 v13, v76, v13, s44 bitop3:0xde
v_bitop3_b32 v13, v77, v13, s44 bitop3:0xde
v_bitop3_b32 v13, v78, v13, s44 bitop3:0xde
v_bitop3_b32 v13, v79, v13, s44 bitop3:0xde
v_and_b32 v13, 1, v13
v_cmp_eq_u32 vcc, s59, v13
s_cbranch_vccnz C_OF16
s_branch C_OK16
s_nop 2
C_FB6:
ds_read_b128 v[28:31], v0 offset:13312
ds_read_b128 v[24:27], v0 offset:11264
ds_read_b128 v[16:19], v0 offset:12288
ds_read_b128 v[40:43], v0 offset:9216
ds_read_b128 v[44:47], v0 offset:10240
v_mov_b32 v20, 0x3f003f00
v_mov_b32 v21, 0x3f003f00
s_waitcnt lgkmcnt(0)
v_pk_add_f32 v[28:29], v[28:29], v[30:31]
v_add_f32 v28, v28, v29
v_mul_f32 v28, s72, v28
v_mul_f32 v24, s72, v24
v_mul_f32 v25, s72, v25
v_mul_f32 v26, s72, v26
v_mul_f32 v27, s72, v27
v_pk_fma_f32 v[24:25], v[16:17], s[72:73], v[24:25]
v_pk_fma_f32 v[26:27], v[18:19], s[72:73], v[26:27]
v_pk_fma_f32 v[24:25], v[40:41], s[72:73], v[24:25]
v_pk_fma_f32 v[26:27], v[42:43], s[72:73], v[26:27]
v_pk_fma_f32 v[24:25], v[44:45], s[72:73], v[24:25]
v_pk_fma_f32 v[26:27], v[46:47], s[72:73], v[26:27]
v_max3_f32 v36, v24, v25, v26
v_max3_f32 v36, v36, v27, v28
s_nop 1
v_max_f32_dpp v36, v36, v36 quad_perm:[2,3,0,1] row_mask:0xf bank_mask:0xf
v_mov_b32 v37, v36
s_nop 1
v_permlane16_swap_b32 v36, v37
v_max_f32 v36, v36, v37
v_mov_b32 v37, v36
s_nop 1
v_permlane32_swap_b32 v36, v37
v_max_f32 v36, v36, v37
v_sub_f32 v24, v24, v36
v_sub_f32 v25, v25, v36
v_sub_f32 v26, v26, v36
v_sub_f32 v27, v27, v36
v_sub_f32 v28, v28, v36
v_exp_f32 v29, v28
s_nop 0
v_cvt_pk_bf16_f32 v30, v29, v29
s_nop 1
v_mov_b32_dpp v31, v30 quad_perm:[2,3,0,1] row_mask:0xf bank_mask:0xf
v_exp_f32 v24, v24
s_nop 0
v_mfma_f32_16x16x16_bf16 v[40:43], v[32:33], v[30:31], 0
v_exp_f32 v25, v25
v_mfma_f32_16x16x16_bf16 v[44:47], v[34:35], v[30:31], 0
v_exp_f32 v26, v26
v_mfma_f32_16x16x16_bf16 v[36:39], v[20:21], v[30:31], 0
v_exp_f32 v27, v27
v_cvt_pk_bf16_f32 v16, v24, v25
v_cvt_pk_bf16_f32 v17, v26, v27
v_mov_b64 v[22:23], 0
v_mov_b32_dpp v18, v16 quad_perm:[2,3,0,1] row_mask:0xf bank_mask:0xf
v_mov_b32_dpp v19, v17 quad_perm:[2,3,0,1] row_mask:0xf bank_mask:0xf
v_mov_b64 v[24:25], 0
v_mov_b64 v[26:27], 0
v_mfma_f32_16x16x32_bf16 v[36:39], v[12:15], v[16:19], v[36:39]
v_mov_b32 v20, 0
v_mov_b32 v21, 0
v_mfma_f32_16x16x32_bf16 v[40:43], v[48:51], v[16:19], v[40:43]
v_mov_b32 v28, 0
v_mov_b32 v29, 0
v_mfma_f32_16x16x32_bf16 v[44:47], v[52:55], v[16:19], v[44:47]
v_rcp_f32 v38, v36
s_nop 2
v_pk_mul_f32 v[40:41], v[40:41], v[38:39] op_sel_hi:[1,0]
v_pk_mul_f32 v[42:43], v[42:43], v[38:39] op_sel_hi:[1,0]
v_cvt_pk_bf16_f32 v40, v40, v41
v_cvt_pk_bf16_f32 v41, v42, v43
v_pk_mul_f32 v[44:45], v[44:45], v[38:39] op_sel_hi:[1,0]
v_pk_mul_f32 v[46:47], v[46:47], v[38:39] op_sel_hi:[1,0]
s_mov_b64 exec, s[62:63]
v_cvt_pk_bf16_f32 v42, v44, v45
v_cvt_pk_bf16_f32 v43, v46, v47
ds_write_b128 v3, v[40:43] offset:1024
s_mov_b64 exec, -1
v_mov_b32_dpp v40, v40 quad_perm:[2,3,2,3] row_mask:0xf bank_mask:0xf
v_mov_b32_dpp v41, v41 quad_perm:[2,3,2,3] row_mask:0xf bank_mask:0xf
v_mov_b32_dpp v42, v42 quad_perm:[2,3,2,3] row_mask:0xf bank_mask:0xf
v_mov_b32_dpp v43, v43 quad_perm:[2,3,2,3] row_mask:0xf bank_mask:0xf
s_waitcnt lgkmcnt(0)
s_nop 1
s_branch C_FBOK6
C_RA7:
s_sub_u32 s45, s45, 1
s_cbranch_scc1 END
s_waitcnt vmcnt(0) lgkmcnt(0)
s_barrier
C_ENTRY7:
s_nop 7
v_mov_b32 v16, 0
v_mov_b32 v17, 0
v_mov_b32 v18, 0
v_mov_b32 v19, 0
v_mov_b32 v20, 0
v_mov_b32 v21, 0
v_mov_b32 v22, 0
v_mov_b32 v23, 0
v_mov_b32 v24, 0
v_mov_b32 v25, 0
v_mov_b32 v26, 0
v_mov_b32 v27, 0
v_mov_b32 v28, 0
v_mov_b32 v29, 0
v_mov_b32 v30, 0
v_mov_b32 v31, 0
v_mov_b32 v32, 0
v_mov_b32 v33, 0
v_mov_b32 v34, 0
v_mov_b32 v35, 0
v_mov_b32 v36, 0
v_mov_b32 v37, 0
v_mov_b32 v38, 0
v_mov_b32 v39, 0
ds_read_b128 v[64:67], v6 offset:24576
ds_read_b128 v[68:71], v6 offset:25600
ds_read_b128 v[72:75], v6 offset:26624
ds_read_b128 v[76:79], v6 offset:27648
s_waitcnt vmcnt(0)
C_A7:
s_barrier
ds_read_b128 v[56:59], v0 offset:0
ds_read_b128 v[60:63], v0 offset:1024
s_waitcnt lgkmcnt(1)
v_smfmac_f32_16x16x64_bf16 v[16:19], v[56:59], v[80:87], v4
v_smfmac_f32_16x16x64_bf16 v[20:23], v[56:59], v[224:231], v4
v_smfmac_f32_16x16x64_bf16 v[24:27], v[56:59], v[88:95], v4
buffer_load_dwordx4 v[40:43], v0, s[8:11], s67 offen offset:0
v_smfmac_f32_16x16x64_bf16 v[28:31], v[56:59], v[232:239], v4
buffer_load_dwordx4 v[44:47], v0, s[8:11], s67 offen offset:1024
v_mov_b32 v5, s43
v_smfmac_f32_16x16x64_bf16 v[32:35], v[56:59], v[64:71], v4
ds_read_b128 v[64:67], v6 offset:28672
ds_read_b128 v[68:71], v6 offset:29696
v_smfmac_f32_16x16x64_bf16 v[36:39], v[56:59], v[72:79], v4
buffer_load_dwordx4 v0, s[8:11], s74 offen offset:0 sc1 lds
buffer_load_dwordx4 v0, s[8:11], s74 offen offset:1024 sc1 lds
ds_read_b128 v[72:75], v6 offset:30720
ds_read_b128 v[76:79], v6 offset:31744
s_waitcnt lgkmcnt(4)
v_smfmac_f32_16x16x64_bf16 v[16:19], v[60:63], v[96:103], v4
s_barrier
ds_read_b128 v[12:15], v0 offset:2048
v_smfmac_f32_16x16x64_bf16 v[20:23], v[60:63], v[240:247], v4
ds_read_b128 v[56:59], v0 offset:3072
v_smfmac_f32_16x16x64_bf16 v[24:27], v[60:63], v[104:111], v4
buffer_load_dwordx4 v[48:51], v0, s[8:11], s67 offen offset:2048
v_smfmac_f32_16x16x64_bf16 v[28:31], v[60:63], v[248:255], v4
buffer_load_dwordx4 v[52:55], v0, s[8:11], s67 offen offset:3072
s_waitcnt lgkmcnt(4)
v_smfmac_f32_16x16x64_bf16 v[32:35], v[60:63], v[64:71], v4
ds_read_b128 v[64:67], v6 offset:32768
ds_read_b128 v[68:71], v6 offset:33792
s_waitcnt lgkmcnt(4)
v_smfmac_f32_16x16x64_bf16 v[36:39], v[60:63], v[72:79], v4
ds_read_b128 v[72:75], v6 offset:34816
ds_read_b128 v[76:79], v6 offset:35840
s_waitcnt lgkmcnt(5)
v_smfmac_f32_16x16x64_bf16 v[16:19], v[12:15], v[112:119], v4
s_waitcnt lgkmcnt(4)
v_bitop3_b32 v7, v12, v13, s44 bitop3:0x7e
v_bitop3_b32 v7, v14, v7, s44 bitop3:0xde
v_bitop3_b32 v7, v15, v7, s44 bitop3:0xde
v_bitop3_b32 v7, v56, v7, s44 bitop3:0xde
v_bitop3_b32 v7, v57, v7, s44 bitop3:0xde
v_bitop3_b32 v7, v58, v7, s44 bitop3:0xde
v_bitop3_b32 v7, v59, v7, s44 bitop3:0xde
v_smfmac_f32_16x16x64_bf16 v[20:23], v[12:15], a[0:7], v4
v_and_b32 v7, 1, v7
s_waitcnt lgkmcnt(2)
v_smfmac_f32_16x16x64_bf16 v[32:35], v[12:15], v[64:71], v4
s_barrier
ds_read_b128 v[60:63], v0 offset:4096
ds_read_b128 v[64:67], v0 offset:5120
v_cmp_eq_u32 vcc, s59, v7
s_waitcnt lgkmcnt(2)
v_smfmac_f32_16x16x64_bf16 v[36:39], v[12:15], v[72:79], v4
v_smfmac_f32_16x16x64_bf16 v[24:27], v[12:15], v[120:127], v4
s_cbranch_vccnz C_RA7
v_smfmac_f32_16x16x64_bf16 v[28:31], v[12:15], a[8:15], v4
v_smfmac_f32_16x16x64_bf16 v[16:19], v[56:59], v[128:135], v4
s_waitcnt lgkmcnt(0)
v_bitop3_b32 v7, v60, v61, s44 bitop3:0x7e
v_bitop3_b32 v7, v62, v7, s44 bitop3:0xde
v_bitop3_b32 v7, v63, v7, s44 bitop3:0xde
v_bitop3_b32 v7, v64, v7, s44 bitop3:0xde
v_bitop3_b32 v7, v65, v7, s44 bitop3:0xde
v_bitop3_b32 v7, v66, v7, s44 bitop3:0xde
v_bitop3_b32 v7, v67, v7, s44 bitop3:0xde
v_smfmac_f32_16x16x64_bf16 v[20:23], v[56:59], a[16:23], v4
v_and_b32 v7, 1, v7
v_smfmac_f32_16x16x64_bf16 v[24:27], v[56:59], v[136:143], v4
v_cmp_eq_u32 vcc, s59, v7
v_smfmac_f32_16x16x64_bf16 v[28:31], v[56:59], a[24:31], v4
s_cbranch_vccnz C_OF07
C_OK07:
s_waitcnt vmcnt(2)
s_barrier
ds_read_b128 v[68:71], v0 offset:6144
v_smfmac_f32_16x16x64_bf16 v[16:19], v[60:63], v[144:151], v4
ds_read_b128 v[72:75], v0 offset:7168
ds_read_b128 v[76:79], v0 offset:8192
v_smfmac_f32_16x16x64_bf16 v[20:23], v[60:63], a[32:39], v4
v_smfmac_f32_16x16x64_bf16 v[24:27], v[60:63], v[152:159], v4
v_smfmac_f32_16x16x64_bf16 v[28:31], v[60:63], a[40:47], v4
s_waitcnt lgkmcnt(1)
s_waitcnt lgkmcnt(0)
v_bitop3_b32 v13, v68, v69, s44 bitop3:0x7e
v_bitop3_b32 v13, v70, v13, s44 bitop3:0xde
v_bitop3_b32 v13, v71, v13, s44 bitop3:0xde
v_bitop3_b32 v13, v72, v13, s44 bitop3:0xde
v_bitop3_b32 v13, v73, v13, s44 bitop3:0xde
v_bitop3_b32 v13, v74, v13, s44 bitop3:0xde
v_bitop3_b32 v13, v75, v13, s44 bitop3:0xde
v_bitop3_b32 v13, v76, v13, s44 bitop3:0xde
v_bitop3_b32 v13, v77, v13, s44 bitop3:0xde
v_bitop3_b32 v13, v78, v13, s44 bitop3:0xde
v_smfmac_f32_16x16x64_bf16 v[16:19], v[64:67], v[160:167], v4
v_bitop3_b32 v13, v79, v13, s44 bitop3:0xde
v_smfmac_f32_16x16x64_bf16 v[20:23], v[64:67], a[48:55], v4
v_and_b32 v13, 1, v13
v_smfmac_f32_16x16x64_bf16 v[24:27], v[64:67], v[168:175], v4
v_cmp_eq_u32 vcc, s59, v13
v_smfmac_f32_16x16x64_bf16 v[28:31], v[64:67], a[56:63], v4
s_cbranch_vccnz C_OF17
C_OK17:
v_add_u32 v12, s48, v0
v_smfmac_f32_16x16x64_bf16 v[16:19], v[68:71], v[176:183], v4
ds_read_b128 v[12:15], v12
v_smfmac_f32_16x16x64_bf16 v[20:23], v[68:71], a[64:71], v4
s_add_u32 s67, s67, 524288
s_mov_b32 s74, s66
v_smfmac_f32_16x16x64_bf16 v[16:19], v[72:75], v[192:199], v4
buffer_store_dword v5, off, s[36:39], s49 sc1
v_smfmac_f32_16x16x64_bf16 v[20:23], v[72:75], a[80:87], v4
v_smfmac_f32_16x16x64_bf16 v[16:19], v[76:79], v[208:215], v4
s_waitcnt lgkmcnt(0)
buffer_store_dwordx4 v[12:15], v0, s[36:39], s68 offen sc1
v_smfmac_f32_16x16x64_bf16 v[20:23], v[76:79], a[96:103], v4
s_xor_b32 s44, s44, -1
s_mov_b32 s59, 1
v_smfmac_f32_16x16x64_bf16 v[24:27], v[68:71], v[184:191], v4
s_add_u32 s68, s68, 16384
v_cvt_pk_bf16_f32 v16, v16, v17
v_smfmac_f32_16x16x64_bf16 v[24:27], v[72:75], v[200:207], v4
v_cvt_pk_bf16_f32 v17, v18, v19
v_smfmac_f32_16x16x64_bf16 v[24:27], v[76:79], v[216:223], v4
v_cvt_pk_bf16_f32 v18, v20, v21
v_smfmac_f32_16x16x64_bf16 v[28:31], v[68:71], a[72:79], v4
v_cvt_pk_bf16_f32 v19, v22, v23
v_smfmac_f32_16x16x64_bf16 v[28:31], v[72:75], a[88:95], v4
v_cvt_pk_bf16_f32 v24, v24, v25
v_smfmac_f32_16x16x64_bf16 v[28:31], v[76:79], a[104:111], v4
v_cvt_pk_bf16_f32 v25, v26, v27
v_mfma_f32_16x16x32_bf16 v[20:23], v[16:19], v[8:11], 0
s_nop 3
v_cvt_pk_bf16_f32 v26, v28, v29
v_cvt_pk_bf16_f32 v27, v30, v31
s_nop 1
v_mfma_f32_16x16x32_bf16 v[28:31], v[24:27], v[8:11], 0
v_cvt_pk_bf16_f32 v16, v20, v21
v_cvt_pk_bf16_f32 v17, v22, v23
v_smfmac_f32_16x16x64_bf16 v[32:35], v[72:75], a[224:231], v4
s_mov_b64 vcc, s[62:63]
s_nop 2
v_cvt_pk_bf16_f32 v18, v28, v29
v_cvt_pk_bf16_f32 v19, v30, v31
s_nop 1
v_mfma_f32_16x16x32_bf16 v[24:27], v[44:47], v[16:19], 0
v_mfma_f32_16x16x32_bf16 v[20:23], v[40:43], v[16:19], 0
v_mfma_f32_16x16x32_bf16 v[28:31], v[16:19], v[16:19], 0
s_nop 3
v_cndmask_b32_dpp v20, v24, v20, vcc quad_perm:[2,3,2,3] row_mask:0xf bank_mask:0xf
v_cndmask_b32_dpp v21, v25, v21, vcc quad_perm:[2,3,2,3] row_mask:0xf bank_mask:0xf
v_cndmask_b32_dpp v22, v26, v22, vcc quad_perm:[2,3,2,3] row_mask:0xf bank_mask:0xf
v_cndmask_b32_dpp v23, v27, v23, vcc quad_perm:[2,3,2,3] row_mask:0xf bank_mask:0xf
v_smfmac_f32_16x16x64_bf16 v[36:39], v[72:75], a[232:239], v4
ds_write_b128 v0, v[20:23] offset:12288
v_cndmask_b32_dpp v28, v29, v28, vcc quad_perm:[2,3,2,3] row_mask:0xf bank_mask:0xf
v_smfmac_f32_16x16x64_bf16 v[32:35], v[76:79], a[240:247], v4
ds_write_b32 v0, v28 offset:13324
v_mul_f32 v24, s72, v20
v_smfmac_f32_16x16x64_bf16 v[36:39], v[76:79], a[248:255], v4
v_mul_f32 v25, s72, v21
v_smfmac_f32_16x16x64_bf16 v[32:35], v[64:67], a[192:199], v4
v_mul_f32 v26, s72, v22
v_smfmac_f32_16x16x64_bf16 v[36:39], v[64:67], a[200:207], v4
v_mul_f32 v27, s72, v23
v_smfmac_f32_16x16x64_bf16 v[32:35], v[68:71], a[208:215], v4
v_mov_b32 v12, 0x3f803f80
v_smfmac_f32_16x16x64_bf16 v[36:39], v[68:71], a[216:223], v4
s_waitcnt lgkmcnt(0)
s_barrier
ds_read_b128 v[28:31], v0 offset:13312
ds_read_b128 v[16:19], v0 offset:11264
v_smfmac_f32_16x16x64_bf16 v[32:35], v[56:59], a[160:167], v4
ds_read_b128 v[40:43], v0 offset:10240
ds_read_b128 v[44:47], v0 offset:9216
v_mov_b32 v13, 0x3f803f80
v_smfmac_f32_16x16x64_bf16 v[36:39], v[56:59], a[168:175], v4
ds_read_b128 v[72:75], v6 offset:0
ds_read_b128 v[76:79], v6 offset:1024
v_mov_b32 v14, 0x3f803f80
v_smfmac_f32_16x16x64_bf16 v[32:35], v[60:63], a[176:183], v4
ds_read_b128 v[64:67], v6 offset:4096
ds_read_b128 v[68:71], v6 offset:5120
v_mov_b32 v15, 0x3f803f80
v_smfmac_f32_16x16x64_bf16 v[36:39], v[60:63], a[184:191], v4
v_mov_b32 v20, 0x3f003f00
v_mov_b32 v21, 0x3f003f00
s_waitcnt lgkmcnt(7)
v_pk_add_f32 v[28:29], v[28:29], v[30:31]
v_add_f32 v28, v28, v29
v_mul_f32 v28, s72, v28
s_waitcnt lgkmcnt(6)
v_pk_fma_f32 v[24:25], v[16:17], s[72:73], v[24:25]
v_exp_f32 v29, v28
v_pk_fma_f32 v[26:27], v[18:19], s[72:73], v[26:27]
s_waitcnt lgkmcnt(5)
v_pk_fma_f32 v[24:25], v[40:41], s[72:73], v[24:25]
v_cvt_pk_bf16_f32 v30, v29, v29
v_pk_fma_f32 v[26:27], v[42:43], s[72:73], v[26:27]
s_waitcnt lgkmcnt(4)
v_pk_fma_f32 v[24:25], v[44:45], s[72:73], v[24:25]
v_mov_b32_dpp v31, v30 quad_perm:[2,3,0,1] row_mask:0xf bank_mask:0xf
v_pk_fma_f32 v[26:27], v[46:47], s[72:73], v[26:27]
v_cvt_pk_bf16_f32 v32, v32, v33
v_cvt_pk_bf16_f32 v33, v34, v35
v_cvt_pk_bf16_f32 v34, v36, v37
v_cvt_pk_bf16_f32 v35, v38, v39
v_exp_f32 v24, v24
v_mfma_f32_16x16x16_bf16 v[40:43], v[32:33], v[30:31], 0
ds_read_b128 v[56:59], v6 offset:12288
ds_read_b128 v[60:63], v6 offset:13312
v_exp_f32 v25, v25
v_mfma_f32_16x16x16_bf16 v[44:47], v[34:35], v[30:31], 0
s_waitcnt vmcnt(2)
v_exp_f32 v26, v26
v_mfma_f32_16x16x16_bf16 v[36:39], v[20:21], v[30:31], 0
v_exp_f32 v27, v27
v_cvt_pk_bf16_f32 v16, v24, v25
v_cvt_pk_bf16_f32 v17, v26, v27
v_mov_b64 v[22:23], 0
v_mov_b32_dpp v18, v16 quad_perm:[2,3,0,1] row_mask:0xf bank_mask:0xf
v_mov_b32_dpp v19, v17 quad_perm:[2,3,0,1] row_mask:0xf bank_mask:0xf
v_mov_b64 v[24:25], 0
v_mov_b64 v[26:27], 0
v_mfma_f32_16x16x32_bf16 v[36:39], v[12:15], v[16:19], v[36:39]
v_mov_b32 v20, 0
v_mov_b32 v21, 0
v_mfma_f32_16x16x32_bf16 v[40:43], v[48:51], v[16:19], v[40:43]
v_mov_b32 v28, 0
v_mov_b32 v29, 0
v_mfma_f32_16x16x32_bf16 v[44:47], v[52:55], v[16:19], v[44:47]
v_rcp_f32 v38, v36
s_nop 2
v_pk_mul_f32 v[40:41], v[40:41], v[38:39] op_sel_hi:[1,0]
v_pk_mul_f32 v[42:43], v[42:43], v[38:39] op_sel_hi:[1,0]
v_cvt_pk_bf16_f32 v40, v40, v41
v_cvt_pk_bf16_f32 v41, v42, v43
v_pk_mul_f32 v[44:45], v[44:45], v[38:39] op_sel_hi:[1,0]
v_pk_mul_f32 v[46:47], v[46:47], v[38:39] op_sel_hi:[1,0]
s_mov_b64 exec, s[62:63]
v_cvt_pk_bf16_f32 v42, v44, v45
v_cvt_pk_bf16_f32 v43, v46, v47
ds_write_b128 v3, v[40:43] offset:1536
s_mov_b64 exec, -1
v_max_f32 v36, v36, v38
v_cmp_nge_f32 vcc, s47, v36
v_mov_b32_dpp v40, v40 quad_perm:[2,3,2,3] row_mask:0xf bank_mask:0xf
v_mov_b32_dpp v41, v41 quad_perm:[2,3,2,3] row_mask:0xf bank_mask:0xf
v_mov_b32_dpp v42, v42 quad_perm:[2,3,2,3] row_mask:0xf bank_mask:0xf
v_mov_b32_dpp v43, v43 quad_perm:[2,3,2,3] row_mask:0xf bank_mask:0xf
s_cbranch_vccnz C_FB7
C_FBOK7:
v_mov_b64 v[30:31], 0
s_waitcnt lgkmcnt(5)
v_smfmac_f32_16x16x64_bf16 v[20:23], v[40:43], v[72:79], v4 abid:1
ds_read_b128 v[48:51], v6 offset:16384
ds_read_b128 v[52:55], v6 offset:17408
v_mov_b64 v[16:17], 0
s_waitcnt lgkmcnt(5)
v_smfmac_f32_16x16x64_bf16 v[24:27], v[40:43], v[64:71], v4 abid:1
ds_read_b128 v[72:75], v6 offset:2048
ds_read_b128 v[76:79], v6 offset:3072
v_mov_b64 v[18:19], 0
s_waitcnt lgkmcnt(4)
s_barrier
ds_read_b128 v[44:47], v3 offset:1024
ds_read_b128 v[36:39], v3 offset:512
ds_read_b128 v[12:15], v3 offset:0
v_smfmac_f32_16x16x64_bf16 v[28:31], v[40:43], v[56:63], v4 abid:1
ds_read_b128 v[64:67], v6 offset:6144
ds_read_b128 v[68:71], v6 offset:7168
v_mov_b64 v[32:33], 0
v_smfmac_f32_16x16x64_bf16 v[16:19], v[40:43], a[112:119], v4 abid:1
ds_read_b128 v[56:59], v6 offset:8192
ds_read_b128 v[60:63], v6 offset:9216
v_mov_b64 v[34:35], 0
s_waitcnt lgkmcnt(9)
s_nop 0
v_smfmac_f32_16x16x64_bf16 v[32:35], v[40:43], v[48:55], v4 abid:1
ds_read_b128 v[48:51], v6 offset:10240
ds_read_b128 v[52:55], v6 offset:11264
s_waitcnt lgkmcnt(8)
v_smfmac_f32_16x16x64_bf16 v[20:23], v[44:47], v[72:79], v4 abid:1
ds_read_b128 v[72:75], v6 offset:14336
ds_read_b128 v[76:79], v6 offset:15360
s_waitcnt lgkmcnt(9)
v_smfmac_f32_16x16x64_bf16 v[20:23], v[36:39], a[128:135], v4 abid:1
s_waitcnt lgkmcnt(8)
v_smfmac_f32_16x16x64_bf16 v[20:23], v[12:15], a[136:143], v4 abid:1
s_waitcnt lgkmcnt(6)
v_smfmac_f32_16x16x64_bf16 v[24:27], v[44:47], v[64:71], v4 abid:1
ds_read_b128 v[64:67], v6 offset:18432
ds_read_b128 v[68:71], v6 offset:19456
s_waitcnt lgkmcnt(6)
v_smfmac_f32_16x16x64_bf16 v[24:27], v[36:39], v[56:63], v4 abid:1
ds_read_b128 v[56:59], v6 offset:20480
ds_read_b128 v[60:63], v6 offset:21504
v_cvt_pk_bf16_f32 v20, v20, v21
v_bfi_b32 v20, 1, s44, v20
v_cvt_pk_bf16_f32 v22, v22, v23
v_bfi_b32 v22, 1, s44, v22
s_waitcnt lgkmcnt(6)
v_smfmac_f32_16x16x64_bf16 v[24:27], v[12:15], v[48:55], v4 abid:1
buffer_store_dword v20, v1, s[8:11], s50 offen sc1
buffer_store_dword v22, v1, s[8:11], s51 offen sc1
ds_read_b128 v[48:51], v6 offset:22528
ds_read_b128 v[52:55], v6 offset:23552
s_waitcnt lgkmcnt(6)
v_smfmac_f32_16x16x64_bf16 v[28:31], v[44:47], v[72:79], v4 abid:1
v_mov_b32 v21, 0xeeee
v_smfmac_f32_16x16x64_bf16 v[28:31], v[36:39], a[144:151], v4 abid:1
v_cvt_pk_bf16_f32 v24, v24, v25
v_bfi_b32 v24, 1, s44, v24
v_smfmac_f32_16x16x64_bf16 v[28:31], v[12:15], a[152:159], v4 abid:1
buffer_store_dword v24, v1, s[8:11], s52 offen sc1
v_cvt_pk_bf16_f32 v26, v26, v27
v_bfi_b32 v26, 1, s44, v26
s_waitcnt lgkmcnt(4)
v_smfmac_f32_16x16x64_bf16 v[32:35], v[44:47], v[64:71], v4 abid:1
buffer_store_dword v26, v1, s[8:11], s53 offen sc1
s_waitcnt lgkmcnt(2)
v_smfmac_f32_16x16x64_bf16 v[32:35], v[36:39], v[56:63], v4 abid:1
v_cvt_pk_bf16_f32 v28, v28, v29
v_bfi_b32 v28, 1, s44, v28
s_waitcnt lgkmcnt(0)
v_smfmac_f32_16x16x64_bf16 v[32:35], v[12:15], v[48:55], v4 abid:1
buffer_store_dword v28, v1, s[8:11], s54 offen sc1
v_cvt_pk_bf16_f32 v30, v30, v31
v_bfi_b32 v30, 1, s44, v30
v_smfmac_f32_16x16x64_bf16 v[16:19], v[44:47], a[112:119], v21
buffer_store_dword v30, v1, s[8:11], s55 offen sc1
v_smfmac_f32_16x16x64_bf16 v[16:19], v[36:39], a[120:127], v4 abid:1
v_cvt_pk_bf16_f32 v32, v32, v33
v_bfi_b32 v32, 1, s44, v32
v_smfmac_f32_16x16x64_bf16 v[16:19], v[12:15], a[120:127], v21
buffer_store_dword v32, v1, s[8:11], s56 offen sc1
v_cvt_pk_bf16_f32 v34, v34, v35
v_bfi_b32 v34, 1, s44, v34
buffer_store_dword v34, v1, s[8:11], s57 offen sc1
s_nop 3
v_cvt_pk_bf16_f32 v16, v16, v17
v_bfi_b32 v16, 1, s44, v16
buffer_store_dword v16, v1, s[8:11], s58 offen sc1
v_mov_b32 v60, 0x3f80
v_cndmask_b32 v60, v60, 1.0, s[32:33]
v_cndmask_b32 v56, 0, v60, s[24:25]
v_cndmask_b32 v57, 0, v60, s[26:27]
v_cndmask_b32 v58, 0, v60, s[28:29]
v_cndmask_b32 v59, 0, v60, s[30:31]
v_mov_b32 v20, 0
v_mov_b32 v21, 0
v_mov_b32 v22, 0
v_mov_b32 v23, 0
v_mov_b32 v24, 0
v_mov_b32 v25, 0
v_mov_b32 v26, 0
v_mov_b32 v27, 0
v_mov_b32 v28, 0
v_mov_b32 v29, 0
v_mov_b32 v30, 0
v_mov_b32 v31, 0
v_mov_b32 v32, 0
v_mov_b32 v33, 0
v_mov_b32 v34, 0
v_mov_b32 v35, 0
v_mov_b32 v36, 0
v_mov_b32 v37, 0
v_mov_b32 v38, 0
v_mov_b32 v39, 0
v_mov_b32 v17, 0
v_mov_b32 v18, 0
v_mov_b32 v19, 0
v_mov_b32 v16, 0
s_waitcnt vmcnt(0)
buffer_load_dwordx4 v[72:75], v0, s[8:11], s64 offen offset:0 sc1
buffer_load_dwordx4 v[76:79], v0, s[8:11], s64 offen offset:1024 sc1
s_waitcnt vmcnt(1)
v_mfma_f32_16x16x32_bf16 v[60:63], v[56:59], v[72:75], 0
s_waitcnt vmcnt(0)
v_mfma_f32_16x16x32_bf16 v[60:63], v[56:59], v[76:79], v[60:63]
v_bitop3_b32 v12, v72, v73, s44 bitop3:0x7e
v_bitop3_b32 v13, v74, v75, s44 bitop3:0x7e
v_bitop3_b32 v14, v76, v77, s44 bitop3:0x7e
v_bitop3_b32 v15, v78, v79, s44 bitop3:0x7e
v_or3_b32 v12, v12, v13, v14
v_bitop3_b32 v12, v12, v15, 1 bitop3:0xa8
v_cmp_ne_u32 vcc, 0, v12
s_nop 0
v_add_f32_dpp v60, v60, v60 row_ror:4 row_mask:0xf bank_mask:0xf
v_add_f32_dpp v61, v61, v61 row_ror:4 row_mask:0xf bank_mask:0xf
s_cbranch_vccnz C_RR07
C_RT07:
v_add_f32_dpp v60, v60, v60 row_ror:8 row_mask:0xf bank_mask:0xf
v_add_f32_dpp v61, v61, v61 row_ror:8 row_mask:0xf bank_mask:0xf
s_mov_b64 exec, s[60:61]
v_cvt_pk_bf16_f32 v60, v60, v61
v_bfi_b32 v60, 1, s44, v60
buffer_store_dword v60, v2, s[8:11], 0 offen sc1
s_mov_b64 exec, -1
s_add_u32 s43, s43, 1
s_cmp_eq_u32 s43, 63
s_cbranch_scc1 C_X7
s_waitcnt vmcnt(1)
ds_read_b128 v[64:67], v6 offset:24576
ds_read_b128 v[68:71], v6 offset:25600
ds_read_b128 v[72:75], v6 offset:26624
ds_read_b128 v[76:79], v6 offset:27648
s_barrier
s_branch C_A7
C_X7:
s_waitcnt vmcnt(0) lgkmcnt(0)
s_cmp_lt_u32 s41, 9
s_cbranch_scc0 END
v_mov_b32 v7, s43
s_add_u32 s3, s48, 114688
buffer_store_dword v7, off, s[8:11], s49 sc1
C_FL7:
s_sub_u32 s45, s45, 1
s_cbranch_scc1 END
buffer_load_dwordx4 v[64:67], v0, s[8:11], s3 offen sc1
s_waitcnt vmcnt(0)
v_bitop3_b32 v40, v64, v65, s44 bitop3:0x7e
v_bitop3_b32 v41, v66, v67, s44 bitop3:0x7e
v_bitop3_b32 v40, v40, v41, 1 bitop3:0xa8
v_cmp_ne_u32 vcc, 0, v40
s_cbranch_vccnz C_FL7
buffer_store_dwordx4 v[64:67], v0, s[8:11], s68 offen sc1
v_mov_b32 v36, 64
s_waitcnt vmcnt(0)
buffer_store_dword v36, off, s[8:11], s49 sc1
s_branch END
C_RR07:
s_mov_b64 exec, vcc
buffer_load_dwordx4 v[72:75], v0, s[8:11], s64 offen offset:0 sc1
buffer_load_dwordx4 v[76:79], v0, s[8:11], s64 offen offset:1024 sc1
s_mov_b64 exec, -1
C_RL07:
s_mov_b64 exec, vcc
buffer_load_dwordx4 v[72:75], v0, s[8:11], s64 offen offset:0 sc1
buffer_load_dwordx4 v[76:79], v0, s[8:11], s64 offen offset:1024 sc1
s_mov_b64 exec, -1
s_sub_u32 s45, s45, 1
s_cbranch_scc1 END
s_waitcnt vmcnt(2)
v_bitop3_b32 v12, v72, v73, s44 bitop3:0x7e
v_bitop3_b32 v13, v74, v75, s44 bitop3:0x7e
v_bitop3_b32 v14, v76, v77, s44 bitop3:0x7e
v_bitop3_b32 v15, v78, v79, s44 bitop3:0x7e
v_or3_b32 v12, v12, v13, v14
v_bitop3_b32 v12, v12, v15, 1 bitop3:0xa8
v_cmp_ne_u32 vcc, 0, v12
s_cbranch_vccnz C_RL07
C_RM07:
v_mfma_f32_16x16x32_bf16 v[60:63], v[56:59], v[72:75], 0
v_mfma_f32_16x16x32_bf16 v[60:63], v[56:59], v[76:79], v[60:63]
s_nop 7
v_add_f32_dpp v60, v60, v60 row_ror:4 row_mask:0xf bank_mask:0xf
v_add_f32_dpp v61, v61, v61 row_ror:4 row_mask:0xf bank_mask:0xf
s_branch C_RT07
C_OF07:
s_sub_u32 s45, s45, 1
s_cbranch_scc1 END
s_waitcnt lgkmcnt(0)
s_barrier
s_barrier
ds_read_b128 v[60:63], v0 offset:4096
ds_read_b128 v[64:67], v0 offset:5120
s_waitcnt lgkmcnt(0)
v_bitop3_b32 v7, v60, v61, s44 bitop3:0x7e
v_bitop3_b32 v7, v62, v7, s44 bitop3:0xde
v_bitop3_b32 v7, v63, v7, s44 bitop3:0xde
v_bitop3_b32 v7, v64, v7, s44 bitop3:0xde
v_bitop3_b32 v7, v65, v7, s44 bitop3:0xde
v_bitop3_b32 v7, v66, v7, s44 bitop3:0xde
v_bitop3_b32 v7, v67, v7, s44 bitop3:0xde
v_and_b32 v7, 1, v7
v_cmp_eq_u32 vcc, s59, v7
s_cbranch_vccnz C_OF07
s_branch C_OK07
C_OF17:
s_sub_u32 s45, s45, 1
s_cbranch_scc1 END
s_waitcnt lgkmcnt(0)
s_barrier
buffer_load_dwordx4 v0, s[8:11], s74 offen offset:0 sc1 lds
buffer_load_dwordx4 v0, s[8:11], s74 offen offset:1024 sc1 lds
s_waitcnt vmcnt(0)
s_barrier
ds_read_b128 v[68:71], v0 offset:6144
ds_read_b128 v[72:75], v0 offset:7168
ds_read_b128 v[76:79], v0 offset:8192
s_waitcnt lgkmcnt(0)
v_bitop3_b32 v13, v68, v69, s44 bitop3:0x7e
v_bitop3_b32 v13, v70, v13, s44 bitop3:0xde
v_bitop3_b32 v13, v71, v13, s44 bitop3:0xde
v_bitop3_b32 v13, v72, v13, s44 bitop3:0xde
v_bitop3_b32 v13, v73, v13, s44 bitop3:0xde
v_bitop3_b32 v13, v74, v13, s44 bitop3:0xde
v_bitop3_b32 v13, v75, v13, s44 bitop3:0xde
v_bitop3_b32 v13, v76, v13, s44 bitop3:0xde
v_bitop3_b32 v13, v77, v13, s44 bitop3:0xde
v_bitop3_b32 v13, v78, v13, s44 bitop3:0xde
v_bitop3_b32 v13, v79, v13, s44 bitop3:0xde
v_and_b32 v13, 1, v13
v_cmp_eq_u32 vcc, s59, v13
s_cbranch_vccnz C_OF17
s_branch C_OK17
s_nop 2
C_FB7:
ds_read_b128 v[28:31], v0 offset:13312
ds_read_b128 v[24:27], v0 offset:12288
ds_read_b128 v[16:19], v0 offset:11264
ds_read_b128 v[40:43], v0 offset:10240
ds_read_b128 v[44:47], v0 offset:9216
v_mov_b32 v20, 0x3f003f00
v_mov_b32 v21, 0x3f003f00
s_waitcnt lgkmcnt(0)
v_pk_add_f32 v[28:29], v[28:29], v[30:31]
v_add_f32 v28, v28, v29
v_mul_f32 v28, s72, v28
v_mul_f32 v24, s72, v24
v_mul_f32 v25, s72, v25
v_mul_f32 v26, s72, v26
v_mul_f32 v27, s72, v27
v_pk_fma_f32 v[24:25], v[16:17], s[72:73], v[24:25]
v_pk_fma_f32 v[26:27], v[18:19], s[72:73], v[26:27]
v_pk_fma_f32 v[24:25], v[40:41], s[72:73], v[24:25]
v_pk_fma_f32 v[26:27], v[42:43], s[72:73], v[26:27]
v_pk_fma_f32 v[24:25], v[44:45], s[72:73], v[24:25]
v_pk_fma_f32 v[26:27], v[46:47], s[72:73], v[26:27]
v_max3_f32 v36, v24, v25, v26
v_max3_f32 v36, v36, v27, v28
s_nop 1
v_max_f32_dpp v36, v36, v36 quad_perm:[2,3,0,1] row_mask:0xf bank_mask:0xf
v_mov_b32 v37, v36
s_nop 1
v_permlane16_swap_b32 v36, v37
v_max_f32 v36, v36, v37
v_mov_b32 v37, v36
s_nop 1
v_permlane32_swap_b32 v36, v37
v_max_f32 v36, v36, v37
v_sub_f32 v24, v24, v36
v_sub_f32 v25, v25, v36
v_sub_f32 v26, v26, v36
v_sub_f32 v27, v27, v36
v_sub_f32 v28, v28, v36
v_exp_f32 v29, v28
s_nop 0
v_cvt_pk_bf16_f32 v30, v29, v29
s_nop 1
v_mov_b32_dpp v31, v30 quad_perm:[2,3,0,1] row_mask:0xf bank_mask:0xf
v_exp_f32 v24, v24
s_nop 0
v_mfma_f32_16x16x16_bf16 v[40:43], v[32:33], v[30:31], 0
v_exp_f32 v25, v25
v_mfma_f32_16x16x16_bf16 v[44:47], v[34:35], v[30:31], 0
v_exp_f32 v26, v26
v_mfma_f32_16x16x16_bf16 v[36:39], v[20:21], v[30:31], 0
v_exp_f32 v27, v27
v_cvt_pk_bf16_f32 v16, v24, v25
v_cvt_pk_bf16_f32 v17, v26, v27
v_mov_b64 v[22:23], 0
v_mov_b32_dpp v18, v16 quad_perm:[2,3,0,1] row_mask:0xf bank_mask:0xf
v_mov_b32_dpp v19, v17 quad_perm:[2,3,0,1] row_mask:0xf bank_mask:0xf
v_mov_b64 v[24:25], 0
v_mov_b64 v[26:27], 0
v_mfma_f32_16x16x32_bf16 v[36:39], v[12:15], v[16:19], v[36:39]
v_mov_b32 v20, 0
v_mov_b32 v21, 0
v_mfma_f32_16x16x32_bf16 v[40:43], v[48:51], v[16:19], v[40:43]
v_mov_b32 v28, 0
v_mov_b32 v29, 0
v_mfma_f32_16x16x32_bf16 v[44:47], v[52:55], v[16:19], v[44:47]
v_rcp_f32 v38, v36
s_nop 2
v_pk_mul_f32 v[40:41], v[40:41], v[38:39] op_sel_hi:[1,0]
v_pk_mul_f32 v[42:43], v[42:43], v[38:39] op_sel_hi:[1,0]
v_cvt_pk_bf16_f32 v40, v40, v41
v_cvt_pk_bf16_f32 v41, v42, v43
v_pk_mul_f32 v[44:45], v[44:45], v[38:39] op_sel_hi:[1,0]
v_pk_mul_f32 v[46:47], v[46:47], v[38:39] op_sel_hi:[1,0]
s_mov_b64 exec, s[62:63]
v_cvt_pk_bf16_f32 v42, v44, v45
v_cvt_pk_bf16_f32 v43, v46, v47
ds_write_b128 v3, v[40:43] offset:1536
s_mov_b64 exec, -1
v_mov_b32_dpp v40, v40 quad_perm:[2,3,2,3] row_mask:0xf bank_mask:0xf
v_mov_b32_dpp v41, v41 quad_perm:[2,3,2,3] row_mask:0xf bank_mask:0xf
v_mov_b32_dpp v42, v42 quad_perm:[2,3,2,3] row_mask:0xf bank_mask:0xf
v_mov_b32_dpp v43, v43 quad_perm:[2,3,2,3] row_mask:0xf bank_mask:0xf
s_waitcnt lgkmcnt(0)
s_nop 1
s_branch C_FBOK7
END:
EXIT:
s_endpgm
PROJ:
s_sub_u32 s2, s40, 32
s_lshr_b32 s41, s2, 5
s_lshl_b32 s41, s41, 3
s_and_b32 s3, s2, 7
s_add_u32 s41, s41, s3
s_bfe_u32 s56, s2, 0x20003
s_mul_i32 s47, s42, 36864
s_lshl_b32 s48, s42, 18
s_lshl_b32 s49, s42, 17
s_lshl_b32 s2, s41, 8
v_lshrrev_b32 v1, 4, v0
v_and_b32 v2, 15, v0
v_lshlrev_b32 v3, 2, v1
v_xor_b32 v2, v2, v3
v_lshl_add_u32 v3, v1, 13, s2
v_lshl_add_u32 v44, v2, 4, v3
v_xor_b32 v45, 32, v44
s_add_u32 m0, s47, 0
s_add_u32 s2, s48, 0
buffer_load_dwordx4 v44, s[20:23], s2 offen offset:0 lds
s_add_u32 s2, s48, 31744
buffer_load_dwordx4 v44, s[20:23], s2 offen offset:1024 lds
s_add_u32 s2, s48, 63488
buffer_load_dwordx4 v45, s[20:23], s2 offen offset:2048 lds
s_add_u32 s2, s48, 95232
buffer_load_dwordx4 v45, s[20:23], s2 offen offset:3072 lds
s_add_u32 m0, s47, 4096
s_add_u32 s2, s48, 131072
buffer_load_dwordx4 v44, s[20:23], s2 offen offset:0 lds
s_add_u32 s2, s48, 162816
buffer_load_dwordx4 v44, s[20:23], s2 offen offset:1024 lds
s_add_u32 s2, s48, 194560
buffer_load_dwordx4 v45, s[20:23], s2 offen offset:2048 lds
s_add_u32 s2, s48, 226304
buffer_load_dwordx4 v45, s[20:23], s2 offen offset:3072 lds
s_add_u32 m0, s47, 8192
s_add_u32 s2, s48, 1048576
buffer_load_dwordx4 v44, s[20:23], s2 offen offset:0 lds
s_add_u32 s2, s48, 1080320
buffer_load_dwordx4 v44, s[20:23], s2 offen offset:1024 lds
s_add_u32 s2, s48, 1112064
buffer_load_dwordx4 v45, s[20:23], s2 offen offset:2048 lds
s_add_u32 s2, s48, 1143808
buffer_load_dwordx4 v45, s[20:23], s2 offen offset:3072 lds
s_add_u32 m0, s47, 12288
s_add_u32 s2, s48, 1179648
buffer_load_dwordx4 v44, s[20:23], s2 offen offset:0 lds
s_add_u32 s2, s48, 1211392
buffer_load_dwordx4 v44, s[20:23], s2 offen offset:1024 lds
s_add_u32 s2, s48, 1243136
buffer_load_dwordx4 v45, s[20:23], s2 offen offset:2048 lds
s_add_u32 s2, s48, 1274880
buffer_load_dwordx4 v45, s[20:23], s2 offen offset:3072 lds
s_add_u32 m0, s47, 16384
s_add_u32 s2, s48, 2097152
buffer_load_dwordx4 v44, s[20:23], s2 offen offset:0 lds
s_add_u32 s2, s48, 2128896
buffer_load_dwordx4 v44, s[20:23], s2 offen offset:1024 lds
s_add_u32 s2, s48, 2160640
buffer_load_dwordx4 v45, s[20:23], s2 offen offset:2048 lds
s_add_u32 s2, s48, 2192384
buffer_load_dwordx4 v45, s[20:23], s2 offen offset:3072 lds
s_add_u32 m0, s47, 20480
s_add_u32 s2, s48, 2228224
buffer_load_dwordx4 v44, s[20:23], s2 offen offset:0 lds
s_add_u32 s2, s48, 2259968
buffer_load_dwordx4 v44, s[20:23], s2 offen offset:1024 lds
s_add_u32 s2, s48, 2291712
buffer_load_dwordx4 v45, s[20:23], s2 offen offset:2048 lds
s_add_u32 s2, s48, 2323456
buffer_load_dwordx4 v45, s[20:23], s2 offen offset:3072 lds
s_add_u32 m0, s47, 24576
s_add_u32 s2, s48, 3145728
buffer_load_dwordx4 v44, s[20:23], s2 offen offset:0 lds
s_add_u32 s2, s48, 3177472
buffer_load_dwordx4 v44, s[20:23], s2 offen offset:1024 lds
s_add_u32 s2, s48, 3209216
buffer_load_dwordx4 v45, s[20:23], s2 offen offset:2048 lds
s_add_u32 s2, s48, 3240960
buffer_load_dwordx4 v45, s[20:23], s2 offen offset:3072 lds
s_add_u32 m0, s47, 28672
s_add_u32 s2, s48, 3276800
buffer_load_dwordx4 v44, s[20:23], s2 offen offset:0 lds
s_add_u32 s2, s48, 3308544
buffer_load_dwordx4 v44, s[20:23], s2 offen offset:1024 lds
s_add_u32 s2, s48, 3340288
buffer_load_dwordx4 v45, s[20:23], s2 offen offset:2048 lds
s_add_u32 s2, s48, 3372032
buffer_load_dwordx4 v45, s[20:23], s2 offen offset:3072 lds
s_add_u32 m0, s47, 32768
s_add_u32 s2, s49, 4194304
buffer_load_dwordx4 v44, s[20:23], s2 offen offset:0 lds
s_add_u32 s2, s49, 4226048
buffer_load_dwordx4 v44, s[20:23], s2 offen offset:1024 lds
s_add_u32 s2, s49, 4257792
buffer_load_dwordx4 v45, s[20:23], s2 offen offset:2048 lds
s_add_u32 s2, s49, 4289536
buffer_load_dwordx4 v45, s[20:23], s2 offen offset:3072 lds
v_lshrrev_b32 v2, 1, v1
v_mul_u32_u24 v2, 36864, v2
v_and_b32 v3, 1, v1
v_lshl_add_u32 v2, v3, 11, v2
v_lshl_add_u32 v2, v3, 5, v2
v_bfe_u32 v3, v0, 2, 2
v_lshl_add_u32 v2, v3, 8, v2
v_xor_b32 v3, s42, v3
v_lshl_add_u32 v2, v3, 6, v2
v_and_b32 v3, 3, v0
v_lshl_add_u32 v50, v3, 3, v2
v_add_u32 v51, 73728, v50
v_xor_b32 v52, 32, v50
v_xor_b32 v53, 32, v51
v_lshl_add_u32 v54, v0, 4, s47
s_waitcnt vmcnt(32)
s_barrier
ds_read_b64_tr_b16 v[224:225], v50 offset:0
ds_read_b64_tr_b16 v[226:227], v50 offset:1024
ds_read_b64_tr_b16 v[228:229], v51 offset:0
ds_read_b64_tr_b16 v[230:231], v51 offset:1024
ds_read_b64_tr_b16 v[232:233], v52 offset:0
ds_read_b64_tr_b16 v[234:235], v52 offset:1024
ds_read_b64_tr_b16 v[236:237], v53 offset:0
ds_read_b64_tr_b16 v[238:239], v53 offset:1024
s_waitcnt lgkmcnt(0)
s_waitcnt vmcnt(28)
s_barrier
s_add_u32 m0, s47, 0
s_add_u32 s2, s48, 0
buffer_load_dwordx4 v44, s[24:27], s2 offen offset:0 lds
s_add_u32 s2, s48, 31744
buffer_load_dwordx4 v44, s[24:27], s2 offen offset:1024 lds
s_add_u32 s2, s48, 63488
buffer_load_dwordx4 v45, s[24:27], s2 offen offset:2048 lds
s_add_u32 s2, s48, 95232
buffer_load_dwordx4 v45, s[24:27], s2 offen offset:3072 lds
ds_read_b64_tr_b16 v[240:241], v50 offset:4096
ds_read_b64_tr_b16 v[242:243], v50 offset:5120
ds_read_b64_tr_b16 v[244:245], v51 offset:4096
ds_read_b64_tr_b16 v[246:247], v51 offset:5120
ds_read_b64_tr_b16 v[248:249], v52 offset:4096
ds_read_b64_tr_b16 v[250:251], v52 offset:5120
ds_read_b64_tr_b16 v[252:253], v53 offset:4096
ds_read_b64_tr_b16 v[254:255], v53 offset:5120
s_waitcnt lgkmcnt(0)
s_waitcnt vmcnt(28)
s_barrier
s_add_u32 m0, s47, 4096
s_add_u32 s2, s48, 131072
buffer_load_dwordx4 v44, s[24:27], s2 offen offset:0 lds
s_add_u32 s2, s48, 162816
buffer_load_dwordx4 v44, s[24:27], s2 offen offset:1024 lds
s_add_u32 s2, s48, 194560
buffer_load_dwordx4 v45, s[24:27], s2 offen offset:2048 lds
s_add_u32 s2, s48, 226304
buffer_load_dwordx4 v45, s[24:27], s2 offen offset:3072 lds
ds_read_b64_tr_b16 a[0:1], v50 offset:8192
ds_read_b64_tr_b16 a[2:3], v50 offset:9216
ds_read_b64_tr_b16 a[4:5], v51 offset:8192
ds_read_b64_tr_b16 a[6:7], v51 offset:9216
ds_read_b64_tr_b16 a[8:9], v52 offset:8192
ds_read_b64_tr_b16 a[10:11], v52 offset:9216
ds_read_b64_tr_b16 a[12:13], v53 offset:8192
ds_read_b64_tr_b16 a[14:15], v53 offset:9216
s_waitcnt lgkmcnt(0)
s_waitcnt vmcnt(28)
s_barrier
s_add_u32 m0, s47, 8192
s_add_u32 s2, s48, 1048576
buffer_load_dwordx4 v44, s[24:27], s2 offen offset:0 lds
s_add_u32 s2, s48, 1080320
buffer_load_dwordx4 v44, s[24:27], s2 offen offset:1024 lds
s_add_u32 s2, s48, 1112064
buffer_load_dwordx4 v45, s[24:27], s2 offen offset:2048 lds
s_add_u32 s2, s48, 1143808
buffer_load_dwordx4 v45, s[24:27], s2 offen offset:3072 lds
ds_read_b64_tr_b16 a[16:17], v50 offset:12288
ds_read_b64_tr_b16 a[18:19], v50 offset:13312
ds_read_b64_tr_b16 a[20:21], v51 offset:12288
ds_read_b64_tr_b16 a[22:23], v51 offset:13312
ds_read_b64_tr_b16 a[24:25], v52 offset:12288
ds_read_b64_tr_b16 a[26:27], v52 offset:13312
ds_read_b64_tr_b16 a[28:29], v53 offset:12288
ds_read_b64_tr_b16 a[30:31], v53 offset:13312
s_waitcnt lgkmcnt(0)
s_waitcnt vmcnt(28)
s_barrier
s_add_u32 m0, s47, 12288
s_add_u32 s2, s48, 1179648
buffer_load_dwordx4 v44, s[24:27], s2 offen offset:0 lds
s_add_u32 s2, s48, 1211392
buffer_load_dwordx4 v44, s[24:27], s2 offen offset:1024 lds
s_add_u32 s2, s48, 1243136
buffer_load_dwordx4 v45, s[24:27], s2 offen offset:2048 lds
s_add_u32 s2, s48, 1274880
buffer_load_dwordx4 v45, s[24:27], s2 offen offset:3072 lds
ds_read_b64_tr_b16 a[32:33], v50 offset:16384
ds_read_b64_tr_b16 a[34:35], v50 offset:17408
ds_read_b64_tr_b16 a[36:37], v51 offset:16384
ds_read_b64_tr_b16 a[38:39], v51 offset:17408
ds_read_b64_tr_b16 a[40:41], v52 offset:16384
ds_read_b64_tr_b16 a[42:43], v52 offset:17408
ds_read_b64_tr_b16 a[44:45], v53 offset:16384
ds_read_b64_tr_b16 a[46:47], v53 offset:17408
s_waitcnt lgkmcnt(0)
s_waitcnt vmcnt(28)
s_barrier
s_add_u32 m0, s47, 16384
s_add_u32 s2, s48, 2097152
buffer_load_dwordx4 v44, s[24:27], s2 offen offset:0 lds
s_add_u32 s2, s48, 2128896
buffer_load_dwordx4 v44, s[24:27], s2 offen offset:1024 lds
s_add_u32 s2, s48, 2160640
buffer_load_dwordx4 v45, s[24:27], s2 offen offset:2048 lds
s_add_u32 s2, s48, 2192384
buffer_load_dwordx4 v45, s[24:27], s2 offen offset:3072 lds
ds_read_b64_tr_b16 a[48:49], v50 offset:20480
ds_read_b64_tr_b16 a[50:51], v50 offset:21504
ds_read_b64_tr_b16 a[52:53], v51 offset:20480
ds_read_b64_tr_b16 a[54:55], v51 offset:21504
ds_read_b64_tr_b16 a[56:57], v52 offset:20480
ds_read_b64_tr_b16 a[58:59], v52 offset:21504
ds_read_b64_tr_b16 a[60:61], v53 offset:20480
ds_read_b64_tr_b16 a[62:63], v53 offset:21504
s_waitcnt lgkmcnt(0)
s_waitcnt vmcnt(28)
s_barrier
s_add_u32 m0, s47, 20480
s_add_u32 s2, s48, 2228224
buffer_load_dwordx4 v44, s[24:27], s2 offen offset:0 lds
s_add_u32 s2, s48, 2259968
buffer_load_dwordx4 v44, s[24:27], s2 offen offset:1024 lds
s_add_u32 s2, s48, 2291712
buffer_load_dwordx4 v45, s[24:27], s2 offen offset:2048 lds
s_add_u32 s2, s48, 2323456
buffer_load_dwordx4 v45, s[24:27], s2 offen offset:3072 lds
ds_read_b64_tr_b16 a[64:65], v50 offset:24576
ds_read_b64_tr_b16 a[66:67], v50 offset:25600
ds_read_b64_tr_b16 a[68:69], v51 offset:24576
ds_read_b64_tr_b16 a[70:71], v51 offset:25600
ds_read_b64_tr_b16 a[72:73], v52 offset:24576
ds_read_b64_tr_b16 a[74:75], v52 offset:25600
ds_read_b64_tr_b16 a[76:77], v53 offset:24576
ds_read_b64_tr_b16 a[78:79], v53 offset:25600
s_waitcnt lgkmcnt(0)
s_waitcnt vmcnt(28)
s_barrier
s_add_u32 m0, s47, 24576
s_add_u32 s2, s48, 3145728
buffer_load_dwordx4 v44, s[24:27], s2 offen offset:0 lds
s_add_u32 s2, s48, 3177472
buffer_load_dwordx4 v44, s[24:27], s2 offen offset:1024 lds
s_add_u32 s2, s48, 3209216
buffer_load_dwordx4 v45, s[24:27], s2 offen offset:2048 lds
s_add_u32 s2, s48, 3240960
buffer_load_dwordx4 v45, s[24:27], s2 offen offset:3072 lds
ds_read_b64_tr_b16 a[80:81], v50 offset:28672
ds_read_b64_tr_b16 a[82:83], v50 offset:29696
ds_read_b64_tr_b16 a[84:85], v51 offset:28672
ds_read_b64_tr_b16 a[86:87], v51 offset:29696
ds_read_b64_tr_b16 a[88:89], v52 offset:28672
ds_read_b64_tr_b16 a[90:91], v52 offset:29696
ds_read_b64_tr_b16 a[92:93], v53 offset:28672
ds_read_b64_tr_b16 a[94:95], v53 offset:29696
s_waitcnt lgkmcnt(0)
s_waitcnt vmcnt(28)
s_barrier
s_add_u32 m0, s47, 28672
s_add_u32 s2, s48, 3276800
buffer_load_dwordx4 v44, s[24:27], s2 offen offset:0 lds
s_add_u32 s2, s48, 3308544
buffer_load_dwordx4 v44, s[24:27], s2 offen offset:1024 lds
s_add_u32 s2, s48, 3340288
buffer_load_dwordx4 v45, s[24:27], s2 offen offset:2048 lds
s_add_u32 s2, s48, 3372032
buffer_load_dwordx4 v45, s[24:27], s2 offen offset:3072 lds
ds_read_b64_tr_b16 a[96:97], v50 offset:32768
ds_read_b64_tr_b16 a[98:99], v50 offset:33792
ds_read_b64_tr_b16 a[100:101], v51 offset:32768
ds_read_b64_tr_b16 a[102:103], v51 offset:33792
ds_read_b64_tr_b16 a[104:105], v52 offset:32768
ds_read_b64_tr_b16 a[106:107], v52 offset:33792
ds_read_b64_tr_b16 a[108:109], v53 offset:32768
ds_read_b64_tr_b16 a[110:111], v53 offset:33792
s_waitcnt lgkmcnt(0)
s_waitcnt vmcnt(28)
s_barrier
s_add_u32 m0, s47, 32768
s_add_u32 s2, s49, 4194304
buffer_load_dwordx4 v44, s[24:27], s2 offen offset:0 lds
s_add_u32 s2, s49, 4226048
buffer_load_dwordx4 v44, s[24:27], s2 offen offset:1024 lds
s_add_u32 s2, s49, 4257792
buffer_load_dwordx4 v45, s[24:27], s2 offen offset:2048 lds
s_add_u32 s2, s49, 4289536
buffer_load_dwordx4 v45, s[24:27], s2 offen offset:3072 lds
ds_read_b64_tr_b16 a[112:113], v50 offset:0
ds_read_b64_tr_b16 a[114:115], v50 offset:1024
ds_read_b64_tr_b16 a[116:117], v51 offset:0
ds_read_b64_tr_b16 a[118:119], v51 offset:1024
ds_read_b64_tr_b16 a[120:121], v52 offset:0
ds_read_b64_tr_b16 a[122:123], v52 offset:1024
ds_read_b64_tr_b16 a[124:125], v53 offset:0
ds_read_b64_tr_b16 a[126:127], v53 offset:1024
s_waitcnt lgkmcnt(0)
s_waitcnt vmcnt(28)
s_barrier
s_add_u32 m0, s47, 0
s_add_u32 s2, s48, 0
buffer_load_dwordx4 v44, s[16:19], s2 offen offset:0 lds
s_add_u32 s2, s48, 31744
buffer_load_dwordx4 v44, s[16:19], s2 offen offset:1024 lds
s_add_u32 s2, s48, 63488
buffer_load_dwordx4 v45, s[16:19], s2 offen offset:2048 lds
s_add_u32 s2, s48, 95232
buffer_load_dwordx4 v45, s[16:19], s2 offen offset:3072 lds
ds_read_b64_tr_b16 a[128:129], v50 offset:4096
ds_read_b64_tr_b16 a[130:131], v50 offset:5120
ds_read_b64_tr_b16 a[132:133], v51 offset:4096
ds_read_b64_tr_b16 a[134:135], v51 offset:5120
ds_read_b64_tr_b16 a[136:137], v52 offset:4096
ds_read_b64_tr_b16 a[138:139], v52 offset:5120
ds_read_b64_tr_b16 a[140:141], v53 offset:4096
ds_read_b64_tr_b16 a[142:143], v53 offset:5120
s_waitcnt lgkmcnt(0)
s_waitcnt vmcnt(28)
s_barrier
s_add_u32 m0, s47, 4096
s_add_u32 s2, s48, 131072
buffer_load_dwordx4 v44, s[16:19], s2 offen offset:0 lds
s_add_u32 s2, s48, 162816
buffer_load_dwordx4 v44, s[16:19], s2 offen offset:1024 lds
s_add_u32 s2, s48, 194560
buffer_load_dwordx4 v45, s[16:19], s2 offen offset:2048 lds
s_add_u32 s2, s48, 226304
buffer_load_dwordx4 v45, s[16:19], s2 offen offset:3072 lds
ds_read_b64_tr_b16 a[144:145], v50 offset:8192
ds_read_b64_tr_b16 a[146:147], v50 offset:9216
ds_read_b64_tr_b16 a[148:149], v51 offset:8192
ds_read_b64_tr_b16 a[150:151], v51 offset:9216
ds_read_b64_tr_b16 a[152:153], v52 offset:8192
ds_read_b64_tr_b16 a[154:155], v52 offset:9216
ds_read_b64_tr_b16 a[156:157], v53 offset:8192
ds_read_b64_tr_b16 a[158:159], v53 offset:9216
s_waitcnt lgkmcnt(0)
s_waitcnt vmcnt(28)
s_barrier
s_add_u32 m0, s47, 8192
s_add_u32 s2, s48, 1048576
buffer_load_dwordx4 v44, s[16:19], s2 offen offset:0 lds
s_add_u32 s2, s48, 1080320
buffer_load_dwordx4 v44, s[16:19], s2 offen offset:1024 lds
s_add_u32 s2, s48, 1112064
buffer_load_dwordx4 v45, s[16:19], s2 offen offset:2048 lds
s_add_u32 s2, s48, 1143808
buffer_load_dwordx4 v45, s[16:19], s2 offen offset:3072 lds
ds_read_b64_tr_b16 a[160:161], v50 offset:12288
ds_read_b64_tr_b16 a[162:163], v50 offset:13312
ds_read_b64_tr_b16 a[164:165], v51 offset:12288
ds_read_b64_tr_b16 a[166:167], v51 offset:13312
ds_read_b64_tr_b16 a[168:169], v52 offset:12288
ds_read_b64_tr_b16 a[170:171], v52 offset:13312
ds_read_b64_tr_b16 a[172:173], v53 offset:12288
ds_read_b64_tr_b16 a[174:175], v53 offset:13312
s_waitcnt lgkmcnt(0)
s_waitcnt vmcnt(28)
s_barrier
s_add_u32 m0, s47, 12288
s_add_u32 s2, s48, 1179648
buffer_load_dwordx4 v44, s[16:19], s2 offen offset:0 lds
s_add_u32 s2, s48, 1211392
buffer_load_dwordx4 v44, s[16:19], s2 offen offset:1024 lds
s_add_u32 s2, s48, 1243136
buffer_load_dwordx4 v45, s[16:19], s2 offen offset:2048 lds
s_add_u32 s2, s48, 1274880
buffer_load_dwordx4 v45, s[16:19], s2 offen offset:3072 lds
ds_read_b64_tr_b16 a[176:177], v50 offset:16384
ds_read_b64_tr_b16 a[178:179], v50 offset:17408
ds_read_b64_tr_b16 a[180:181], v51 offset:16384
ds_read_b64_tr_b16 a[182:183], v51 offset:17408
ds_read_b64_tr_b16 a[184:185], v52 offset:16384
ds_read_b64_tr_b16 a[186:187], v52 offset:17408
ds_read_b64_tr_b16 a[188:189], v53 offset:16384
ds_read_b64_tr_b16 a[190:191], v53 offset:17408
s_waitcnt lgkmcnt(0)
s_waitcnt vmcnt(28)
s_barrier
s_add_u32 m0, s47, 16384
s_add_u32 s2, s48, 2097152
buffer_load_dwordx4 v44, s[16:19], s2 offen offset:0 lds
s_add_u32 s2, s48, 2128896
buffer_load_dwordx4 v44, s[16:19], s2 offen offset:1024 lds
s_add_u32 s2, s48, 2160640
buffer_load_dwordx4 v45, s[16:19], s2 offen offset:2048 lds
s_add_u32 s2, s48, 2192384
buffer_load_dwordx4 v45, s[16:19], s2 offen offset:3072 lds
ds_read_b64_tr_b16 a[192:193], v50 offset:20480
ds_read_b64_tr_b16 a[194:195], v50 offset:21504
ds_read_b64_tr_b16 a[196:197], v51 offset:20480
ds_read_b64_tr_b16 a[198:199], v51 offset:21504
ds_read_b64_tr_b16 a[200:201], v52 offset:20480
ds_read_b64_tr_b16 a[202:203], v52 offset:21504
ds_read_b64_tr_b16 a[204:205], v53 offset:20480
ds_read_b64_tr_b16 a[206:207], v53 offset:21504
s_waitcnt lgkmcnt(0)
s_waitcnt vmcnt(28)
s_barrier
s_add_u32 m0, s47, 20480
s_add_u32 s2, s48, 2228224
buffer_load_dwordx4 v44, s[16:19], s2 offen offset:0 lds
s_add_u32 s2, s48, 2259968
buffer_load_dwordx4 v44, s[16:19], s2 offen offset:1024 lds
s_add_u32 s2, s48, 2291712
buffer_load_dwordx4 v45, s[16:19], s2 offen offset:2048 lds
s_add_u32 s2, s48, 2323456
buffer_load_dwordx4 v45, s[16:19], s2 offen offset:3072 lds
ds_read_b64_tr_b16 a[208:209], v50 offset:24576
ds_read_b64_tr_b16 a[210:211], v50 offset:25600
ds_read_b64_tr_b16 a[212:213], v51 offset:24576
ds_read_b64_tr_b16 a[214:215], v51 offset:25600
ds_read_b64_tr_b16 a[216:217], v52 offset:24576
ds_read_b64_tr_b16 a[218:219], v52 offset:25600
ds_read_b64_tr_b16 a[220:221], v53 offset:24576
ds_read_b64_tr_b16 a[222:223], v53 offset:25600
s_waitcnt lgkmcnt(0)
s_waitcnt vmcnt(28)
s_barrier
s_add_u32 m0, s47, 24576
s_add_u32 s2, s48, 3145728
buffer_load_dwordx4 v44, s[16:19], s2 offen offset:0 lds
s_add_u32 s2, s48, 3177472
buffer_load_dwordx4 v44, s[16:19], s2 offen offset:1024 lds
s_add_u32 s2, s48, 3209216
buffer_load_dwordx4 v45, s[16:19], s2 offen offset:2048 lds
s_add_u32 s2, s48, 3240960
buffer_load_dwordx4 v45, s[16:19], s2 offen offset:3072 lds
ds_read_b64_tr_b16 a[224:225], v50 offset:28672
ds_read_b64_tr_b16 a[226:227], v50 offset:29696
ds_read_b64_tr_b16 a[228:229], v51 offset:28672
ds_read_b64_tr_b16 a[230:231], v51 offset:29696
ds_read_b64_tr_b16 a[232:233], v52 offset:28672
ds_read_b64_tr_b16 a[234:235], v52 offset:29696
ds_read_b64_tr_b16 a[236:237], v53 offset:28672
ds_read_b64_tr_b16 a[238:239], v53 offset:29696
s_waitcnt lgkmcnt(0)
s_waitcnt vmcnt(28)
s_barrier
s_add_u32 m0, s47, 28672
s_add_u32 s2, s48, 3276800
buffer_load_dwordx4 v44, s[16:19], s2 offen offset:0 lds
s_add_u32 s2, s48, 3308544
buffer_load_dwordx4 v44, s[16:19], s2 offen offset:1024 lds
s_add_u32 s2, s48, 3340288
buffer_load_dwordx4 v45, s[16:19], s2 offen offset:2048 lds
s_add_u32 s2, s48, 3372032
buffer_load_dwordx4 v45, s[16:19], s2 offen offset:3072 lds
ds_read_b64_tr_b16 a[240:241], v50 offset:32768
ds_read_b64_tr_b16 a[242:243], v50 offset:33792
ds_read_b64_tr_b16 a[244:245], v51 offset:32768
ds_read_b64_tr_b16 a[246:247], v51 offset:33792
ds_read_b64_tr_b16 a[248:249], v52 offset:32768
ds_read_b64_tr_b16 a[250:251], v52 offset:33792
ds_read_b64_tr_b16 a[252:253], v53 offset:32768
ds_read_b64_tr_b16 a[254:255], v53 offset:33792
s_waitcnt lgkmcnt(0)
s_waitcnt vmcnt(28)
s_barrier
s_add_u32 m0, s47, 32768
s_add_u32 s2, s49, 4194304
buffer_load_dwordx4 v44, s[16:19], s2 offen offset:0 lds
s_add_u32 s2, s49, 4226048
buffer_load_dwordx4 v44, s[16:19], s2 offen offset:1024 lds
s_add_u32 s2, s49, 4257792
buffer_load_dwordx4 v45, s[16:19], s2 offen offset:2048 lds
s_add_u32 s2, s49, 4289536
buffer_load_dwordx4 v45, s[16:19], s2 offen offset:3072 lds
ds_read_b64_tr_b16 v[80:81], v50 offset:0
ds_read_b64_tr_b16 v[82:83], v50 offset:1024
ds_read_b64_tr_b16 v[84:85], v51 offset:0
ds_read_b64_tr_b16 v[86:87], v51 offset:1024
ds_read_b64_tr_b16 v[88:89], v52 offset:0
ds_read_b64_tr_b16 v[90:91], v52 offset:1024
ds_read_b64_tr_b16 v[92:93], v53 offset:0
ds_read_b64_tr_b16 v[94:95], v53 offset:1024
s_waitcnt lgkmcnt(0)
s_waitcnt vmcnt(28)
s_barrier
ds_read_b64_tr_b16 v[96:97], v50 offset:4096
ds_read_b64_tr_b16 v[98:99], v50 offset:5120
ds_read_b64_tr_b16 v[100:101], v51 offset:4096
ds_read_b64_tr_b16 v[102:103], v51 offset:5120
ds_read_b64_tr_b16 v[104:105], v52 offset:4096
ds_read_b64_tr_b16 v[106:107], v52 offset:5120
ds_read_b64_tr_b16 v[108:109], v53 offset:4096
ds_read_b64_tr_b16 v[110:111], v53 offset:5120
s_waitcnt lgkmcnt(0)
s_waitcnt vmcnt(24)
s_barrier
ds_read_b64_tr_b16 v[112:113], v50 offset:8192
ds_read_b64_tr_b16 v[114:115], v50 offset:9216
ds_read_b64_tr_b16 v[116:117], v51 offset:8192
ds_read_b64_tr_b16 v[118:119], v51 offset:9216
ds_read_b64_tr_b16 v[120:121], v52 offset:8192
ds_read_b64_tr_b16 v[122:123], v52 offset:9216
ds_read_b64_tr_b16 v[124:125], v53 offset:8192
ds_read_b64_tr_b16 v[126:127], v53 offset:9216
s_waitcnt lgkmcnt(0)
s_waitcnt vmcnt(20)
s_barrier
ds_read_b64_tr_b16 v[128:129], v50 offset:12288
ds_read_b64_tr_b16 v[130:131], v50 offset:13312
ds_read_b64_tr_b16 v[132:133], v51 offset:12288
ds_read_b64_tr_b16 v[134:135], v51 offset:13312
ds_read_b64_tr_b16 v[136:137], v52 offset:12288
ds_read_b64_tr_b16 v[138:139], v52 offset:13312
ds_read_b64_tr_b16 v[140:141], v53 offset:12288
ds_read_b64_tr_b16 v[142:143], v53 offset:13312
s_waitcnt lgkmcnt(0)
s_waitcnt vmcnt(16)
s_barrier
ds_read_b64_tr_b16 v[144:145], v50 offset:16384
ds_read_b64_tr_b16 v[146:147], v50 offset:17408
ds_read_b64_tr_b16 v[148:149], v51 offset:16384
ds_read_b64_tr_b16 v[150:151], v51 offset:17408
ds_read_b64_tr_b16 v[152:153], v52 offset:16384
ds_read_b64_tr_b16 v[154:155], v52 offset:17408
ds_read_b64_tr_b16 v[156:157], v53 offset:16384
ds_read_b64_tr_b16 v[158:159], v53 offset:17408
s_waitcnt lgkmcnt(0)
s_waitcnt vmcnt(12)
s_barrier
ds_read_b64_tr_b16 v[160:161], v50 offset:20480
ds_read_b64_tr_b16 v[162:163], v50 offset:21504
ds_read_b64_tr_b16 v[164:165], v51 offset:20480
ds_read_b64_tr_b16 v[166:167], v51 offset:21504
ds_read_b64_tr_b16 v[168:169], v52 offset:20480
ds_read_b64_tr_b16 v[170:171], v52 offset:21504
ds_read_b64_tr_b16 v[172:173], v53 offset:20480
ds_read_b64_tr_b16 v[174:175], v53 offset:21504
s_waitcnt lgkmcnt(0)
s_waitcnt vmcnt(8)
s_barrier
ds_read_b64_tr_b16 v[176:177], v50 offset:24576
ds_read_b64_tr_b16 v[178:179], v50 offset:25600
ds_read_b64_tr_b16 v[180:181], v51 offset:24576
ds_read_b64_tr_b16 v[182:183], v51 offset:25600
ds_read_b64_tr_b16 v[184:185], v52 offset:24576
ds_read_b64_tr_b16 v[186:187], v52 offset:25600
ds_read_b64_tr_b16 v[188:189], v53 offset:24576
ds_read_b64_tr_b16 v[190:191], v53 offset:25600
s_waitcnt lgkmcnt(0)
s_waitcnt vmcnt(4)
s_barrier
ds_read_b64_tr_b16 v[192:193], v50 offset:28672
ds_read_b64_tr_b16 v[194:195], v50 offset:29696
ds_read_b64_tr_b16 v[196:197], v51 offset:28672
ds_read_b64_tr_b16 v[198:199], v51 offset:29696
ds_read_b64_tr_b16 v[200:201], v52 offset:28672
ds_read_b64_tr_b16 v[202:203], v52 offset:29696
ds_read_b64_tr_b16 v[204:205], v53 offset:28672
ds_read_b64_tr_b16 v[206:207], v53 offset:29696
s_waitcnt lgkmcnt(0)
s_waitcnt vmcnt(0)
s_barrier
ds_read_b64_tr_b16 v[208:209], v50 offset:32768
ds_read_b64_tr_b16 v[210:211], v50 offset:33792
ds_read_b64_tr_b16 v[212:213], v51 offset:32768
ds_read_b64_tr_b16 v[214:215], v51 offset:33792
ds_read_b64_tr_b16 v[216:217], v52 offset:32768
ds_read_b64_tr_b16 v[218:219], v52 offset:33792
ds_read_b64_tr_b16 v[220:221], v53 offset:32768
ds_read_b64_tr_b16 v[222:223], v53 offset:33792
s_waitcnt lgkmcnt(0)
s_barrier
s_mov_b32 s47, s56
v_and_b32 v20, 15, v0
v_lshrrev_b32 v21, 4, v0
s_and_b32 s2, s42, 1
s_lshl_b32 s2, s2, 4
s_lshr_b32 s3, s42, 1
s_lshl_b32 s3, s3, 6
v_add_u32 v22, s2, v20
v_mul_u32_u24 v23, 1152, v22
v_add_u32 v23, s3, v23
v_lshl_add_u32 v2, v21, 4, v23
v_lshrrev_b32 v24, 1, v21
v_lshlrev_b32 v24, 5, v24
v_add3_u32 v1, v2, v24, s3
v_add_u32 v2, 1024, v2
s_mul_i32 s49, s47, 36864
s_lshl_b32 s55, s42, 10
s_mov_b32 s50, 0
s_mov_b32 s14, s55
s_add_u32 m0, s14, 0
s_add_u32 s2, s49, 0
buffer_load_dwordx4 v1, s[32:35], s2 offen lds
s_add_u32 m0, s14, 4096
s_add_u32 s2, s49, 32
buffer_load_dwordx4 v1, s[32:35], s2 offen lds
s_add_u32 m0, s14, 8192
s_add_u32 s2, s49, 256
buffer_load_dwordx4 v1, s[32:35], s2 offen lds
s_add_u32 m0, s14, 12288
s_add_u32 s2, s49, 288
buffer_load_dwordx4 v1, s[32:35], s2 offen lds
s_add_u32 m0, s14, 16384
s_add_u32 s2, s49, 512
buffer_load_dwordx4 v1, s[32:35], s2 offen lds
s_add_u32 m0, s14, 20480
s_add_u32 s2, s49, 544
buffer_load_dwordx4 v1, s[32:35], s2 offen lds
s_add_u32 m0, s14, 24576
s_add_u32 s2, s49, 768
buffer_load_dwordx4 v1, s[32:35], s2 offen lds
s_add_u32 m0, s14, 28672
s_add_u32 s2, s49, 800
buffer_load_dwordx4 v1, s[32:35], s2 offen lds
s_add_u32 m0, s14, 32768
s_nop 0
buffer_load_dwordx4 v2, s[32:35], s49 offen lds
s_add_u32 s49, s49, 147456
v_lshlrev_b32 v24, 2, v21
v_sub_u32 v22, v22, v24
v_cmp_le_i32 s[60:61], 0, v22
v_cmp_le_i32 s[62:63], 1, v22
v_cmp_le_i32 s[64:65], 2, v22
v_cmp_le_i32 s[66:67], 3, v22
v_cmp_le_i32 s[68:69], 16, v22
v_cmp_le_i32 s[70:71], 17, v22
v_cmp_le_i32 s[72:73], 18, v22
v_cmp_le_i32 s[74:75], 19, v22
v_lshrrev_b32 v24, 2, v20
v_cmp_eq_u32 vcc, v24, v21
v_and_b32 v24, 3, v20
s_nop 0
v_cndmask_b32 v24, 7, v24, vcc
v_mov_b32 v25, 0x3f803f80
v_cmp_eq_u32 vcc, 2, v24
s_nop 1
v_cndmask_b32 v8, 0, v25, vcc
v_cmp_eq_u32 vcc, 3, v24
s_nop 1
v_cndmask_b32 v9, 0, v25, vcc
v_cmp_eq_u32 vcc, 0, v24
s_nop 1
v_cndmask_b32 v10, 0, v25, vcc
v_cmp_eq_u32 vcc, 1, v24
s_nop 1
v_cndmask_b32 v11, 0, v25, vcc
v_and_b32 v24, 1, v20
v_mul_u32_u24 v24, 0xaaaa, v24
v_add_u32 v4, 0x4444, v24
v_lshlrev_b32 v0, 4, v0
v_add_u32 v12, 122880, v0
v_add_u32 v13, s55, v12
s_lshl_b32 s2, s47, 5
s_add_u32 s2, s2, s41
s_lshl_b32 s2, s2, 14
s_lshl_b32 s3, s42, 12
s_add_u32 s2, s2, s3
s_add_u32 s51, s2, 16777216
s_lshl_b32 s53, s47, 14
s_add_u32 s53, s53, 1048576
s_lshl_b32 s2, s47, 18
s_and_b32 s3, s42, 1
s_lshl_b32 s3, s3, 17
s_add_u32 s2, s2, s3
s_lshl_b32 s3, s41, 12
s_add_u32 s2, s2, s3
s_lshr_b32 s3, s42, 1
s_lshl_b32 s3, s3, 11
s_add_u32 s2, s2, s3
s_add_u32 s54, s2, 50331648
s_mov_b32 s52, 0x3e0293ee
s_mov_b32 s48, 0
v_mov_b32 v24, 192
WD_2:
s_sub_u32 s45, s45, 1
s_cbranch_scc1 END
global_load_dword v25, v24, s[12:13] sc1
s_waitcnt vmcnt(0)
v_readfirstlane_b32 s2, v25
s_cmp_lt_u32 s2, 1
s_cbranch_scc1 WD_2
s_barrier
s_nop 1
P_LOOP:
s_cmp_eq_u32 s48, 16
s_cbranch_scc1 P_ATT
s_mul_i32 s3, s50, 36864
v_add_u32 v3, s3, v0
ds_read_b128 v[64:67], v3 offset:0
ds_read_b128 v[68:71], v3 offset:1024
s_cmp_eq_u32 s48, 15
s_cbranch_scc1 P_NOX
s_sub_u32 s14, 36864, s3
s_add_u32 s14, s14, s55
s_add_u32 m0, s14, 0
s_add_u32 s2, s49, 0
buffer_load_dwordx4 v1, s[32:35], s2 offen lds
s_add_u32 m0, s14, 4096
s_add_u32 s2, s49, 32
buffer_load_dwordx4 v1, s[32:35], s2 offen lds
s_add_u32 m0, s14, 8192
s_add_u32 s2, s49, 256
buffer_load_dwordx4 v1, s[32:35], s2 offen lds
s_add_u32 m0, s14, 12288
s_add_u32 s2, s49, 288
buffer_load_dwordx4 v1, s[32:35], s2 offen lds
s_add_u32 m0, s14, 16384
s_add_u32 s2, s49, 512
buffer_load_dwordx4 v1, s[32:35], s2 offen lds
s_add_u32 m0, s14, 20480
s_add_u32 s2, s49, 544
buffer_load_dwordx4 v1, s[32:35], s2 offen lds
s_add_u32 m0, s14, 24576
s_add_u32 s2, s49, 768
buffer_load_dwordx4 v1, s[32:35], s2 offen lds
s_add_u32 m0, s14, 28672
s_add_u32 s2, s49, 800
buffer_load_dwordx4 v1, s[32:35], s2 offen lds
s_add_u32 m0, s14, 32768
s_nop 0
buffer_load_dwordx4 v2, s[32:35], s49 offen lds
s_add_u32 s49, s49, 147456
P_NOX:
s_waitcnt lgkmcnt(0)
v_mfma_f32_16x16x32_bf16 v[32:35], v[224:227], v[64:67], 0
ds_read_b128 v[72:75], v3 offset:2048
ds_read_b128 v[76:79], v3 offset:3072
v_mfma_f32_16x16x32_bf16 v[36:39], v[232:235], v[64:67], 0
v_mfma_f32_16x16x32_bf16 v[40:43], v[224:227], v[68:71], 0
v_mfma_f32_16x16x32_bf16 v[44:47], v[232:235], v[68:71], 0
v_mfma_f32_16x16x32_bf16 v[48:51], v[64:67], a[112:115], 0
v_mfma_f32_16x16x32_bf16 v[56:59], v[64:67], a[120:123], 0
v_mfma_f32_16x16x32_bf16 v[52:55], v[68:71], a[112:115], 0
v_mfma_f32_16x16x32_bf16 v[60:63], v[68:71], a[120:123], 0
v_mfma_f32_16x16x32_bf16 v[16:19], v[80:83], v[64:67], 0
v_mfma_f32_16x16x32_bf16 v[20:23], v[88:91], v[64:67], 0
v_mfma_f32_16x16x32_bf16 v[24:27], v[80:83], v[68:71], 0
v_mfma_f32_16x16x32_bf16 v[28:31], v[88:91], v[68:71], 0
s_waitcnt lgkmcnt(0)
v_mfma_f32_16x16x32_bf16 v[32:35], v[228:231], v[72:75], v[32:35]
ds_read_b128 v[64:67], v3 offset:4096
ds_read_b128 v[68:71], v3 offset:5120
v_mfma_f32_16x16x32_bf16 v[36:39], v[236:239], v[72:75], v[36:39]
v_mfma_f32_16x16x32_bf16 v[40:43], v[228:231], v[76:79], v[40:43]
v_mfma_f32_16x16x32_bf16 v[44:47], v[236:239], v[76:79], v[44:47]
v_mfma_f32_16x16x32_bf16 v[48:51], v[72:75], a[116:119], v[48:51]
v_mfma_f32_16x16x32_bf16 v[56:59], v[72:75], a[124:127], v[56:59]
v_mfma_f32_16x16x32_bf16 v[52:55], v[76:79], a[116:119], v[52:55]
v_mfma_f32_16x16x32_bf16 v[60:63], v[76:79], a[124:127], v[60:63]
v_mfma_f32_16x16x32_bf16 v[16:19], v[84:87], v[72:75], v[16:19]
v_mfma_f32_16x16x32_bf16 v[20:23], v[92:95], v[72:75], v[20:23]
v_mfma_f32_16x16x32_bf16 v[24:27], v[84:87], v[76:79], v[24:27]
v_mfma_f32_16x16x32_bf16 v[28:31], v[92:95], v[76:79], v[28:31]
s_waitcnt lgkmcnt(0)
v_mfma_f32_16x16x32_bf16 v[32:35], v[240:243], v[64:67], v[32:35]
ds_read_b128 v[72:75], v3 offset:6144
ds_read_b128 v[76:79], v3 offset:7168
v_mfma_f32_16x16x32_bf16 v[36:39], v[248:251], v[64:67], v[36:39]
v_mfma_f32_16x16x32_bf16 v[40:43], v[240:243], v[68:71], v[40:43]
v_mfma_f32_16x16x32_bf16 v[44:47], v[248:251], v[68:71], v[44:47]
v_mfma_f32_16x16x32_bf16 v[48:51], v[64:67], a[128:131], v[48:51]
v_mfma_f32_16x16x32_bf16 v[56:59], v[64:67], a[136:139], v[56:59]
v_mfma_f32_16x16x32_bf16 v[52:55], v[68:71], a[128:131], v[52:55]
v_mfma_f32_16x16x32_bf16 v[60:63], v[68:71], a[136:139], v[60:63]
v_mfma_f32_16x16x32_bf16 v[16:19], v[96:99], v[64:67], v[16:19]
v_mfma_f32_16x16x32_bf16 v[20:23], v[104:107], v[64:67], v[20:23]
v_mfma_f32_16x16x32_bf16 v[24:27], v[96:99], v[68:71], v[24:27]
v_mfma_f32_16x16x32_bf16 v[28:31], v[104:107], v[68:71], v[28:31]
s_waitcnt lgkmcnt(0)
v_mfma_f32_16x16x32_bf16 v[32:35], v[244:247], v[72:75], v[32:35]
ds_read_b128 v[64:67], v3 offset:8192
ds_read_b128 v[68:71], v3 offset:9216
v_mfma_f32_16x16x32_bf16 v[36:39], v[252:255], v[72:75], v[36:39]
v_mfma_f32_16x16x32_bf16 v[40:43], v[244:247], v[76:79], v[40:43]
v_mfma_f32_16x16x32_bf16 v[44:47], v[252:255], v[76:79], v[44:47]
v_mfma_f32_16x16x32_bf16 v[48:51], v[72:75], a[132:135], v[48:51]
v_mfma_f32_16x16x32_bf16 v[56:59], v[72:75], a[140:143], v[56:59]
v_mfma_f32_16x16x32_bf16 v[52:55], v[76:79], a[132:135], v[52:55]
v_mfma_f32_16x16x32_bf16 v[60:63], v[76:79], a[140:143], v[60:63]
v_mfma_f32_16x16x32_bf16 v[16:19], v[100:103], v[72:75], v[16:19]
v_mfma_f32_16x16x32_bf16 v[20:23], v[108:111], v[72:75], v[20:23]
v_mfma_f32_16x16x32_bf16 v[24:27], v[100:103], v[76:79], v[24:27]
v_mfma_f32_16x16x32_bf16 v[28:31], v[108:111], v[76:79], v[28:31]
s_waitcnt lgkmcnt(0)
v_mfma_f32_16x16x32_bf16 v[32:35], a[0:3], v[64:67], v[32:35]
ds_read_b128 v[72:75], v3 offset:10240
ds_read_b128 v[76:79], v3 offset:11264
v_mfma_f32_16x16x32_bf16 v[36:39], a[8:11], v[64:67], v[36:39]
v_mfma_f32_16x16x32_bf16 v[40:43], a[0:3], v[68:71], v[40:43]
v_mfma_f32_16x16x32_bf16 v[44:47], a[8:11], v[68:71], v[44:47]
v_mfma_f32_16x16x32_bf16 v[48:51], v[64:67], a[144:147], v[48:51]
v_mfma_f32_16x16x32_bf16 v[56:59], v[64:67], a[152:155], v[56:59]
v_mfma_f32_16x16x32_bf16 v[52:55], v[68:71], a[144:147], v[52:55]
v_mfma_f32_16x16x32_bf16 v[60:63], v[68:71], a[152:155], v[60:63]
v_mfma_f32_16x16x32_bf16 v[16:19], v[112:115], v[64:67], v[16:19]
v_mfma_f32_16x16x32_bf16 v[20:23], v[120:123], v[64:67], v[20:23]
v_mfma_f32_16x16x32_bf16 v[24:27], v[112:115], v[68:71], v[24:27]
v_mfma_f32_16x16x32_bf16 v[28:31], v[120:123], v[68:71], v[28:31]
s_waitcnt lgkmcnt(0)
v_mfma_f32_16x16x32_bf16 v[32:35], a[4:7], v[72:75], v[32:35]
ds_read_b128 v[64:67], v3 offset:12288
ds_read_b128 v[68:71], v3 offset:13312
v_mfma_f32_16x16x32_bf16 v[36:39], a[12:15], v[72:75], v[36:39]
v_mfma_f32_16x16x32_bf16 v[40:43], a[4:7], v[76:79], v[40:43]
v_mfma_f32_16x16x32_bf16 v[44:47], a[12:15], v[76:79], v[44:47]
v_mfma_f32_16x16x32_bf16 v[48:51], v[72:75], a[148:151], v[48:51]
v_mfma_f32_16x16x32_bf16 v[56:59], v[72:75], a[156:159], v[56:59]
v_mfma_f32_16x16x32_bf16 v[52:55], v[76:79], a[148:151], v[52:55]
v_mfma_f32_16x16x32_bf16 v[60:63], v[76:79], a[156:159], v[60:63]
v_mfma_f32_16x16x32_bf16 v[16:19], v[116:119], v[72:75], v[16:19]
v_mfma_f32_16x16x32_bf16 v[20:23], v[124:127], v[72:75], v[20:23]
v_mfma_f32_16x16x32_bf16 v[24:27], v[116:119], v[76:79], v[24:27]
v_mfma_f32_16x16x32_bf16 v[28:31], v[124:127], v[76:79], v[28:31]
s_waitcnt lgkmcnt(0)
v_mfma_f32_16x16x32_bf16 v[32:35], a[16:19], v[64:67], v[32:35]
ds_read_b128 v[72:75], v3 offset:14336
ds_read_b128 v[76:79], v3 offset:15360
v_mfma_f32_16x16x32_bf16 v[36:39], a[24:27], v[64:67], v[36:39]
v_mfma_f32_16x16x32_bf16 v[40:43], a[16:19], v[68:71], v[40:43]
v_mfma_f32_16x16x32_bf16 v[44:47], a[24:27], v[68:71], v[44:47]
v_mfma_f32_16x16x32_bf16 v[48:51], v[64:67], a[160:163], v[48:51]
v_mfma_f32_16x16x32_bf16 v[56:59], v[64:67], a[168:171], v[56:59]
v_mfma_f32_16x16x32_bf16 v[52:55], v[68:71], a[160:163], v[52:55]
v_mfma_f32_16x16x32_bf16 v[60:63], v[68:71], a[168:171], v[60:63]
v_mfma_f32_16x16x32_bf16 v[16:19], v[128:131], v[64:67], v[16:19]
v_mfma_f32_16x16x32_bf16 v[20:23], v[136:139], v[64:67], v[20:23]
v_mfma_f32_16x16x32_bf16 v[24:27], v[128:131], v[68:71], v[24:27]
v_mfma_f32_16x16x32_bf16 v[28:31], v[136:139], v[68:71], v[28:31]
s_waitcnt lgkmcnt(0)
v_mfma_f32_16x16x32_bf16 v[32:35], a[20:23], v[72:75], v[32:35]
ds_read_b128 v[64:67], v3 offset:16384
ds_read_b128 v[68:71], v3 offset:17408
v_mfma_f32_16x16x32_bf16 v[36:39], a[28:31], v[72:75], v[36:39]
v_mfma_f32_16x16x32_bf16 v[40:43], a[20:23], v[76:79], v[40:43]
v_mfma_f32_16x16x32_bf16 v[44:47], a[28:31], v[76:79], v[44:47]
v_mfma_f32_16x16x32_bf16 v[48:51], v[72:75], a[164:167], v[48:51]
v_mfma_f32_16x16x32_bf16 v[56:59], v[72:75], a[172:175], v[56:59]
v_mfma_f32_16x16x32_bf16 v[52:55], v[76:79], a[164:167], v[52:55]
v_mfma_f32_16x16x32_bf16 v[60:63], v[76:79], a[172:175], v[60:63]
v_mfma_f32_16x16x32_bf16 v[16:19], v[132:135], v[72:75], v[16:19]
v_mfma_f32_16x16x32_bf16 v[20:23], v[140:143], v[72:75], v[20:23]
v_mfma_f32_16x16x32_bf16 v[24:27], v[132:135], v[76:79], v[24:27]
v_mfma_f32_16x16x32_bf16 v[28:31], v[140:143], v[76:79], v[28:31]
s_waitcnt lgkmcnt(0)
v_mfma_f32_16x16x32_bf16 v[32:35], a[32:35], v[64:67], v[32:35]
ds_read_b128 v[72:75], v3 offset:18432
ds_read_b128 v[76:79], v3 offset:19456
v_mfma_f32_16x16x32_bf16 v[36:39], a[40:43], v[64:67], v[36:39]
v_mfma_f32_16x16x32_bf16 v[40:43], a[32:35], v[68:71], v[40:43]
v_mfma_f32_16x16x32_bf16 v[44:47], a[40:43], v[68:71], v[44:47]
v_mfma_f32_16x16x32_bf16 v[48:51], v[64:67], a[176:179], v[48:51]
v_mfma_f32_16x16x32_bf16 v[56:59], v[64:67], a[184:187], v[56:59]
v_mfma_f32_16x16x32_bf16 v[52:55], v[68:71], a[176:179], v[52:55]
v_mfma_f32_16x16x32_bf16 v[60:63], v[68:71], a[184:187], v[60:63]
v_mfma_f32_16x16x32_bf16 v[16:19], v[144:147], v[64:67], v[16:19]
v_mfma_f32_16x16x32_bf16 v[20:23], v[152:155], v[64:67], v[20:23]
v_mfma_f32_16x16x32_bf16 v[24:27], v[144:147], v[68:71], v[24:27]
v_mfma_f32_16x16x32_bf16 v[28:31], v[152:155], v[68:71], v[28:31]
s_waitcnt lgkmcnt(0)
v_mfma_f32_16x16x32_bf16 v[32:35], a[36:39], v[72:75], v[32:35]
ds_read_b128 v[64:67], v3 offset:20480
ds_read_b128 v[68:71], v3 offset:21504
v_mfma_f32_16x16x32_bf16 v[36:39], a[44:47], v[72:75], v[36:39]
v_mfma_f32_16x16x32_bf16 v[40:43], a[36:39], v[76:79], v[40:43]
v_mfma_f32_16x16x32_bf16 v[44:47], a[44:47], v[76:79], v[44:47]
v_mfma_f32_16x16x32_bf16 v[48:51], v[72:75], a[180:183], v[48:51]
v_mfma_f32_16x16x32_bf16 v[56:59], v[72:75], a[188:191], v[56:59]
v_mfma_f32_16x16x32_bf16 v[52:55], v[76:79], a[180:183], v[52:55]
v_mfma_f32_16x16x32_bf16 v[60:63], v[76:79], a[188:191], v[60:63]
v_mfma_f32_16x16x32_bf16 v[16:19], v[148:151], v[72:75], v[16:19]
v_mfma_f32_16x16x32_bf16 v[20:23], v[156:159], v[72:75], v[20:23]
v_mfma_f32_16x16x32_bf16 v[24:27], v[148:151], v[76:79], v[24:27]
v_mfma_f32_16x16x32_bf16 v[28:31], v[156:159], v[76:79], v[28:31]
s_waitcnt lgkmcnt(0)
v_mfma_f32_16x16x32_bf16 v[32:35], a[48:51], v[64:67], v[32:35]
ds_read_b128 v[72:75], v3 offset:22528
ds_read_b128 v[76:79], v3 offset:23552
v_mfma_f32_16x16x32_bf16 v[36:39], a[56:59], v[64:67], v[36:39]
v_mfma_f32_16x16x32_bf16 v[40:43], a[48:51], v[68:71], v[40:43]
v_mfma_f32_16x16x32_bf16 v[44:47], a[56:59], v[68:71], v[44:47]
v_mfma_f32_16x16x32_bf16 v[48:51], v[64:67], a[192:195], v[48:51]
v_mfma_f32_16x16x32_bf16 v[56:59], v[64:67], a[200:203], v[56:59]
v_mfma_f32_16x16x32_bf16 v[52:55], v[68:71], a[192:195], v[52:55]
v_mfma_f32_16x16x32_bf16 v[60:63], v[68:71], a[200:203], v[60:63]
v_mfma_f32_16x16x32_bf16 v[16:19], v[160:163], v[64:67], v[16:19]
v_mfma_f32_16x16x32_bf16 v[20:23], v[168:171], v[64:67], v[20:23]
v_mfma_f32_16x16x32_bf16 v[24:27], v[160:163], v[68:71], v[24:27]
v_mfma_f32_16x16x32_bf16 v[28:31], v[168:171], v[68:71], v[28:31]
s_waitcnt lgkmcnt(0)
v_mfma_f32_16x16x32_bf16 v[32:35], a[52:55], v[72:75], v[32:35]
ds_read_b128 v[64:67], v3 offset:24576
ds_read_b128 v[68:71], v3 offset:25600
v_mfma_f32_16x16x32_bf16 v[36:39], a[60:63], v[72:75], v[36:39]
v_mfma_f32_16x16x32_bf16 v[40:43], a[52:55], v[76:79], v[40:43]
v_mfma_f32_16x16x32_bf16 v[44:47], a[60:63], v[76:79], v[44:47]
v_mfma_f32_16x16x32_bf16 v[48:51], v[72:75], a[196:199], v[48:51]
v_mfma_f32_16x16x32_bf16 v[56:59], v[72:75], a[204:207], v[56:59]
v_mfma_f32_16x16x32_bf16 v[52:55], v[76:79], a[196:199], v[52:55]
v_mfma_f32_16x16x32_bf16 v[60:63], v[76:79], a[204:207], v[60:63]
v_mfma_f32_16x16x32_bf16 v[16:19], v[164:167], v[72:75], v[16:19]
v_mfma_f32_16x16x32_bf16 v[20:23], v[172:175], v[72:75], v[20:23]
v_mfma_f32_16x16x32_bf16 v[24:27], v[164:167], v[76:79], v[24:27]
v_mfma_f32_16x16x32_bf16 v[28:31], v[172:175], v[76:79], v[28:31]
s_waitcnt lgkmcnt(0)
v_mfma_f32_16x16x32_bf16 v[32:35], a[64:67], v[64:67], v[32:35]
ds_read_b128 v[72:75], v3 offset:26624
ds_read_b128 v[76:79], v3 offset:27648
v_mfma_f32_16x16x32_bf16 v[36:39], a[72:75], v[64:67], v[36:39]
v_mfma_f32_16x16x32_bf16 v[40:43], a[64:67], v[68:71], v[40:43]
v_mfma_f32_16x16x32_bf16 v[44:47], a[72:75], v[68:71], v[44:47]
v_mfma_f32_16x16x32_bf16 v[48:51], v[64:67], a[208:211], v[48:51]
v_mfma_f32_16x16x32_bf16 v[56:59], v[64:67], a[216:219], v[56:59]
v_mfma_f32_16x16x32_bf16 v[52:55], v[68:71], a[208:211], v[52:55]
v_mfma_f32_16x16x32_bf16 v[60:63], v[68:71], a[216:219], v[60:63]
v_mfma_f32_16x16x32_bf16 v[16:19], v[176:179], v[64:67], v[16:19]
v_mfma_f32_16x16x32_bf16 v[20:23], v[184:187], v[64:67], v[20:23]
v_mfma_f32_16x16x32_bf16 v[24:27], v[176:179], v[68:71], v[24:27]
v_mfma_f32_16x16x32_bf16 v[28:31], v[184:187], v[68:71], v[28:31]
s_waitcnt lgkmcnt(0)
v_mfma_f32_16x16x32_bf16 v[32:35], a[68:71], v[72:75], v[32:35]
ds_read_b128 v[64:67], v3 offset:28672
ds_read_b128 v[68:71], v3 offset:29696
v_mfma_f32_16x16x32_bf16 v[36:39], a[76:79], v[72:75], v[36:39]
v_mfma_f32_16x16x32_bf16 v[40:43], a[68:71], v[76:79], v[40:43]
v_mfma_f32_16x16x32_bf16 v[44:47], a[76:79], v[76:79], v[44:47]
v_mfma_f32_16x16x32_bf16 v[48:51], v[72:75], a[212:215], v[48:51]
v_mfma_f32_16x16x32_bf16 v[56:59], v[72:75], a[220:223], v[56:59]
v_mfma_f32_16x16x32_bf16 v[52:55], v[76:79], a[212:215], v[52:55]
v_mfma_f32_16x16x32_bf16 v[60:63], v[76:79], a[220:223], v[60:63]
v_mfma_f32_16x16x32_bf16 v[16:19], v[180:183], v[72:75], v[16:19]
v_mfma_f32_16x16x32_bf16 v[20:23], v[188:191], v[72:75], v[20:23]
v_mfma_f32_16x16x32_bf16 v[24:27], v[180:183], v[76:79], v[24:27]
v_mfma_f32_16x16x32_bf16 v[28:31], v[188:191], v[76:79], v[28:31]
s_waitcnt lgkmcnt(0)
v_mfma_f32_16x16x32_bf16 v[32:35], a[80:83], v[64:67], v[32:35]
ds_read_b128 v[72:75], v3 offset:30720
ds_read_b128 v[76:79], v3 offset:31744
v_mfma_f32_16x16x32_bf16 v[36:39], a[88:91], v[64:67], v[36:39]
v_mfma_f32_16x16x32_bf16 v[40:43], a[80:83], v[68:71], v[40:43]
v_mfma_f32_16x16x32_bf16 v[44:47], a[88:91], v[68:71], v[44:47]
v_mfma_f32_16x16x32_bf16 v[48:51], v[64:67], a[224:227], v[48:51]
v_mfma_f32_16x16x32_bf16 v[56:59], v[64:67], a[232:235], v[56:59]
v_mfma_f32_16x16x32_bf16 v[52:55], v[68:71], a[224:227], v[52:55]
v_mfma_f32_16x16x32_bf16 v[60:63], v[68:71], a[232:235], v[60:63]
v_mfma_f32_16x16x32_bf16 v[16:19], v[192:195], v[64:67], v[16:19]
v_mfma_f32_16x16x32_bf16 v[20:23], v[200:203], v[64:67], v[20:23]
v_mfma_f32_16x16x32_bf16 v[24:27], v[192:195], v[68:71], v[24:27]
v_mfma_f32_16x16x32_bf16 v[28:31], v[200:203], v[68:71], v[28:31]
s_waitcnt lgkmcnt(0)
v_mfma_f32_16x16x32_bf16 v[32:35], a[84:87], v[72:75], v[32:35]
ds_read_b128 v[64:67], v3 offset:32768
ds_read_b128 v[68:71], v3 offset:33792
v_mfma_f32_16x16x32_bf16 v[36:39], a[92:95], v[72:75], v[36:39]
v_mfma_f32_16x16x32_bf16 v[40:43], a[84:87], v[76:79], v[40:43]
v_mfma_f32_16x16x32_bf16 v[44:47], a[92:95], v[76:79], v[44:47]
v_mfma_f32_16x16x32_bf16 v[48:51], v[72:75], a[228:231], v[48:51]
v_mfma_f32_16x16x32_bf16 v[56:59], v[72:75], a[236:239], v[56:59]
v_mfma_f32_16x16x32_bf16 v[52:55], v[76:79], a[228:231], v[52:55]
v_mfma_f32_16x16x32_bf16 v[60:63], v[76:79], a[236:239], v[60:63]
v_mfma_f32_16x16x32_bf16 v[16:19], v[196:199], v[72:75], v[16:19]
v_mfma_f32_16x16x32_bf16 v[20:23], v[204:207], v[72:75], v[20:23]
v_mfma_f32_16x16x32_bf16 v[24:27], v[196:199], v[76:79], v[24:27]
v_mfma_f32_16x16x32_bf16 v[28:31], v[204:207], v[76:79], v[28:31]
s_waitcnt lgkmcnt(0)
v_mfma_f32_16x16x32_bf16 v[32:35], a[96:99], v[64:67], v[32:35]
ds_read_b128 v[72:75], v3 offset:34816
ds_read_b128 v[76:79], v3 offset:35840
v_mfma_f32_16x16x32_bf16 v[36:39], a[104:107], v[64:67], v[36:39]
v_mfma_f32_16x16x32_bf16 v[40:43], a[96:99], v[68:71], v[40:43]
v_mfma_f32_16x16x32_bf16 v[44:47], a[104:107], v[68:71], v[44:47]
v_mfma_f32_16x16x32_bf16 v[48:51], v[64:67], a[240:243], v[48:51]
v_mfma_f32_16x16x32_bf16 v[56:59], v[64:67], a[248:251], v[56:59]
v_mfma_f32_16x16x32_bf16 v[52:55], v[68:71], a[240:243], v[52:55]
v_mfma_f32_16x16x32_bf16 v[60:63], v[68:71], a[248:251], v[60:63]
v_mfma_f32_16x16x32_bf16 v[16:19], v[208:211], v[64:67], v[16:19]
v_mfma_f32_16x16x32_bf16 v[20:23], v[216:219], v[64:67], v[20:23]
v_mfma_f32_16x16x32_bf16 v[24:27], v[208:211], v[68:71], v[24:27]
v_mfma_f32_16x16x32_bf16 v[28:31], v[216:219], v[68:71], v[28:31]
s_waitcnt lgkmcnt(0)
v_mfma_f32_16x16x32_bf16 v[32:35], a[100:103], v[72:75], v[32:35]
v_mfma_f32_16x16x32_bf16 v[36:39], a[108:111], v[72:75], v[36:39]
v_mfma_f32_16x16x32_bf16 v[40:43], a[100:103], v[76:79], v[40:43]
v_mfma_f32_16x16x32_bf16 v[44:47], a[108:111], v[76:79], v[44:47]
v_mfma_f32_16x16x32_bf16 v[48:51], v[72:75], a[244:247], v[48:51]
v_mfma_f32_16x16x32_bf16 v[56:59], v[72:75], a[252:255], v[56:59]
v_mfma_f32_16x16x32_bf16 v[52:55], v[76:79], a[244:247], v[52:55]
v_mfma_f32_16x16x32_bf16 v[60:63], v[76:79], a[252:255], v[60:63]
v_mfma_f32_16x16x32_bf16 v[16:19], v[212:215], v[72:75], v[16:19]
v_mfma_f32_16x16x32_bf16 v[20:23], v[220:223], v[72:75], v[20:23]
v_mfma_f32_16x16x32_bf16 v[24:27], v[212:215], v[76:79], v[24:27]
v_mfma_f32_16x16x32_bf16 v[28:31], v[220:223], v[76:79], v[28:31]
s_mul_i32 s3, s50, 24576
s_add_u32 s3, s3, 73728
s_add_u32 s3, s3, s55
v_add_u32 v5, s3, v0
v_cvt_pk_bf16_f32 v32, v32, v33
v_cvt_pk_bf16_f32 v33, v34, v35
v_cvt_pk_bf16_f32 v34, v36, v37
v_cvt_pk_bf16_f32 v35, v38, v39
buffer_store_dwordx4 v[32:35], v0, s[8:11], s51 offen offset:0 sc1
ds_write_b128 v5, v[32:35] offset:8192
v_cvt_pk_bf16_f32 v40, v40, v41
v_cvt_pk_bf16_f32 v41, v42, v43
v_cvt_pk_bf16_f32 v42, v44, v45
v_cvt_pk_bf16_f32 v43, v46, v47
buffer_store_dwordx4 v[40:43], v0, s[8:11], s51 offen offset:1024 sc1
ds_write_b128 v5, v[40:43] offset:12288
v_cvt_pk_bf16_f32 v48, v48, v49
v_cvt_pk_bf16_f32 v49, v50, v51
v_cvt_pk_bf16_f32 v50, v52, v53
v_cvt_pk_bf16_f32 v51, v54, v55
buffer_store_dwordx4 v[48:51], v0, s[8:11], s51 offen offset:2048 sc1
ds_write_b128 v5, v[48:51] offset:16384
v_cvt_pk_bf16_f32 v56, v56, v57
v_cvt_pk_bf16_f32 v57, v58, v59
v_cvt_pk_bf16_f32 v58, v60, v61
v_cvt_pk_bf16_f32 v59, v62, v63
buffer_store_dwordx4 v[56:59], v0, s[8:11], s51 offen offset:3072 sc1
ds_write_b128 v5, v[56:59] offset:20480
v_cvt_pk_bf16_f32 v16, v16, v17
v_cvt_pk_bf16_f32 v17, v18, v19
v_cvt_pk_bf16_f32 v18, v20, v21
v_cvt_pk_bf16_f32 v19, v22, v23
ds_write_b128 v5, v[16:19] offset:0
v_cvt_pk_bf16_f32 v24, v24, v25
v_cvt_pk_bf16_f32 v25, v26, v27
v_cvt_pk_bf16_f32 v26, v28, v29
v_cvt_pk_bf16_f32 v27, v30, v31
ds_write_b128 v5, v[24:27] offset:4096
s_add_u32 s51, s51, 0x200000
s_add_u32 s3, s48, 1
v_mov_b32 v6, s3
s_lshl_b32 s2, s41, 5
s_add_u32 s2, s2, s47
s_lshl_b32 s2, s2, 2
s_waitcnt vmcnt(0) lgkmcnt(0)
s_barrier
s_cmp_lg_u32 s42, 0
s_cbranch_scc1 P_NF1
s_mov_b64 exec, 1
buffer_store_dword v6, off, s[8:11], s2 sc1
s_mov_b64 exec, -1
P_NF1:
s_cmp_eq_u32 s48, 0
s_cbranch_scc1 P_NEXT
P_ATT:
s_lshl_b32 s3, s48, 2
s_add_u32 s3, s3, s47
s_sub_u32 s3, s3, 4
s_mov_b32 s2, 4608
v_mov_b32 v16, 0
v_mov_b32 v17, 0
v_mov_b32 v18, 0
v_mov_b32 v19, 0
v_mov_b32 v20, 0
v_mov_b32 v21, 0
v_mov_b32 v22, 0
v_mov_b32 v23, 0
v_mov_b32 v24, 0
v_mov_b32 v25, 0
v_mov_b32 v26, 0
v_mov_b32 v27, 0
v_mov_b32 v28, 0
v_mov_b32 v29, 0
v_mov_b32 v30, 0
v_mov_b32 v31, 0
s_xor_b32 s14, s50, 1
s_mul_i32 s14, s14, 24576
s_add_u32 s14, s14, 73728
v_add_u32 v5, s14, v0
s_and_b32 s14, s42, 1
s_lshl_b32 s14, s14, 12
v_add_u32 v6, s14, v5
s_lshr_b32 s14, s42, 1
s_lshl_b32 s14, s14, 11
v_add_u32 v7, s14, v5
v_add_u32 v14, s14, v12
v_lshrrev_b32 v33, 2, v0
v_min_u32 v33, 32, v33
P_WM:
s_sub_u32 s45, s45, 1
s_cbranch_scc1 END
buffer_load_dword v32, v33, s[8:11], s2 offen sc1
s_waitcnt vmcnt(0)
v_cmp_ge_u32 vcc, s3, v32
s_cbranch_vccnz P_WM
s_add_u32 m0, s55, 122880
s_add_u32 s2, s53, s55
buffer_load_dwordx4 v0, s[8:11], s2 offen sc1 lds
s_add_u32 m0, s55, 126976
s_add_u32 s2, s2, 4096
buffer_load_dwordx4 v0, s[8:11], s2 offen sc1 lds
s_add_u32 s2, s53, 8192
buffer_load_dwordx4 v[64:67], v0, s[8:11], s2 offen sc1
s_add_u32 s53, s53, 65536
s_waitcnt vmcnt(0)
s_barrier
ds_read_b128 v[32:35], v12 offset:0
ds_read_b128 v[36:39], v12 offset:1024
ds_read_b128 v[40:43], v12 offset:2048
ds_read_b128 v[44:47], v12 offset:3072
ds_read_b128 v[48:51], v12 offset:4096
ds_read_b128 v[52:55], v12 offset:5120
ds_read_b128 v[56:59], v12 offset:6144
ds_read_b128 v[60:63], v12 offset:7168
v_smfmac_f32_16x16x64_bf16 v[16:19], v[64:67], a[96:103], v4
v_smfmac_f32_16x16x64_bf16 v[20:23], v[64:67], a[104:111], v4
s_waitcnt lgkmcnt(7)
v_smfmac_f32_16x16x64_bf16 v[16:19], v[32:35], v[224:231], v4
v_smfmac_f32_16x16x64_bf16 v[20:23], v[32:35], v[232:239], v4
s_waitcnt lgkmcnt(6)
v_smfmac_f32_16x16x64_bf16 v[16:19], v[36:39], v[240:247], v4
v_smfmac_f32_16x16x64_bf16 v[20:23], v[36:39], v[248:255], v4
s_waitcnt lgkmcnt(5)
v_smfmac_f32_16x16x64_bf16 v[16:19], v[40:43], a[0:7], v4
v_smfmac_f32_16x16x64_bf16 v[20:23], v[40:43], a[8:15], v4
s_waitcnt lgkmcnt(4)
v_smfmac_f32_16x16x64_bf16 v[16:19], v[44:47], a[16:23], v4
v_smfmac_f32_16x16x64_bf16 v[20:23], v[44:47], a[24:31], v4
s_waitcnt lgkmcnt(3)
v_smfmac_f32_16x16x64_bf16 v[16:19], v[48:51], a[32:39], v4
v_smfmac_f32_16x16x64_bf16 v[20:23], v[48:51], a[40:47], v4
s_waitcnt lgkmcnt(2)
v_smfmac_f32_16x16x64_bf16 v[16:19], v[52:55], a[48:55], v4
v_smfmac_f32_16x16x64_bf16 v[20:23], v[52:55], a[56:63], v4
s_waitcnt lgkmcnt(1)
v_smfmac_f32_16x16x64_bf16 v[16:19], v[56:59], a[64:71], v4
v_smfmac_f32_16x16x64_bf16 v[20:23], v[56:59], a[72:79], v4
s_waitcnt lgkmcnt(0)
v_smfmac_f32_16x16x64_bf16 v[16:19], v[60:63], a[80:87], v4
v_smfmac_f32_16x16x64_bf16 v[20:23], v[60:63], a[88:95], v4
v_smfmac_f32_16x16x64_bf16 v[24:27], v[64:67], a[240:247], v4
v_smfmac_f32_16x16x64_bf16 v[28:31], v[64:67], a[248:255], v4
v_smfmac_f32_16x16x64_bf16 v[24:27], v[32:35], a[112:119], v4
v_smfmac_f32_16x16x64_bf16 v[28:31], v[32:35], a[120:127], v4
v_cvt_pk_bf16_f32 v16, v16, v17
v_cvt_pk_bf16_f32 v17, v18, v19
v_cvt_pk_bf16_f32 v18, v20, v21
v_cvt_pk_bf16_f32 v19, v22, v23
v_smfmac_f32_16x16x64_bf16 v[24:27], v[36:39], a[128:135], v4
v_smfmac_f32_16x16x64_bf16 v[28:31], v[36:39], a[136:143], v4
v_mfma_f32_16x16x16_bf16 v[68:71], v[16:17], v[10:11], 0
v_mfma_f32_16x16x16_bf16 v[72:75], v[18:19], v[10:11], 0
v_smfmac_f32_16x16x64_bf16 v[24:27], v[40:43], a[144:151], v4
v_smfmac_f32_16x16x64_bf16 v[28:31], v[40:43], a[152:159], v4
v_smfmac_f32_16x16x64_bf16 v[24:27], v[44:47], a[160:167], v4
v_smfmac_f32_16x16x64_bf16 v[28:31], v[44:47], a[168:175], v4
v_cvt_pk_bf16_f32 v68, v68, v69
v_cvt_pk_bf16_f32 v69, v70, v71
v_cvt_pk_bf16_f32 v70, v72, v73
v_cvt_pk_bf16_f32 v71, v74, v75
ds_write_b128 v13, v[68:71] offset:9216
v_smfmac_f32_16x16x64_bf16 v[24:27], v[48:51], a[176:183], v4
v_smfmac_f32_16x16x64_bf16 v[28:31], v[48:51], a[184:191], v4
v_smfmac_f32_16x16x64_bf16 v[24:27], v[52:55], a[192:199], v4
v_smfmac_f32_16x16x64_bf16 v[28:31], v[52:55], a[200:207], v4
v_smfmac_f32_16x16x64_bf16 v[24:27], v[56:59], a[208:215], v4
v_smfmac_f32_16x16x64_bf16 v[28:31], v[56:59], a[216:223], v4
v_smfmac_f32_16x16x64_bf16 v[24:27], v[60:63], a[224:231], v4
v_smfmac_f32_16x16x64_bf16 v[28:31], v[60:63], a[232:239], v4
ds_read_b128 v[32:35], v6 offset:0
ds_read_b128 v[36:39], v6 offset:1024
ds_read_b128 v[40:43], v6 offset:2048
ds_read_b128 v[44:47], v6 offset:3072
ds_read_b128 v[48:51], v5 offset:8192
ds_read_b128 v[52:55], v5 offset:12288
ds_read_b128 v[56:59], v5 offset:9216
ds_read_b128 v[60:63], v5 offset:13312
ds_read_b128 v[64:67], v5 offset:10240
ds_read_b128 v[68:71], v5 offset:14336
v_cvt_pk_bf16_f32 v24, v24, v25
v_cvt_pk_bf16_f32 v25, v26, v27
v_cvt_pk_bf16_f32 v26, v28, v29
v_cvt_pk_bf16_f32 v27, v30, v31
ds_write_b128 v13, v[24:27] offset:13312
ds_read_b128 v[72:75], v5 offset:11264
ds_read_b128 v[28:31], v5 offset:15360
s_waitcnt lgkmcnt(0)
s_barrier
v_mfma_f32_16x16x32_bf16 v[16:19], v[48:51], v[32:35], 0
v_mfma_f32_16x16x32_bf16 v[20:23], v[52:55], v[32:35], 0
v_mfma_f32_16x16x32_bf16 v[16:19], v[56:59], v[36:39], v[16:19]
v_mfma_f32_16x16x32_bf16 v[20:23], v[60:63], v[36:39], v[20:23]
ds_read_b128 v[48:51], v12 offset:9216
ds_read_b128 v[52:55], v12 offset:10240
v_mfma_f32_16x16x32_bf16 v[16:19], v[64:67], v[40:43], v[16:19]
v_mfma_f32_16x16x32_bf16 v[20:23], v[68:71], v[40:43], v[20:23]
ds_read_b128 v[56:59], v12 offset:11264
ds_read_b128 v[60:63], v12 offset:12288
v_mfma_f32_16x16x32_bf16 v[16:19], v[72:75], v[44:47], v[16:19]
v_mfma_f32_16x16x32_bf16 v[20:23], v[28:31], v[44:47], v[20:23]
s_waitcnt lgkmcnt(3)
v_mfma_f32_16x16x32_bf16 v[76:79], v[48:51], v[32:35], 0
s_waitcnt lgkmcnt(2)
v_mfma_f32_16x16x32_bf16 v[76:79], v[52:55], v[36:39], v[76:79]
s_waitcnt lgkmcnt(1)
v_mfma_f32_16x16x32_bf16 v[76:79], v[56:59], v[40:43], v[76:79]
s_waitcnt lgkmcnt(0)
v_mfma_f32_16x16x32_bf16 v[76:79], v[60:63], v[44:47], v[76:79]
ds_read_b128 v[32:35], v7 offset:16384
ds_read_b128 v[36:39], v7 offset:20480
ds_read_b128 v[64:67], v14 offset:13312
ds_read_b128 v[40:43], v7 offset:17408
ds_read_b128 v[44:47], v7 offset:21504
ds_read_b128 v[68:71], v14 offset:14336
v_mov_b32 v26, 0xce6e6b28
v_cndmask_b32 v16, v26, v16, s[60:61]
v_cndmask_b32 v17, v26, v17, s[62:63]
v_cndmask_b32 v18, v26, v18, s[64:65]
v_cndmask_b32 v19, v26, v19, s[66:67]
v_cndmask_b32 v20, v26, v20, s[68:69]
v_cndmask_b32 v21, v26, v21, s[70:71]
v_cndmask_b32 v22, v26, v22, s[72:73]
v_cndmask_b32 v23, v26, v23, s[74:75]
v_mov_b32 v24, v76
v_mov_b32 v25, v77
v_max3_f32 v26, v16, v17, v18
v_max3_f32 v27, v19, v20, v21
v_max3_f32 v26, v26, v22, v23
v_max3_f32 v27, v27, v24, v25
v_max_f32 v26, v26, v27
v_mov_b32 v27, v26
s_nop 1
v_permlane16_swap_b32 v26, v27
v_max_f32 v26, v26, v27
v_mov_b32 v27, v26
s_nop 1
v_permlane32_swap_b32 v26, v27
v_max_f32 v26, v26, v27
v_mul_f32 v26, s52, v26
v_fma_f32 v16, v16, s52, -v26
v_fma_f32 v17, v17, s52, -v26
v_fma_f32 v18, v18, s52, -v26
v_fma_f32 v19, v19, s52, -v26
v_fma_f32 v20, v20, s52, -v26
v_fma_f32 v21, v21, s52, -v26
v_fma_f32 v22, v22, s52, -v26
v_fma_f32 v23, v23, s52, -v26
v_fma_f32 v24, v24, s52, -v26
v_fma_f32 v25, v25, s52, -v26
v_exp_f32 v16, v16
v_exp_f32 v17, v17
v_exp_f32 v18, v18
v_exp_f32 v19, v19
v_exp_f32 v20, v20
v_exp_f32 v21, v21
v_exp_f32 v22, v22
v_exp_f32 v23, v23
v_exp_f32 v24, v24
v_exp_f32 v25, v25
v_cvt_pk_bf16_f32 v28, v16, v17
v_cvt_pk_bf16_f32 v29, v18, v19
v_cvt_pk_bf16_f32 v30, v20, v21
v_cvt_pk_bf16_f32 v31, v22, v23
v_cvt_pk_bf16_f32 v26, v24, v24
v_cvt_pk_bf16_f32 v27, v25, v25
s_waitcnt lgkmcnt(0)
v_mfma_f32_16x16x32_bf16 v[48:51], v[32:35], v[28:31], 0
v_mfma_f32_16x16x32_bf16 v[52:55], v[36:39], v[28:31], 0
v_mfma_f32_16x16x32_bf16 v[56:59], v[40:43], v[28:31], 0
v_mfma_f32_16x16x32_bf16 v[60:63], v[44:47], v[28:31], 0
v_mfma_f32_16x16x16_bf16 v[48:51], v[64:65], v[26:27], v[48:51]
v_mfma_f32_16x16x16_bf16 v[52:55], v[66:67], v[26:27], v[52:55]
v_mfma_f32_16x16x16_bf16 v[56:59], v[68:69], v[26:27], v[56:59]
v_mfma_f32_16x16x16_bf16 v[60:63], v[70:71], v[26:27], v[60:63]
v_add_f32 v16, v16, v21
v_add_f32 v17, v17, v22
v_add_f32 v18, v18, v23
v_add_f32 v19, v19, v24
v_add_f32 v20, v20, v25
v_add_f32 v16, v16, v17
v_add_f32 v18, v18, v19
v_add_f32 v16, v16, v20
v_add_f32 v16, v16, v18
v_mov_b32 v17, v16
s_nop 1
v_permlane16_swap_b32 v16, v17
v_add_f32 v16, v16, v17
v_mov_b32 v17, v16
s_nop 1
v_permlane32_swap_b32 v16, v17
v_add_f32 v16, v16, v17
v_rcp_f32 v16, v16
s_nop 0
v_pk_mul_f32 v[48:49], v[48:49], v[16:17] op_sel_hi:[1,0]
v_pk_mul_f32 v[50:51], v[50:51], v[16:17] op_sel_hi:[1,0]
v_pk_mul_f32 v[52:53], v[52:53], v[16:17] op_sel_hi:[1,0]
v_pk_mul_f32 v[54:55], v[54:55], v[16:17] op_sel_hi:[1,0]
v_cvt_pk_bf16_f32 v48, v48, v49
v_cvt_pk_bf16_f32 v49, v50, v51
v_cvt_pk_bf16_f32 v50, v52, v53
v_cvt_pk_bf16_f32 v51, v54, v55
buffer_store_dwordx4 v[48:51], v0, s[8:11], s54 offen offset:0 sc1
v_pk_mul_f32 v[56:57], v[56:57], v[16:17] op_sel_hi:[1,0]
v_pk_mul_f32 v[58:59], v[58:59], v[16:17] op_sel_hi:[1,0]
v_pk_mul_f32 v[60:61], v[60:61], v[16:17] op_sel_hi:[1,0]
v_pk_mul_f32 v[62:63], v[62:63], v[16:17] op_sel_hi:[1,0]
v_cvt_pk_bf16_f32 v56, v56, v57
v_cvt_pk_bf16_f32 v57, v58, v59
v_cvt_pk_bf16_f32 v58, v60, v61
v_cvt_pk_bf16_f32 v59, v62, v63
buffer_store_dwordx4 v[56:59], v0, s[8:11], s54 offen offset:1024 sc1
s_add_u32 s54, s54, 0x100000
v_mov_b32 v6, s48
s_lshl_b32 s2, s47, 5
s_add_u32 s2, s2, s41
s_lshl_b32 s2, s2, 2
s_add_u32 s2, s2, 4096
s_waitcnt vmcnt(0)
s_barrier
s_cmp_lg_u32 s42, 0
s_cbranch_scc1 P_NEXT
s_mov_b64 exec, 1
buffer_store_dword v6, off, s[8:11], s2 sc1
s_mov_b64 exec, -1
P_NEXT:
s_xor_b32 s50, s50, 1
s_add_u32 s48, s48, 1
s_cmp_le_u32 s48, 16
s_cbranch_scc1 P_LOOP
s_branch END
OUTP:
s_sub_u32 s47, s40, 160
s_cmp_lt_u32 s47, 72
s_cbranch_scc1 S_ROLE
s_cmp_lt_u32 s47, 88
s_cbranch_scc1 G_ROLE
s_cmp_lg_u32 s47, 88
s_cbranch_scc1 O_ROLE
v_mov_b32 v4, 0
v_mov_b32 v5, 0
v_mov_b32 v6, 0
v_mov_b32 v7, 0
v_lshlrev_b32 v3, 4, v0
s_lshl_b32 s2, s42, 11
buffer_store_dwordx4 v[4:7], v3, s[8:11], s2 offen offset:0 sc1
buffer_store_dwordx4 v[4:7], v3, s[8:11], s2 offen offset:1024 sc1
s_waitcnt vmcnt(0)
s_barrier
s_cmp_lg_u32 s42, 0
s_cbranch_scc1 ARR_3
v_mov_b32 v1, 192
v_mov_b32 v2, 1
s_mov_b64 exec, 1
global_atomic_add v1, v2, s[12:13] sc1
s_mov_b64 exec, -1
ARR_3:
s_branch O_ROLE
S_ROLE:
s_load_dwordx2 s[16:17], s[0:1], 64
s_mov_b32 s18, 147456
s_mov_b32 s19, 0x00020000
s_load_dwordx2 s[20:21], s[0:1], 72
s_mov_b32 s22, 147456
s_mov_b32 s23, 0x00020000
s_load_dwordx2 s[24:25], s[0:1], 80
s_mov_b32 s26, 147456
s_mov_b32 s27, 0x00020000
s_load_dwordx2 s[36:37], s[0:1], 88
s_mov_b32 s38, 147456
s_mov_b32 s39, 0x00020000
s_load_dwordx2 s[48:49], s[0:1], 96
s_mov_b32 s50, 1152
s_mov_b32 s51, 0x00020000
s_load_dwordx2 s[52:53], s[0:1], 104
s_mov_b32 s54, 1152
s_mov_b32 s55, 0x00020000
s_lshl_b32 s2, s42, 6
v_add_u32 v1, s2, v0
v_mul_u32_u24 v3, 9216, v1
s_lshl_b32 s2, s47, 4
s_add_u32 s3, s2, 4608
s_lshl_b32 s14, s47, 2
s_add_u32 s14, s14, s42
s_lshl_b32 s15, s14, 2
s_lshl_b32 s14, s14, 9
v_lshlrev_b32 v4, 3, v0
v_lshrrev_b32 v5, 5, v0
v_lshlrev_b32 v6, 1, v5
s_waitcnt lgkmcnt(0)
buffer_load_ushort v16, v6, s[48:51], s15 offen
buffer_load_dwordx2 v[18:19], v4, s[16:19], s14 offen
buffer_load_dwordx2 v[20:21], v4, s[20:23], s14 offen
buffer_load_dwordx2 v[22:23], v4, s[24:27], s14 offen
buffer_load_dwordx2 v[24:25], v4, s[36:39], s14 offen
buffer_load_ushort v17, v6, s[52:55], s15 offen
buffer_load_dwordx4 v[200:203], v3, s[32:35], s2 offen offset:0
buffer_load_dwordx4 v[204:207], v3, s[32:35], s2 offen offset:1152
buffer_load_dwordx4 v[208:211], v3, s[32:35], s2 offen offset:2304
buffer_load_dwordx4 v[212:215], v3, s[32:35], s2 offen offset:3456
buffer_load_dwordx4 v[216:219], v3, s[32:35], s3 offen offset:0
buffer_load_dwordx4 v[220:223], v3, s[32:35], s3 offen offset:1152
buffer_load_dwordx4 v[224:227], v3, s[32:35], s3 offen offset:2304
buffer_load_dwordx4 v[228:231], v3, s[32:35], s3 offen offset:3456
s_mov_b32 s56, 0x05040100
s_mov_b32 s57, 0x07060302
s_mov_b32 s62, 0x3fb8aa00
s_mov_b32 s63, 0x36eca570
v_mov_b32 v32, 0
v_mov_b32 v33, 0
v_mov_b32 v34, 0
v_mov_b32 v35, 0
v_lshlrev_b32 v7, 4, v1
v_cmp_gt_u32 vcc, 160, v1
s_and_saveexec_b64 s[64:65], vcc
ds_write_b128 v7, v[32:35] offset:0
ds_write_b128 v7, v[32:35] offset:7680
ds_write_b128 v7, v[32:35] offset:15360
ds_write_b128 v7, v[32:35] offset:23040
ds_write_b128 v7, v[32:35] offset:30720
ds_write_b128 v7, v[32:35] offset:38400
ds_write_b128 v7, v[32:35] offset:46080
ds_write_b128 v7, v[32:35] offset:53760
s_mov_b64 exec, 0xffff
s_mul_i32 s2, s42, 16640
s_add_u32 s66, s2, 61440
s_mul_i32 s2, s42, 3328
s_add_u32 s67, s2, 128000
s_lshl_b32 s2, s42, 12
s_add_u32 s68, s2, 141312
v_lshrrev_b32 v7, 2, v0
v_mul_u32_u24 v7, 4160, v7
v_and_b32 v11, 3, v0
v_lshl_add_u32 v7, v11, 4, v7
v_add_u32 v7, s66, v7
ds_write_b128 v7, v[32:35] offset:4096
v_mul_u32_u24 v7, 208, v0
v_add_u32 v7, s67, v7
ds_write_b128 v7, v[32:35] offset:192
s_mov_b64 exec, -1
v_lshrrev_b32 v7, 2, v1
v_mul_u32_u24 v7, 80, v7
v_and_b32 v11, 3, v0
v_lshl_add_u32 v2, v11, 4, v7
v_lshlrev_b32 v7, 5, v0
v_sub_u32 v7, 2047, v7
v_subrev_u32 v11, 0, v7
v_cmp_gt_i32 vcc, 0, v11
v_cvt_f32_i32 v11, v11
v_cvt_pk_bf16_f32 v11, v11, v11
v_bfe_u32 v12, v11, 7, 8
v_lshlrev_b32 v11, 16, v11
v_cvt_u32_f32 v11, v11
v_subrev_u32 v12, 134, v12
v_med3_i32 v12, v12, 0, 3
v_lshrrev_b32 v13, 4, v11
v_bfi_b32 v13, 7, v11, v13
v_lshrrev_b32 v13, v12, v13
v_lshl_add_u32 v13, v12, 3, v13
v_bfe_u32 v11, v11, 3, 4
v_mul_u32_u24 v11, 52, v11
v_add_u32 v11, v11, v13
v_lshl_add_u32 v160, v11, 2, s67
v_subrev_u32 v11, 1, v7
v_cmp_gt_i32 vcc, 0, v11
v_cvt_f32_i32 v11, v11
v_cvt_pk_bf16_f32 v11, v11, v11
v_bfe_u32 v12, v11, 7, 8
v_lshlrev_b32 v11, 16, v11
v_cvt_u32_f32 v11, v11
v_subrev_u32 v12, 134, v12
v_med3_i32 v12, v12, 0, 3
v_lshrrev_b32 v13, 4, v11
v_bfi_b32 v13, 7, v11, v13
v_lshrrev_b32 v13, v12, v13
v_lshl_add_u32 v13, v12, 3, v13
v_bfe_u32 v11, v11, 3, 4
v_mul_u32_u24 v11, 52, v11
v_add_u32 v11, v11, v13
v_lshl_add_u32 v161, v11, 2, s67
v_subrev_u32 v11, 2, v7
v_cmp_gt_i32 vcc, 0, v11
v_cvt_f32_i32 v11, v11
v_cvt_pk_bf16_f32 v11, v11, v11
v_bfe_u32 v12, v11, 7, 8
v_lshlrev_b32 v11, 16, v11
v_cvt_u32_f32 v11, v11
v_subrev_u32 v12, 134, v12
v_med3_i32 v12, v12, 0, 3
v_lshrrev_b32 v13, 4, v11
v_bfi_b32 v13, 7, v11, v13
v_lshrrev_b32 v13, v12, v13
v_lshl_add_u32 v13, v12, 3, v13
v_bfe_u32 v11, v11, 3, 4
v_mul_u32_u24 v11, 52, v11
v_add_u32 v11, v11, v13
v_lshl_add_u32 v162, v11, 2, s67
v_subrev_u32 v11, 3, v7
v_cmp_gt_i32 vcc, 0, v11
v_cvt_f32_i32 v11, v11
v_cvt_pk_bf16_f32 v11, v11, v11
v_bfe_u32 v12, v11, 7, 8
v_lshlrev_b32 v11, 16, v11
v_cvt_u32_f32 v11, v11
v_subrev_u32 v12, 134, v12
v_med3_i32 v12, v12, 0, 3
v_lshrrev_b32 v13, 4, v11
v_bfi_b32 v13, 7, v11, v13
v_lshrrev_b32 v13, v12, v13
v_lshl_add_u32 v13, v12, 3, v13
v_bfe_u32 v11, v11, 3, 4
v_mul_u32_u24 v11, 52, v11
v_add_u32 v11, v11, v13
v_lshl_add_u32 v163, v11, 2, s67
v_subrev_u32 v11, 4, v7
v_cmp_gt_i32 vcc, 0, v11
v_cvt_f32_i32 v11, v11
v_cvt_pk_bf16_f32 v11, v11, v11
v_bfe_u32 v12, v11, 7, 8
v_lshlrev_b32 v11, 16, v11
v_cvt_u32_f32 v11, v11
v_subrev_u32 v12, 134, v12
v_med3_i32 v12, v12, 0, 3
v_lshrrev_b32 v13, 4, v11
v_bfi_b32 v13, 7, v11, v13
v_lshrrev_b32 v13, v12, v13
v_lshl_add_u32 v13, v12, 3, v13
v_bfe_u32 v11, v11, 3, 4
v_mul_u32_u24 v11, 52, v11
v_add_u32 v11, v11, v13
v_lshl_add_u32 v164, v11, 2, s67
v_subrev_u32 v11, 5, v7
v_cmp_gt_i32 vcc, 0, v11
v_cvt_f32_i32 v11, v11
v_cvt_pk_bf16_f32 v11, v11, v11
v_bfe_u32 v12, v11, 7, 8
v_lshlrev_b32 v11, 16, v11
v_cvt_u32_f32 v11, v11
v_subrev_u32 v12, 134, v12
v_med3_i32 v12, v12, 0, 3
v_lshrrev_b32 v13, 4, v11
v_bfi_b32 v13, 7, v11, v13
v_lshrrev_b32 v13, v12, v13
v_lshl_add_u32 v13, v12, 3, v13
v_bfe_u32 v11, v11, 3, 4
v_mul_u32_u24 v11, 52, v11
v_add_u32 v11, v11, v13
v_lshl_add_u32 v165, v11, 2, s67
v_subrev_u32 v11, 6, v7
v_cmp_gt_i32 vcc, 0, v11
v_cvt_f32_i32 v11, v11
v_cvt_pk_bf16_f32 v11, v11, v11
v_bfe_u32 v12, v11, 7, 8
v_lshlrev_b32 v11, 16, v11
v_cvt_u32_f32 v11, v11
v_subrev_u32 v12, 134, v12
v_med3_i32 v12, v12, 0, 3
v_lshrrev_b32 v13, 4, v11
v_bfi_b32 v13, 7, v11, v13
v_lshrrev_b32 v13, v12, v13
v_lshl_add_u32 v13, v12, 3, v13
v_bfe_u32 v11, v11, 3, 4
v_mul_u32_u24 v11, 52, v11
v_add_u32 v11, v11, v13
v_lshl_add_u32 v166, v11, 2, s67
v_subrev_u32 v11, 7, v7
v_cmp_gt_i32 vcc, 0, v11
v_cvt_f32_i32 v11, v11
v_cvt_pk_bf16_f32 v11, v11, v11
v_bfe_u32 v12, v11, 7, 8
v_lshlrev_b32 v11, 16, v11
v_cvt_u32_f32 v11, v11
v_subrev_u32 v12, 134, v12
v_med3_i32 v12, v12, 0, 3
v_lshrrev_b32 v13, 4, v11
v_bfi_b32 v13, 7, v11, v13
v_lshrrev_b32 v13, v12, v13
v_lshl_add_u32 v13, v12, 3, v13
v_bfe_u32 v11, v11, 3, 4
v_mul_u32_u24 v11, 52, v11
v_add_u32 v11, v11, v13
v_lshl_add_u32 v167, v11, 2, s67
v_subrev_u32 v11, 8, v7
v_cmp_gt_i32 vcc, 0, v11
v_cvt_f32_i32 v11, v11
v_cvt_pk_bf16_f32 v11, v11, v11
v_bfe_u32 v12, v11, 7, 8
v_lshlrev_b32 v11, 16, v11
v_cvt_u32_f32 v11, v11
v_subrev_u32 v12, 134, v12
v_med3_i32 v12, v12, 0, 3
v_lshrrev_b32 v13, 4, v11
v_bfi_b32 v13, 7, v11, v13
v_lshrrev_b32 v13, v12, v13
v_lshl_add_u32 v13, v12, 3, v13
v_bfe_u32 v11, v11, 3, 4
v_mul_u32_u24 v11, 52, v11
v_add_u32 v11, v11, v13
v_lshl_add_u32 v168, v11, 2, s67
v_subrev_u32 v11, 9, v7
v_cmp_gt_i32 vcc, 0, v11
v_cvt_f32_i32 v11, v11
v_cvt_pk_bf16_f32 v11, v11, v11
v_bfe_u32 v12, v11, 7, 8
v_lshlrev_b32 v11, 16, v11
v_cvt_u32_f32 v11, v11
v_subrev_u32 v12, 134, v12
v_med3_i32 v12, v12, 0, 3
v_lshrrev_b32 v13, 4, v11
v_bfi_b32 v13, 7, v11, v13
v_lshrrev_b32 v13, v12, v13
v_lshl_add_u32 v13, v12, 3, v13
v_bfe_u32 v11, v11, 3, 4
v_mul_u32_u24 v11, 52, v11
v_add_u32 v11, v11, v13
v_lshl_add_u32 v169, v11, 2, s67
v_subrev_u32 v11, 10, v7
v_cmp_gt_i32 vcc, 0, v11
v_cvt_f32_i32 v11, v11
v_cvt_pk_bf16_f32 v11, v11, v11
v_bfe_u32 v12, v11, 7, 8
v_lshlrev_b32 v11, 16, v11
v_cvt_u32_f32 v11, v11
v_subrev_u32 v12, 134, v12
v_med3_i32 v12, v12, 0, 3
v_lshrrev_b32 v13, 4, v11
v_bfi_b32 v13, 7, v11, v13
v_lshrrev_b32 v13, v12, v13
v_lshl_add_u32 v13, v12, 3, v13
v_bfe_u32 v11, v11, 3, 4
v_mul_u32_u24 v11, 52, v11
v_add_u32 v11, v11, v13
v_lshl_add_u32 v170, v11, 2, s67
v_subrev_u32 v11, 11, v7
v_cmp_gt_i32 vcc, 0, v11
v_cvt_f32_i32 v11, v11
v_cvt_pk_bf16_f32 v11, v11, v11
v_bfe_u32 v12, v11, 7, 8
v_lshlrev_b32 v11, 16, v11
v_cvt_u32_f32 v11, v11
v_subrev_u32 v12, 134, v12
v_med3_i32 v12, v12, 0, 3
v_lshrrev_b32 v13, 4, v11
v_bfi_b32 v13, 7, v11, v13
v_lshrrev_b32 v13, v12, v13
v_lshl_add_u32 v13, v12, 3, v13
v_bfe_u32 v11, v11, 3, 4
v_mul_u32_u24 v11, 52, v11
v_add_u32 v11, v11, v13
v_lshl_add_u32 v171, v11, 2, s67
v_subrev_u32 v11, 12, v7
v_cmp_gt_i32 vcc, 0, v11
v_cvt_f32_i32 v11, v11
v_cvt_pk_bf16_f32 v11, v11, v11
v_bfe_u32 v12, v11, 7, 8
v_lshlrev_b32 v11, 16, v11
v_cvt_u32_f32 v11, v11
v_subrev_u32 v12, 134, v12
v_med3_i32 v12, v12, 0, 3
v_lshrrev_b32 v13, 4, v11
v_bfi_b32 v13, 7, v11, v13
v_lshrrev_b32 v13, v12, v13
v_lshl_add_u32 v13, v12, 3, v13
v_bfe_u32 v11, v11, 3, 4
v_mul_u32_u24 v11, 52, v11
v_add_u32 v11, v11, v13
v_lshl_add_u32 v172, v11, 2, s67
v_subrev_u32 v11, 13, v7
v_cmp_gt_i32 vcc, 0, v11
v_cvt_f32_i32 v11, v11
v_cvt_pk_bf16_f32 v11, v11, v11
v_bfe_u32 v12, v11, 7, 8
v_lshlrev_b32 v11, 16, v11
v_cvt_u32_f32 v11, v11
v_subrev_u32 v12, 134, v12
v_med3_i32 v12, v12, 0, 3
v_lshrrev_b32 v13, 4, v11
v_bfi_b32 v13, 7, v11, v13
v_lshrrev_b32 v13, v12, v13
v_lshl_add_u32 v13, v12, 3, v13
v_bfe_u32 v11, v11, 3, 4
v_mul_u32_u24 v11, 52, v11
v_add_u32 v11, v11, v13
v_lshl_add_u32 v173, v11, 2, s67
v_subrev_u32 v11, 14, v7
v_cmp_gt_i32 vcc, 0, v11
v_cvt_f32_i32 v11, v11
v_cvt_pk_bf16_f32 v11, v11, v11
v_bfe_u32 v12, v11, 7, 8
v_lshlrev_b32 v11, 16, v11
v_cvt_u32_f32 v11, v11
v_subrev_u32 v12, 134, v12
v_med3_i32 v12, v12, 0, 3
v_lshrrev_b32 v13, 4, v11
v_bfi_b32 v13, 7, v11, v13
v_lshrrev_b32 v13, v12, v13
v_lshl_add_u32 v13, v12, 3, v13
v_bfe_u32 v11, v11, 3, 4
v_mul_u32_u24 v11, 52, v11
v_add_u32 v11, v11, v13
v_lshl_add_u32 v174, v11, 2, s67
v_subrev_u32 v11, 15, v7
v_cmp_gt_i32 vcc, 0, v11
v_cvt_f32_i32 v11, v11
v_cvt_pk_bf16_f32 v11, v11, v11
v_bfe_u32 v12, v11, 7, 8
v_lshlrev_b32 v11, 16, v11
v_cvt_u32_f32 v11, v11
v_subrev_u32 v12, 134, v12
v_med3_i32 v12, v12, 0, 3
v_lshrrev_b32 v13, 4, v11
v_bfi_b32 v13, 7, v11, v13
v_lshrrev_b32 v13, v12, v13
v_lshl_add_u32 v13, v12, 3, v13
v_bfe_u32 v11, v11, 3, 4
v_mul_u32_u24 v11, 52, v11
v_add_u32 v11, v11, v13
v_lshl_add_u32 v175, v11, 2, s67
v_subrev_u32 v11, 16, v7
v_cmp_gt_i32 vcc, 0, v11
v_cvt_f32_i32 v11, v11
v_cvt_pk_bf16_f32 v11, v11, v11
v_bfe_u32 v12, v11, 7, 8
v_lshlrev_b32 v11, 16, v11
v_cvt_u32_f32 v11, v11
v_subrev_u32 v12, 134, v12
v_med3_i32 v12, v12, 0, 3
v_lshrrev_b32 v13, 4, v11
v_bfi_b32 v13, 7, v11, v13
v_lshrrev_b32 v13, v12, v13
v_lshl_add_u32 v13, v12, 3, v13
v_bfe_u32 v11, v11, 3, 4
v_mul_u32_u24 v11, 52, v11
v_add_u32 v11, v11, v13
v_lshl_add_u32 v176, v11, 2, s67
v_subrev_u32 v11, 17, v7
v_cmp_gt_i32 vcc, 0, v11
v_cvt_f32_i32 v11, v11
v_cvt_pk_bf16_f32 v11, v11, v11
v_bfe_u32 v12, v11, 7, 8
v_lshlrev_b32 v11, 16, v11
v_cvt_u32_f32 v11, v11
v_subrev_u32 v12, 134, v12
v_med3_i32 v12, v12, 0, 3
v_lshrrev_b32 v13, 4, v11
v_bfi_b32 v13, 7, v11, v13
v_lshrrev_b32 v13, v12, v13
v_lshl_add_u32 v13, v12, 3, v13
v_bfe_u32 v11, v11, 3, 4
v_mul_u32_u24 v11, 52, v11
v_add_u32 v11, v11, v13
v_lshl_add_u32 v177, v11, 2, s67
v_subrev_u32 v11, 18, v7
v_cmp_gt_i32 vcc, 0, v11
v_cvt_f32_i32 v11, v11
v_cvt_pk_bf16_f32 v11, v11, v11
v_bfe_u32 v12, v11, 7, 8
v_lshlrev_b32 v11, 16, v11
v_cvt_u32_f32 v11, v11
v_subrev_u32 v12, 134, v12
v_med3_i32 v12, v12, 0, 3
v_lshrrev_b32 v13, 4, v11
v_bfi_b32 v13, 7, v11, v13
v_lshrrev_b32 v13, v12, v13
v_lshl_add_u32 v13, v12, 3, v13
v_bfe_u32 v11, v11, 3, 4
v_mul_u32_u24 v11, 52, v11
v_add_u32 v11, v11, v13
v_lshl_add_u32 v178, v11, 2, s67
v_subrev_u32 v11, 19, v7
v_cmp_gt_i32 vcc, 0, v11
v_cvt_f32_i32 v11, v11
v_cvt_pk_bf16_f32 v11, v11, v11
v_bfe_u32 v12, v11, 7, 8
v_lshlrev_b32 v11, 16, v11
v_cvt_u32_f32 v11, v11
v_subrev_u32 v12, 134, v12
v_med3_i32 v12, v12, 0, 3
v_lshrrev_b32 v13, 4, v11
v_bfi_b32 v13, 7, v11, v13
v_lshrrev_b32 v13, v12, v13
v_lshl_add_u32 v13, v12, 3, v13
v_bfe_u32 v11, v11, 3, 4
v_mul_u32_u24 v11, 52, v11
v_add_u32 v11, v11, v13
v_lshl_add_u32 v179, v11, 2, s67
v_subrev_u32 v11, 20, v7
v_cmp_gt_i32 vcc, 0, v11
v_cvt_f32_i32 v11, v11
v_cvt_pk_bf16_f32 v11, v11, v11
v_bfe_u32 v12, v11, 7, 8
v_lshlrev_b32 v11, 16, v11
v_cvt_u32_f32 v11, v11
v_subrev_u32 v12, 134, v12
v_med3_i32 v12, v12, 0, 3
v_lshrrev_b32 v13, 4, v11
v_bfi_b32 v13, 7, v11, v13
v_lshrrev_b32 v13, v12, v13
v_lshl_add_u32 v13, v12, 3, v13
v_bfe_u32 v11, v11, 3, 4
v_mul_u32_u24 v11, 52, v11
v_add_u32 v11, v11, v13
v_lshl_add_u32 v180, v11, 2, s67
v_subrev_u32 v11, 21, v7
v_cmp_gt_i32 vcc, 0, v11
v_cvt_f32_i32 v11, v11
v_cvt_pk_bf16_f32 v11, v11, v11
v_bfe_u32 v12, v11, 7, 8
v_lshlrev_b32 v11, 16, v11
v_cvt_u32_f32 v11, v11
v_subrev_u32 v12, 134, v12
v_med3_i32 v12, v12, 0, 3
v_lshrrev_b32 v13, 4, v11
v_bfi_b32 v13, 7, v11, v13
v_lshrrev_b32 v13, v12, v13
v_lshl_add_u32 v13, v12, 3, v13
v_bfe_u32 v11, v11, 3, 4
v_mul_u32_u24 v11, 52, v11
v_add_u32 v11, v11, v13
v_lshl_add_u32 v181, v11, 2, s67
v_subrev_u32 v11, 22, v7
v_cmp_gt_i32 vcc, 0, v11
v_cvt_f32_i32 v11, v11
v_cvt_pk_bf16_f32 v11, v11, v11
v_bfe_u32 v12, v11, 7, 8
v_lshlrev_b32 v11, 16, v11
v_cvt_u32_f32 v11, v11
v_subrev_u32 v12, 134, v12
v_med3_i32 v12, v12, 0, 3
v_lshrrev_b32 v13, 4, v11
v_bfi_b32 v13, 7, v11, v13
v_lshrrev_b32 v13, v12, v13
v_lshl_add_u32 v13, v12, 3, v13
v_bfe_u32 v11, v11, 3, 4
v_mul_u32_u24 v11, 52, v11
v_add_u32 v11, v11, v13
v_lshl_add_u32 v182, v11, 2, s67
v_subrev_u32 v11, 23, v7
v_cmp_gt_i32 vcc, 0, v11
v_cvt_f32_i32 v11, v11
v_cvt_pk_bf16_f32 v11, v11, v11
v_bfe_u32 v12, v11, 7, 8
v_lshlrev_b32 v11, 16, v11
v_cvt_u32_f32 v11, v11
v_subrev_u32 v12, 134, v12
v_med3_i32 v12, v12, 0, 3
v_lshrrev_b32 v13, 4, v11
v_bfi_b32 v13, 7, v11, v13
v_lshrrev_b32 v13, v12, v13
v_lshl_add_u32 v13, v12, 3, v13
v_bfe_u32 v11, v11, 3, 4
v_mul_u32_u24 v11, 52, v11
v_add_u32 v11, v11, v13
v_lshl_add_u32 v183, v11, 2, s67
v_subrev_u32 v11, 24, v7
v_cmp_gt_i32 vcc, 0, v11
v_cvt_f32_i32 v11, v11
v_cvt_pk_bf16_f32 v11, v11, v11
v_bfe_u32 v12, v11, 7, 8
v_lshlrev_b32 v11, 16, v11
v_cvt_u32_f32 v11, v11
v_subrev_u32 v12, 134, v12
v_med3_i32 v12, v12, 0, 3
v_lshrrev_b32 v13, 4, v11
v_bfi_b32 v13, 7, v11, v13
v_lshrrev_b32 v13, v12, v13
v_lshl_add_u32 v13, v12, 3, v13
v_bfe_u32 v11, v11, 3, 4
v_mul_u32_u24 v11, 52, v11
v_add_u32 v11, v11, v13
v_lshl_add_u32 v184, v11, 2, s67
v_subrev_u32 v11, 25, v7
v_cmp_gt_i32 vcc, 0, v11
v_cvt_f32_i32 v11, v11
v_cvt_pk_bf16_f32 v11, v11, v11
v_bfe_u32 v12, v11, 7, 8
v_lshlrev_b32 v11, 16, v11
v_cvt_u32_f32 v11, v11
v_subrev_u32 v12, 134, v12
v_med3_i32 v12, v12, 0, 3
v_lshrrev_b32 v13, 4, v11
v_bfi_b32 v13, 7, v11, v13
v_lshrrev_b32 v13, v12, v13
v_lshl_add_u32 v13, v12, 3, v13
v_bfe_u32 v11, v11, 3, 4
v_mul_u32_u24 v11, 52, v11
v_add_u32 v11, v11, v13
v_lshl_add_u32 v185, v11, 2, s67
v_subrev_u32 v11, 26, v7
v_cmp_gt_i32 vcc, 0, v11
v_cvt_f32_i32 v11, v11
v_cvt_pk_bf16_f32 v11, v11, v11
v_bfe_u32 v12, v11, 7, 8
v_lshlrev_b32 v11, 16, v11
v_cvt_u32_f32 v11, v11
v_subrev_u32 v12, 134, v12
v_med3_i32 v12, v12, 0, 3
v_lshrrev_b32 v13, 4, v11
v_bfi_b32 v13, 7, v11, v13
v_lshrrev_b32 v13, v12, v13
v_lshl_add_u32 v13, v12, 3, v13
v_bfe_u32 v11, v11, 3, 4
v_mul_u32_u24 v11, 52, v11
v_add_u32 v11, v11, v13
v_lshl_add_u32 v186, v11, 2, s67
v_subrev_u32 v11, 27, v7
v_cmp_gt_i32 vcc, 0, v11
v_cvt_f32_i32 v11, v11
v_cvt_pk_bf16_f32 v11, v11, v11
v_bfe_u32 v12, v11, 7, 8
v_lshlrev_b32 v11, 16, v11
v_cvt_u32_f32 v11, v11
v_subrev_u32 v12, 134, v12
v_med3_i32 v12, v12, 0, 3
v_lshrrev_b32 v13, 4, v11
v_bfi_b32 v13, 7, v11, v13
v_lshrrev_b32 v13, v12, v13
v_lshl_add_u32 v13, v12, 3, v13
v_bfe_u32 v11, v11, 3, 4
v_mul_u32_u24 v11, 52, v11
v_add_u32 v11, v11, v13
v_lshl_add_u32 v187, v11, 2, s67
v_subrev_u32 v11, 28, v7
v_cmp_gt_i32 vcc, 0, v11
v_cvt_f32_i32 v11, v11
v_cvt_pk_bf16_f32 v11, v11, v11
v_bfe_u32 v12, v11, 7, 8
v_lshlrev_b32 v11, 16, v11
v_cvt_u32_f32 v11, v11
v_subrev_u32 v12, 134, v12
v_med3_i32 v12, v12, 0, 3
v_lshrrev_b32 v13, 4, v11
v_bfi_b32 v13, 7, v11, v13
v_lshrrev_b32 v13, v12, v13
v_lshl_add_u32 v13, v12, 3, v13
v_bfe_u32 v11, v11, 3, 4
v_mul_u32_u24 v11, 52, v11
v_add_u32 v11, v11, v13
v_lshl_add_u32 v188, v11, 2, s67
v_subrev_u32 v11, 29, v7
v_cmp_gt_i32 vcc, 0, v11
v_cvt_f32_i32 v11, v11
v_cvt_pk_bf16_f32 v11, v11, v11
v_bfe_u32 v12, v11, 7, 8
v_lshlrev_b32 v11, 16, v11
v_cvt_u32_f32 v11, v11
v_subrev_u32 v12, 134, v12
v_med3_i32 v12, v12, 0, 3
v_lshrrev_b32 v13, 4, v11
v_bfi_b32 v13, 7, v11, v13
v_lshrrev_b32 v13, v12, v13
v_lshl_add_u32 v13, v12, 3, v13
v_bfe_u32 v11, v11, 3, 4
v_mul_u32_u24 v11, 52, v11
v_add_u32 v11, v11, v13
v_lshl_add_u32 v189, v11, 2, s67
v_subrev_u32 v11, 30, v7
v_cmp_gt_i32 vcc, 0, v11
v_cvt_f32_i32 v11, v11
v_cvt_pk_bf16_f32 v11, v11, v11
v_bfe_u32 v12, v11, 7, 8
v_lshlrev_b32 v11, 16, v11
v_cvt_u32_f32 v11, v11
v_subrev_u32 v12, 134, v12
v_med3_i32 v12, v12, 0, 3
v_lshrrev_b32 v13, 4, v11
v_bfi_b32 v13, 7, v11, v13
v_lshrrev_b32 v13, v12, v13
v_lshl_add_u32 v13, v12, 3, v13
v_bfe_u32 v11, v11, 3, 4
v_mul_u32_u24 v11, 52, v11
v_add_u32 v11, v11, v13
v_lshl_add_u32 v190, v11, 2, s67
v_subrev_u32 v11, 31, v7
v_cmp_gt_i32 vcc, 0, v11
v_cvt_f32_i32 v11, v11
v_cvt_pk_bf16_f32 v11, v11, v11
v_bfe_u32 v12, v11, 7, 8
v_lshlrev_b32 v11, 16, v11
v_cvt_u32_f32 v11, v11
v_subrev_u32 v12, 134, v12
v_med3_i32 v12, v12, 0, 3
v_lshrrev_b32 v13, 4, v11
v_bfi_b32 v13, 7, v11, v13
v_lshrrev_b32 v13, v12, v13
v_lshl_add_u32 v13, v12, 3, v13
v_bfe_u32 v11, v11, 3, 4
v_mul_u32_u24 v11, 52, v11
v_add_u32 v11, v11, v13
v_lshl_add_u32 v191, v11, 2, s67
v_subrev_u32 v11, 32, v7
v_cmp_gt_i32 vcc, 0, v11
v_cvt_f32_i32 v11, v11
v_cvt_pk_bf16_f32 v11, v11, v11
v_bfe_u32 v12, v11, 7, 8
v_lshlrev_b32 v11, 16, v11
v_cvt_u32_f32 v11, v11
v_subrev_u32 v12, 134, v12
v_med3_i32 v12, v12, 0, 3
v_lshrrev_b32 v13, 4, v11
v_bfi_b32 v13, 7, v11, v13
v_lshrrev_b32 v13, v12, v13
v_lshl_add_u32 v13, v12, 3, v13
v_bfe_u32 v11, v11, 3, 4
v_mul_u32_u24 v11, 52, v11
v_add_u32 v11, v11, v13
v_cndmask_b32 v11, v11, 48, vcc
v_lshl_add_u32 v192, v11, 2, s67
v_subrev_u32 v11, 33, v7
v_cmp_gt_i32 vcc, 0, v11
v_cvt_f32_i32 v11, v11
v_cvt_pk_bf16_f32 v11, v11, v11
v_bfe_u32 v12, v11, 7, 8
v_lshlrev_b32 v11, 16, v11
v_cvt_u32_f32 v11, v11
v_subrev_u32 v12, 134, v12
v_med3_i32 v12, v12, 0, 3
v_lshrrev_b32 v13, 4, v11
v_bfi_b32 v13, 7, v11, v13
v_lshrrev_b32 v13, v12, v13
v_lshl_add_u32 v13, v12, 3, v13
v_bfe_u32 v11, v11, 3, 4
v_mul_u32_u24 v11, 52, v11
v_add_u32 v11, v11, v13
v_cndmask_b32 v11, v11, 48, vcc
v_lshl_add_u32 v193, v11, 2, s67
v_subrev_u32 v11, 34, v7
v_cmp_gt_i32 vcc, 0, v11
v_cvt_f32_i32 v11, v11
v_cvt_pk_bf16_f32 v11, v11, v11
v_bfe_u32 v12, v11, 7, 8
v_lshlrev_b32 v11, 16, v11
v_cvt_u32_f32 v11, v11
v_subrev_u32 v12, 134, v12
v_med3_i32 v12, v12, 0, 3
v_lshrrev_b32 v13, 4, v11
v_bfi_b32 v13, 7, v11, v13
v_lshrrev_b32 v13, v12, v13
v_lshl_add_u32 v13, v12, 3, v13
v_bfe_u32 v11, v11, 3, 4
v_mul_u32_u24 v11, 52, v11
v_add_u32 v11, v11, v13
v_cndmask_b32 v11, v11, 48, vcc
v_lshl_add_u32 v194, v11, 2, s67
v_and_b32 v14, 15, v0
v_lshrrev_b32 v15, 4, v0
v_add_u32 v11, 0, v14
v_lshrrev_b32 v12, 3, v11
v_subrev_u32 v12, 1, v12
v_med3_i32 v12, v12, 0, 3
v_lshlrev_b32 v13, 3, v12
v_sub_u32 v11, v11, v13
v_lshlrev_b32 v11, v12, v11
v_lshrrev_b32 v12, 3, v11
v_and_b32 v11, 7, v11
v_lshl_add_u32 v11, v12, 7, v11
v_cvt_f32_u32 v40, v11
v_add_u32 v11, 16, v14
v_lshrrev_b32 v12, 3, v11
v_subrev_u32 v12, 1, v12
v_med3_i32 v12, v12, 0, 3
v_lshlrev_b32 v13, 3, v12
v_sub_u32 v11, v11, v13
v_lshlrev_b32 v11, v12, v11
v_lshrrev_b32 v12, 3, v11
v_and_b32 v11, 7, v11
v_lshl_add_u32 v11, v12, 7, v11
v_cvt_f32_u32 v41, v11
v_add_u32 v11, 32, v14
v_lshrrev_b32 v12, 3, v11
v_subrev_u32 v12, 1, v12
v_med3_i32 v12, v12, 0, 3
v_lshlrev_b32 v13, 3, v12
v_sub_u32 v11, v11, v13
v_lshlrev_b32 v11, v12, v11
v_lshrrev_b32 v12, 3, v11
v_and_b32 v11, 7, v11
v_lshl_add_u32 v11, v12, 7, v11
v_cvt_f32_u32 v42, v11
v_lshlrev_b32 v11, 3, v14
v_cvt_f32_u32 v43, v11
v_mul_u32_u24 v11, 208, v14
v_lshl_add_u32 v11, v15, 4, v11
v_add_u32 v9, s67, v11
v_lshl_add_u32 v10, v15, 4, s68
v_lshl_add_u32 v8, v0, 6, s66
v_and_b32 v11, 3, v0
v_sub_u32 v11, 3, v11
v_mul_u32_u24 v11, 4160, v11
v_bfe_u32 v12, v0, 2, 3
v_lshlrev_b32 v12, 3, v12
v_sub_u32 v11, v11, v12
v_lshl_add_u32 v11, v5, 4, v11
s_add_u32 s2, s66, 2104
v_add_u32 v44, s2, v11
v_subrev_u32 v45, 2048, v44
v_and_b32 v11, 31, v0
v_mul_u32_u24 v11, 80, v11
s_mul_i32 s2, s42, 15360
v_add_u32 v11, s2, v11
v_lshl_add_u32 v46, v5, 4, v11
v_lshl_add_u32 v47, v5, 3, v11
s_waitcnt vmcnt(8)
v_lshlrev_b32 v16, 16, v16
v_lshlrev_b32 v17, 16, v17
v_mul_f32 v11, s62, v16
v_rndne_f32 v12, v11
v_sub_f32 v11, v11, v12
v_fma_f32 v11, v16, s63, v11
v_exp_f32 v11, v11
v_cvt_i32_f32 v12, v12
v_ldexp_f32 v11, v11, v12
v_cvt_pk_bf16_f32 v11, v11, v11
v_lshlrev_b32 v16, 16, v11
v_readlane_b32 s58, v17, 0
v_readlane_b32 s59, v17, 32
v_add_f32 v17, v16, v16
v_lshl_add_u32 v7, v0, 6, s68
v_lshlrev_b32 v28, 16, v18
v_lshlrev_b32 v29, 16, v20
v_lshlrev_b32 v30, 16, v22
v_lshlrev_b32 v31, 16, v24
v_mul_f32 v11, s62, v28
v_rndne_f32 v12, v11
v_sub_f32 v11, v11, v12
v_fma_f32 v11, v28, s63, v11
v_exp_f32 v11, v11
v_cvt_i32_f32 v12, v12
v_ldexp_f32 v11, v11, v12
v_cvt_pk_bf16_f32 v11, v11, v11
v_lshlrev_b32 v28, 16, v11
v_mul_f32 v28, v28, v16
v_mul_f32 v29, v29, v16
v_mul_f32 v32, 0xbfb8aa3b, v28
v_mul_f32 v33, 0.15915494, v29
v_mul_f32 v34, v30, v17
v_mul_f32 v35, v31, v17
ds_write_b128 v7, v[32:35] offset:0
v_and_b32 v28, 0xffff0000, v18
v_and_b32 v29, 0xffff0000, v20
v_and_b32 v30, 0xffff0000, v22
v_and_b32 v31, 0xffff0000, v24
v_mul_f32 v11, s62, v28
v_rndne_f32 v12, v11
v_sub_f32 v11, v11, v12
v_fma_f32 v11, v28, s63, v11
v_exp_f32 v11, v11
v_cvt_i32_f32 v12, v12
v_ldexp_f32 v11, v11, v12
v_cvt_pk_bf16_f32 v11, v11, v11
v_lshlrev_b32 v28, 16, v11
v_mul_f32 v28, v28, v16
v_mul_f32 v29, v29, v16
v_mul_f32 v32, 0xbfb8aa3b, v28
v_mul_f32 v33, 0.15915494, v29
v_mul_f32 v34, v30, v17
v_mul_f32 v35, v31, v17
ds_write_b128 v7, v[32:35] offset:16
v_lshlrev_b32 v28, 16, v19
v_lshlrev_b32 v29, 16, v21
v_lshlrev_b32 v30, 16, v23
v_lshlrev_b32 v31, 16, v25
v_mul_f32 v11, s62, v28
v_rndne_f32 v12, v11
v_sub_f32 v11, v11, v12
v_fma_f32 v11, v28, s63, v11
v_exp_f32 v11, v11
v_cvt_i32_f32 v12, v12
v_ldexp_f32 v11, v11, v12
v_cvt_pk_bf16_f32 v11, v11, v11
v_lshlrev_b32 v28, 16, v11
v_mul_f32 v28, v28, v16
v_mul_f32 v29, v29, v16
v_mul_f32 v32, 0xbfb8aa3b, v28
v_mul_f32 v33, 0.15915494, v29
v_mul_f32 v34, v30, v17
v_mul_f32 v35, v31, v17
ds_write_b128 v7, v[32:35] offset:32
v_and_b32 v28, 0xffff0000, v19
v_and_b32 v29, 0xffff0000, v21
v_and_b32 v30, 0xffff0000, v23
v_and_b32 v31, 0xffff0000, v25
v_mul_f32 v11, s62, v28
v_rndne_f32 v12, v11
v_sub_f32 v11, v11, v12
v_fma_f32 v11, v28, s63, v11
v_exp_f32 v11, v11
v_cvt_i32_f32 v12, v12
v_ldexp_f32 v11, v11, v12
v_cvt_pk_bf16_f32 v11, v11, v11
v_lshlrev_b32 v28, 16, v11
v_mul_f32 v28, v28, v16
v_mul_f32 v29, v29, v16
v_mul_f32 v32, 0xbfb8aa3b, v28
v_mul_f32 v33, 0.15915494, v29
v_mul_f32 v34, v30, v17
v_mul_f32 v35, v31, v17
ds_write_b128 v7, v[32:35] offset:48
s_mov_b32 s60, 0
s_nop 0
S_CH:
s_waitcnt lgkmcnt(0)
ds_read_b128 v[16:19], v10
s_mov_b32 s61, 16
v_mov_b32 v48, 0
v_mov_b32 v49, 0
v_mov_b32 v50, 0
v_mov_b32 v51, 0
v_mov_b32 v52, 0
v_mov_b32 v53, 0
v_mov_b32 v54, 0
v_mov_b32 v55, 0
v_mov_b32 v56, 0
v_mov_b32 v57, 0
v_mov_b32 v58, 0
v_mov_b32 v59, 0
v_mov_b32 v80, 0
v_mov_b32 v81, 0
v_mov_b32 v82, 0
v_mov_b32 v83, 0
v_mov_b32 v84, 0
v_mov_b32 v85, 0
v_mov_b32 v86, 0
v_mov_b32 v87, 0
s_nop 2
S_KL:
s_waitcnt lgkmcnt(0)
ds_read_b128 v[20:23], v10 offset:64
v_mul_f32 v28, v17, v40
v_mul_f32 v24, v16, v40
v_mfma_f32_16x16x4_f32 v[48:51], v80, v83, v[48:51]
v_mul_f32 v29, v17, v41
v_mul_f32 v25, v16, v41
v_mul_f32 v30, v17, v42
v_mul_f32 v26, v16, v42
v_mul_f32 v31, v17, v43
v_mul_f32 v27, v16, v43
v_fract_f32 v28, v28
v_fract_f32 v29, v29
v_mfma_f32_16x16x4_f32 v[52:55], v81, v83, v[52:55]
v_fract_f32 v30, v30
v_fract_f32 v31, v31
v_exp_f32 v27, v27
v_cos_f32 v75, v31
v_mfma_f32_16x16x4_f32 v[56:59], v82, v83, v[56:59]
v_sin_f32 v31, v31
v_exp_f32 v24, v24
v_cos_f32 v72, v28
v_mfma_f32_16x16x4_f32 v[48:51], v84, v87, v[48:51]
v_sin_f32 v28, v28
v_exp_f32 v25, v25
v_cos_f32 v73, v29
v_mfma_f32_16x16x4_f32 v[52:55], v85, v87, v[52:55]
v_sin_f32 v29, v29
v_exp_f32 v26, v26
v_cos_f32 v74, v30
v_mfma_f32_16x16x4_f32 v[56:59], v86, v87, v[56:59]
v_sin_f32 v30, v30
v_mul_f32 v75, v75, v27
v_mul_f32 v31, v31, v27
v_mul_f32 v64, v72, v24
v_mul_f32 v68, v28, v24
v_mul_f32 v65, v73, v25
v_mul_f32 v69, v29, v25
v_mul_f32 v66, v74, v26
v_mul_f32 v70, v30, v26
v_mul_f32 v67, v75, v18
v_mul_f32 v71, v75, v19
v_fma_f32 v67, -v31, v19, v67
v_fma_f32 v71, -v31, v18, -v71
s_waitcnt lgkmcnt(0)
ds_read_b128 v[16:19], v10 offset:128
v_mul_f32 v28, v21, v40
v_mul_f32 v24, v20, v40
v_mfma_f32_16x16x4_f32 v[48:51], v64, v67, v[48:51]
v_mul_f32 v29, v21, v41
v_mul_f32 v25, v20, v41
v_mul_f32 v30, v21, v42
v_mul_f32 v26, v20, v42
v_mul_f32 v31, v21, v43
v_mul_f32 v27, v20, v43
v_fract_f32 v28, v28
v_fract_f32 v29, v29
v_mfma_f32_16x16x4_f32 v[52:55], v65, v67, v[52:55]
v_fract_f32 v30, v30
v_fract_f32 v31, v31
v_exp_f32 v27, v27
v_cos_f32 v91, v31
v_mfma_f32_16x16x4_f32 v[56:59], v66, v67, v[56:59]
v_sin_f32 v31, v31
v_exp_f32 v24, v24
v_cos_f32 v88, v28
v_mfma_f32_16x16x4_f32 v[48:51], v68, v71, v[48:51]
v_sin_f32 v28, v28
v_exp_f32 v25, v25
v_cos_f32 v89, v29
v_mfma_f32_16x16x4_f32 v[52:55], v69, v71, v[52:55]
v_sin_f32 v29, v29
v_exp_f32 v26, v26
v_cos_f32 v90, v30
v_mfma_f32_16x16x4_f32 v[56:59], v70, v71, v[56:59]
v_sin_f32 v30, v30
v_mul_f32 v91, v91, v27
v_mul_f32 v31, v31, v27
v_mul_f32 v80, v88, v24
v_mul_f32 v84, v28, v24
v_mul_f32 v81, v89, v25
v_mul_f32 v85, v29, v25
v_mul_f32 v82, v90, v26
v_mul_f32 v86, v30, v26
v_mul_f32 v83, v91, v22
v_mul_f32 v87, v91, v23
v_fma_f32 v83, -v31, v23, v83
v_fma_f32 v87, -v31, v22, -v87
v_add_u32 v10, 128, v10
s_sub_u32 s61, s61, 1
s_cmp_lg_u32 s61, 0
s_cbranch_scc1 S_KL
v_mfma_f32_16x16x4_f32 v[48:51], v80, v83, v[48:51]
v_mfma_f32_16x16x4_f32 v[52:55], v81, v83, v[52:55]
v_mfma_f32_16x16x4_f32 v[56:59], v82, v83, v[56:59]
v_mfma_f32_16x16x4_f32 v[48:51], v84, v87, v[48:51]
v_mfma_f32_16x16x4_f32 v[52:55], v85, v87, v[52:55]
v_mfma_f32_16x16x4_f32 v[56:59], v86, v87, v[56:59]
s_cmp_lg_u32 s60, 0
s_cbranch_scc1 S_NOU
s_waitcnt vmcnt(0)
v_perm_b32 v96, v204, v200, s56
v_perm_b32 v97, v212, v208, s56
v_perm_b32 v98, v220, v216, s56
v_perm_b32 v99, v228, v224, s56
ds_write_b128 v2, v[96:99] offset:2560
v_perm_b32 v100, v204, v200, s57
v_perm_b32 v101, v212, v208, s57
v_perm_b32 v102, v220, v216, s57
v_perm_b32 v103, v228, v224, s57
ds_write_b128 v2, v[100:103] offset:10240
v_perm_b32 v96, v205, v201, s56
v_perm_b32 v97, v213, v209, s56
v_perm_b32 v98, v221, v217, s56
v_perm_b32 v99, v229, v225, s56
ds_write_b128 v2, v[96:99] offset:17920
v_perm_b32 v100, v205, v201, s57
v_perm_b32 v101, v213, v209, s57
v_perm_b32 v102, v221, v217, s57
v_perm_b32 v103, v229, v225, s57
ds_write_b128 v2, v[100:103] offset:25600
v_perm_b32 v96, v206, v202, s56
v_perm_b32 v97, v214, v210, s56
v_perm_b32 v98, v222, v218, s56
v_perm_b32 v99, v230, v226, s56
ds_write_b128 v2, v[96:99] offset:33280
v_perm_b32 v100, v206, v202, s57
v_perm_b32 v101, v214, v210, s57
v_perm_b32 v102, v222, v218, s57
v_perm_b32 v103, v230, v226, s57
ds_write_b128 v2, v[100:103] offset:40960
v_perm_b32 v96, v207, v203, s56
v_perm_b32 v97, v215, v211, s56
v_perm_b32 v98, v223, v219, s56
v_perm_b32 v99, v231, v227, s56
ds_write_b128 v2, v[96:99] offset:48640
v_perm_b32 v100, v207, v203, s57
v_perm_b32 v101, v215, v211, s57
v_perm_b32 v102, v223, v219, s57
v_perm_b32 v103, v231, v227, s57
ds_write_b128 v2, v[100:103] offset:56320
s_waitcnt lgkmcnt(0)
s_barrier
S_NOU:
s_nop 15
s_nop 3
ds_write_b128 v9, v[48:51] offset:0
ds_write_b128 v9, v[52:55] offset:64
ds_write_b128 v9, v[56:59] offset:128
s_waitcnt lgkmcnt(0)
ds_read_b32 v64, v160
ds_read_b32 v65, v161
ds_read_b32 v66, v162
ds_read_b32 v67, v163
ds_read_b32 v68, v164
ds_read_b32 v69, v165
ds_read_b32 v70, v166
ds_read_b32 v71, v167
ds_read_b32 v72, v168
ds_read_b32 v73, v169
ds_read_b32 v74, v170
ds_read_b32 v75, v171
ds_read_b32 v76, v172
ds_read_b32 v77, v173
ds_read_b32 v78, v174
ds_read_b32 v79, v175
ds_read_b32 v80, v176
ds_read_b32 v81, v177
ds_read_b32 v82, v178
ds_read_b32 v83, v179
ds_read_b32 v84, v180
ds_read_b32 v85, v181
ds_read_b32 v86, v182
ds_read_b32 v87, v183
ds_read_b32 v88, v184
ds_read_b32 v89, v185
ds_read_b32 v90, v186
ds_read_b32 v91, v187
ds_read_b32 v92, v188
ds_read_b32 v93, v189
ds_read_b32 v94, v190
ds_read_b32 v95, v191
ds_read_b32 v96, v192
ds_read_b32 v97, v193
ds_read_b32 v98, v194
s_waitcnt lgkmcnt(0)
v_cvt_pk_bf16_f32 v104, v64, v65
v_cvt_pk_bf16_f32 v105, v66, v67
v_cvt_pk_bf16_f32 v106, v68, v69
v_cvt_pk_bf16_f32 v107, v70, v71
ds_write_b128 v8, v[104:107] offset:0
v_cvt_pk_bf16_f32 v108, v72, v73
v_cvt_pk_bf16_f32 v109, v74, v75
v_cvt_pk_bf16_f32 v110, v76, v77
v_cvt_pk_bf16_f32 v111, v78, v79
ds_write_b128 v8, v[108:111] offset:16
v_cvt_pk_bf16_f32 v112, v80, v81
v_cvt_pk_bf16_f32 v113, v82, v83
v_cvt_pk_bf16_f32 v114, v84, v85
v_cvt_pk_bf16_f32 v115, v86, v87
ds_write_b128 v8, v[112:115] offset:32
v_cvt_pk_bf16_f32 v116, v88, v89
v_cvt_pk_bf16_f32 v117, v90, v91
v_cvt_pk_bf16_f32 v118, v92, v93
v_cvt_pk_bf16_f32 v119, v94, v95
ds_write_b128 v8, v[116:119] offset:48
v_cvt_pk_bf16_f32 v104, v65, v66
v_cvt_pk_bf16_f32 v105, v67, v68
v_cvt_pk_bf16_f32 v106, v69, v70
v_cvt_pk_bf16_f32 v107, v71, v72
ds_write_b128 v8, v[104:107] offset:4160
v_cvt_pk_bf16_f32 v108, v73, v74
v_cvt_pk_bf16_f32 v109, v75, v76
v_cvt_pk_bf16_f32 v110, v77, v78
v_cvt_pk_bf16_f32 v111, v79, v80
ds_write_b128 v8, v[108:111] offset:4176
v_cvt_pk_bf16_f32 v112, v81, v82
v_cvt_pk_bf16_f32 v113, v83, v84
v_cvt_pk_bf16_f32 v114, v85, v86
v_cvt_pk_bf16_f32 v115, v87, v88
ds_write_b128 v8, v[112:115] offset:4192
v_cvt_pk_bf16_f32 v116, v89, v90
v_cvt_pk_bf16_f32 v117, v91, v92
v_cvt_pk_bf16_f32 v118, v93, v94
v_cvt_pk_bf16_f32 v119, v95, v96
ds_write_b128 v8, v[116:119] offset:4208
v_cvt_pk_bf16_f32 v104, v66, v67
v_cvt_pk_bf16_f32 v105, v68, v69
v_cvt_pk_bf16_f32 v106, v70, v71
v_cvt_pk_bf16_f32 v107, v72, v73
ds_write_b128 v8, v[104:107] offset:8320
v_cvt_pk_bf16_f32 v108, v74, v75
v_cvt_pk_bf16_f32 v109, v76, v77
v_cvt_pk_bf16_f32 v110, v78, v79
v_cvt_pk_bf16_f32 v111, v80, v81
ds_write_b128 v8, v[108:111] offset:8336
v_cvt_pk_bf16_f32 v112, v82, v83
v_cvt_pk_bf16_f32 v113, v84, v85
v_cvt_pk_bf16_f32 v114, v86, v87
v_cvt_pk_bf16_f32 v115, v88, v89
ds_write_b128 v8, v[112:115] offset:8352
v_cvt_pk_bf16_f32 v116, v90, v91
v_cvt_pk_bf16_f32 v117, v92, v93
v_cvt_pk_bf16_f32 v118, v94, v95
v_cvt_pk_bf16_f32 v119, v96, v97
ds_write_b128 v8, v[116:119] offset:8368
v_cvt_pk_bf16_f32 v104, v67, v68
v_cvt_pk_bf16_f32 v105, v69, v70
v_cvt_pk_bf16_f32 v106, v71, v72
v_cvt_pk_bf16_f32 v107, v73, v74
ds_write_b128 v8, v[104:107] offset:12480
v_cvt_pk_bf16_f32 v108, v75, v76
v_cvt_pk_bf16_f32 v109, v77, v78
v_cvt_pk_bf16_f32 v110, v79, v80
v_cvt_pk_bf16_f32 v111, v81, v82
ds_write_b128 v8, v[108:111] offset:12496
v_cvt_pk_bf16_f32 v112, v83, v84
v_cvt_pk_bf16_f32 v113, v85, v86
v_cvt_pk_bf16_f32 v114, v87, v88
v_cvt_pk_bf16_f32 v115, v89, v90
ds_write_b128 v8, v[112:115] offset:12512
v_cvt_pk_bf16_f32 v116, v91, v92
v_cvt_pk_bf16_f32 v117, v93, v94
v_cvt_pk_bf16_f32 v118, v95, v96
v_cvt_pk_bf16_f32 v119, v97, v98
ds_write_b128 v8, v[116:119] offset:12528
s_waitcnt lgkmcnt(0)
ds_read2_b64 v[96:99], v44 offset0:248 offset1:249
ds_read_b128 v[100:103], v46 offset:5120
ds_read_b128 v[104:107], v46 offset:2560
ds_read2_b64 v[108:111], v45 offset0:248 offset1:249
ds_read2_b64 v[112:115], v44 offset0:252 offset1:253
ds_read_b128 v[116:119], v46 offset:5152
ds_read_b128 v[120:123], v46 offset:2592
ds_read2_b64 v[124:127], v45 offset0:252 offset1:253
s_waitcnt lgkmcnt(4)
v_mfma_f32_32x32x16_bf16 v[64:79], v[96:99], v[100:103], 0
ds_read2_b64 v[128:131], v44 offset0:240 offset1:241
ds_read_b128 v[132:135], v46 offset:5040
ds_read_b128 v[136:139], v46 offset:2480
ds_read2_b64 v[140:143], v45 offset0:240 offset1:241
v_mfma_f32_32x32x16_bf16 v[48:63], v[96:99], v[104:107], 0
v_mfma_f32_32x32x16_bf16 v[80:95], v[108:111], v[104:107], 0
s_waitcnt lgkmcnt(4)
v_mfma_f32_32x32x16_bf16 v[64:79], v[112:115], v[116:119], v[64:79]
ds_read2_b64 v[96:99], v44 offset0:244 offset1:245
ds_read_b128 v[100:103], v46 offset:5072
ds_read_b128 v[104:107], v46 offset:2512
ds_read2_b64 v[108:111], v45 offset0:244 offset1:245
v_mfma_f32_32x32x16_bf16 v[48:63], v[112:115], v[120:123], v[48:63]
v_mfma_f32_32x32x16_bf16 v[80:95], v[124:127], v[120:123], v[80:95]
s_waitcnt lgkmcnt(4)
v_mfma_f32_32x32x16_bf16 v[64:79], v[128:131], v[132:135], v[64:79]
ds_read2_b64 v[112:115], v44 offset0:232 offset1:233
ds_read_b128 v[116:119], v46 offset:4960
ds_read_b128 v[120:123], v46 offset:2400
ds_read2_b64 v[124:127], v45 offset0:232 offset1:233
v_mfma_f32_32x32x16_bf16 v[48:63], v[128:131], v[136:139], v[48:63]
v_mfma_f32_32x32x16_bf16 v[80:95], v[140:143], v[136:139], v[80:95]
s_waitcnt lgkmcnt(4)
v_mfma_f32_32x32x16_bf16 v[64:79], v[96:99], v[100:103], v[64:79]
ds_read2_b64 v[128:131], v44 offset0:236 offset1:237
ds_read_b128 v[132:135], v46 offset:4992
ds_read_b128 v[136:139], v46 offset:2432
ds_read2_b64 v[140:143], v45 offset0:236 offset1:237
v_mfma_f32_32x32x16_bf16 v[48:63], v[96:99], v[104:107], v[48:63]
v_mfma_f32_32x32x16_bf16 v[80:95], v[108:111], v[104:107], v[80:95]
s_waitcnt lgkmcnt(4)
v_mfma_f32_32x32x16_bf16 v[64:79], v[112:115], v[116:119], v[64:79]
ds_read2_b64 v[96:99], v44 offset0:224 offset1:225
ds_read_b128 v[100:103], v46 offset:4880
ds_read_b128 v[104:107], v46 offset:2320
ds_read2_b64 v[108:111], v45 offset0:224 offset1:225
v_mfma_f32_32x32x16_bf16 v[48:63], v[112:115], v[120:123], v[48:63]
v_mfma_f32_32x32x16_bf16 v[80:95], v[124:127], v[120:123], v[80:95]
s_waitcnt lgkmcnt(4)
v_mfma_f32_32x32x16_bf16 v[64:79], v[128:131], v[132:135], v[64:79]
ds_read2_b64 v[112:115], v44 offset0:228 offset1:229
ds_read_b128 v[116:119], v46 offset:4912
ds_read_b128 v[120:123], v46 offset:2352
ds_read2_b64 v[124:127], v45 offset0:228 offset1:229
v_mfma_f32_32x32x16_bf16 v[48:63], v[128:131], v[136:139], v[48:63]
v_mfma_f32_32x32x16_bf16 v[80:95], v[140:143], v[136:139], v[80:95]
s_waitcnt lgkmcnt(4)
v_mfma_f32_32x32x16_bf16 v[64:79], v[96:99], v[100:103], v[64:79]
ds_read2_b64 v[128:131], v44 offset0:216 offset1:217
ds_read_b128 v[132:135], v46 offset:4800
ds_read_b128 v[136:139], v46 offset:2240
ds_read2_b64 v[140:143], v45 offset0:216 offset1:217
v_mfma_f32_32x32x16_bf16 v[48:63], v[96:99], v[104:107], v[48:63]
v_mfma_f32_32x32x16_bf16 v[80:95], v[108:111], v[104:107], v[80:95]
s_waitcnt lgkmcnt(4)
v_mfma_f32_32x32x16_bf16 v[64:79], v[112:115], v[116:119], v[64:79]
ds_read2_b64 v[96:99], v44 offset0:220 offset1:221
ds_read_b128 v[100:103], v46 offset:4832
ds_read_b128 v[104:107], v46 offset:2272
ds_read2_b64 v[108:111], v45 offset0:220 offset1:221
v_mfma_f32_32x32x16_bf16 v[48:63], v[112:115], v[120:123], v[48:63]
v_mfma_f32_32x32x16_bf16 v[80:95], v[124:127], v[120:123], v[80:95]
s_waitcnt lgkmcnt(4)
v_mfma_f32_32x32x16_bf16 v[64:79], v[128:131], v[132:135], v[64:79]
ds_read2_b64 v[112:115], v44 offset0:208 offset1:209
ds_read_b128 v[116:119], v46 offset:4720
ds_read_b128 v[120:123], v46 offset:2160
ds_read2_b64 v[124:127], v45 offset0:208 offset1:209
v_mfma_f32_32x32x16_bf16 v[48:63], v[128:131], v[136:139], v[48:63]
v_mfma_f32_32x32x16_bf16 v[80:95], v[140:143], v[136:139], v[80:95]
s_waitcnt lgkmcnt(4)
v_mfma_f32_32x32x16_bf16 v[64:79], v[96:99], v[100:103], v[64:79]
ds_read2_b64 v[128:131], v44 offset0:212 offset1:213
ds_read_b128 v[132:135], v46 offset:4752
ds_read_b128 v[136:139], v46 offset:2192
ds_read2_b64 v[140:143], v45 offset0:212 offset1:213
v_mfma_f32_32x32x16_bf16 v[48:63], v[96:99], v[104:107], v[48:63]
v_mfma_f32_32x32x16_bf16 v[80:95], v[108:111], v[104:107], v[80:95]
s_waitcnt lgkmcnt(4)
v_mfma_f32_32x32x16_bf16 v[64:79], v[112:115], v[116:119], v[64:79]
ds_read2_b64 v[96:99], v44 offset0:200 offset1:201
ds_read_b128 v[100:103], v46 offset:4640
ds_read_b128 v[104:107], v46 offset:2080
ds_read2_b64 v[108:111], v45 offset0:200 offset1:201
v_mfma_f32_32x32x16_bf16 v[48:63], v[112:115], v[120:123], v[48:63]
v_mfma_f32_32x32x16_bf16 v[80:95], v[124:127], v[120:123], v[80:95]
s_waitcnt lgkmcnt(4)
v_mfma_f32_32x32x16_bf16 v[64:79], v[128:131], v[132:135], v[64:79]
ds_read2_b64 v[112:115], v44 offset0:204 offset1:205
ds_read_b128 v[116:119], v46 offset:4672
ds_read_b128 v[120:123], v46 offset:2112
ds_read2_b64 v[124:127], v45 offset0:204 offset1:205
v_mfma_f32_32x32x16_bf16 v[48:63], v[128:131], v[136:139], v[48:63]
v_mfma_f32_32x32x16_bf16 v[80:95], v[140:143], v[136:139], v[80:95]
s_waitcnt lgkmcnt(4)
v_mfma_f32_32x32x16_bf16 v[64:79], v[96:99], v[100:103], v[64:79]
ds_read2_b64 v[128:131], v44 offset0:192 offset1:193
ds_read_b128 v[132:135], v46 offset:4560
ds_read_b128 v[136:139], v46 offset:2000
ds_read2_b64 v[140:143], v45 offset0:192 offset1:193
v_mfma_f32_32x32x16_bf16 v[48:63], v[96:99], v[104:107], v[48:63]
v_mfma_f32_32x32x16_bf16 v[80:95], v[108:111], v[104:107], v[80:95]
s_waitcnt lgkmcnt(4)
v_mfma_f32_32x32x16_bf16 v[64:79], v[112:115], v[116:119], v[64:79]
ds_read2_b64 v[96:99], v44 offset0:196 offset1:197
ds_read_b128 v[100:103], v46 offset:4592
ds_read_b128 v[104:107], v46 offset:2032
ds_read2_b64 v[108:111], v45 offset0:196 offset1:197
v_mfma_f32_32x32x16_bf16 v[48:63], v[112:115], v[120:123], v[48:63]
v_mfma_f32_32x32x16_bf16 v[80:95], v[124:127], v[120:123], v[80:95]
s_waitcnt lgkmcnt(4)
v_mfma_f32_32x32x16_bf16 v[64:79], v[128:131], v[132:135], v[64:79]
ds_read2_b64 v[112:115], v44 offset0:184 offset1:185
ds_read_b128 v[116:119], v46 offset:4480
ds_read_b128 v[120:123], v46 offset:1920
ds_read2_b64 v[124:127], v45 offset0:184 offset1:185
v_mfma_f32_32x32x16_bf16 v[48:63], v[128:131], v[136:139], v[48:63]
v_mfma_f32_32x32x16_bf16 v[80:95], v[140:143], v[136:139], v[80:95]
s_waitcnt lgkmcnt(4)
v_mfma_f32_32x32x16_bf16 v[64:79], v[96:99], v[100:103], v[64:79]
ds_read2_b64 v[128:131], v44 offset0:188 offset1:189
ds_read_b128 v[132:135], v46 offset:4512
ds_read_b128 v[136:139], v46 offset:1952
ds_read2_b64 v[140:143], v45 offset0:188 offset1:189
v_mfma_f32_32x32x16_bf16 v[48:63], v[96:99], v[104:107], v[48:63]
v_mfma_f32_32x32x16_bf16 v[80:95], v[108:111], v[104:107], v[80:95]
s_waitcnt lgkmcnt(4)
v_mfma_f32_32x32x16_bf16 v[64:79], v[112:115], v[116:119], v[64:79]
ds_read2_b64 v[96:99], v44 offset0:176 offset1:177
ds_read_b128 v[100:103], v46 offset:4400
ds_read_b128 v[104:107], v46 offset:1840
ds_read2_b64 v[108:111], v45 offset0:176 offset1:177
v_mfma_f32_32x32x16_bf16 v[48:63], v[112:115], v[120:123], v[48:63]
v_mfma_f32_32x32x16_bf16 v[80:95], v[124:127], v[120:123], v[80:95]
s_waitcnt lgkmcnt(4)
v_mfma_f32_32x32x16_bf16 v[64:79], v[128:131], v[132:135], v[64:79]
ds_read2_b64 v[112:115], v44 offset0:180 offset1:181
ds_read_b128 v[116:119], v46 offset:4432
ds_read_b128 v[120:123], v46 offset:1872
ds_read2_b64 v[124:127], v45 offset0:180 offset1:181
v_mfma_f32_32x32x16_bf16 v[48:63], v[128:131], v[136:139], v[48:63]
v_mfma_f32_32x32x16_bf16 v[80:95], v[140:143], v[136:139], v[80:95]
s_waitcnt lgkmcnt(4)
v_mfma_f32_32x32x16_bf16 v[64:79], v[96:99], v[100:103], v[64:79]
ds_read2_b64 v[128:131], v44 offset0:168 offset1:169
ds_read_b128 v[132:135], v46 offset:4320
ds_read_b128 v[136:139], v46 offset:1760
ds_read2_b64 v[140:143], v45 offset0:168 offset1:169
v_mfma_f32_32x32x16_bf16 v[48:63], v[96:99], v[104:107], v[48:63]
v_mfma_f32_32x32x16_bf16 v[80:95], v[108:111], v[104:107], v[80:95]
s_waitcnt lgkmcnt(4)
v_mfma_f32_32x32x16_bf16 v[64:79], v[112:115], v[116:119], v[64:79]
ds_read2_b64 v[96:99], v44 offset0:172 offset1:173
ds_read_b128 v[100:103], v46 offset:4352
ds_read_b128 v[104:107], v46 offset:1792
ds_read2_b64 v[108:111], v45 offset0:172 offset1:173
v_mfma_f32_32x32x16_bf16 v[48:63], v[112:115], v[120:123], v[48:63]
v_mfma_f32_32x32x16_bf16 v[80:95], v[124:127], v[120:123], v[80:95]
s_waitcnt lgkmcnt(4)
v_mfma_f32_32x32x16_bf16 v[64:79], v[128:131], v[132:135], v[64:79]
ds_read2_b64 v[112:115], v44 offset0:160 offset1:161
ds_read_b128 v[116:119], v46 offset:4240
ds_read_b128 v[120:123], v46 offset:1680
ds_read2_b64 v[124:127], v45 offset0:160 offset1:161
v_mfma_f32_32x32x16_bf16 v[48:63], v[128:131], v[136:139], v[48:63]
v_mfma_f32_32x32x16_bf16 v[80:95], v[140:143], v[136:139], v[80:95]
s_waitcnt lgkmcnt(4)
v_mfma_f32_32x32x16_bf16 v[64:79], v[96:99], v[100:103], v[64:79]
ds_read2_b64 v[128:131], v44 offset0:164 offset1:165
ds_read_b128 v[132:135], v46 offset:4272
ds_read_b128 v[136:139], v46 offset:1712
ds_read2_b64 v[140:143], v45 offset0:164 offset1:165
v_mfma_f32_32x32x16_bf16 v[48:63], v[96:99], v[104:107], v[48:63]
v_mfma_f32_32x32x16_bf16 v[80:95], v[108:111], v[104:107], v[80:95]
s_waitcnt lgkmcnt(4)
v_mfma_f32_32x32x16_bf16 v[64:79], v[112:115], v[116:119], v[64:79]
ds_read2_b64 v[96:99], v44 offset0:152 offset1:153
ds_read_b128 v[100:103], v46 offset:4160
ds_read_b128 v[104:107], v46 offset:1600
ds_read2_b64 v[108:111], v45 offset0:152 offset1:153
v_mfma_f32_32x32x16_bf16 v[48:63], v[112:115], v[120:123], v[48:63]
v_mfma_f32_32x32x16_bf16 v[80:95], v[124:127], v[120:123], v[80:95]
s_waitcnt lgkmcnt(4)
v_mfma_f32_32x32x16_bf16 v[64:79], v[128:131], v[132:135], v[64:79]
ds_read2_b64 v[112:115], v44 offset0:156 offset1:157
ds_read_b128 v[116:119], v46 offset:4192
ds_read_b128 v[120:123], v46 offset:1632
ds_read2_b64 v[124:127], v45 offset0:156 offset1:157
v_mfma_f32_32x32x16_bf16 v[48:63], v[128:131], v[136:139], v[48:63]
v_mfma_f32_32x32x16_bf16 v[80:95], v[140:143], v[136:139], v[80:95]
s_waitcnt lgkmcnt(4)
v_mfma_f32_32x32x16_bf16 v[64:79], v[96:99], v[100:103], v[64:79]
ds_read2_b64 v[128:131], v44 offset0:144 offset1:145
ds_read_b128 v[132:135], v46 offset:4080
ds_read_b128 v[136:139], v46 offset:1520
ds_read2_b64 v[140:143], v45 offset0:144 offset1:145
v_mfma_f32_32x32x16_bf16 v[48:63], v[96:99], v[104:107], v[48:63]
v_mfma_f32_32x32x16_bf16 v[80:95], v[108:111], v[104:107], v[80:95]
s_waitcnt lgkmcnt(4)
v_mfma_f32_32x32x16_bf16 v[64:79], v[112:115], v[116:119], v[64:79]
ds_read2_b64 v[96:99], v44 offset0:148 offset1:149
ds_read_b128 v[100:103], v46 offset:4112
ds_read_b128 v[104:107], v46 offset:1552
ds_read2_b64 v[108:111], v45 offset0:148 offset1:149
v_mfma_f32_32x32x16_bf16 v[48:63], v[112:115], v[120:123], v[48:63]
v_mfma_f32_32x32x16_bf16 v[80:95], v[124:127], v[120:123], v[80:95]
s_waitcnt lgkmcnt(4)
v_mfma_f32_32x32x16_bf16 v[64:79], v[128:131], v[132:135], v[64:79]
ds_read2_b64 v[112:115], v44 offset0:136 offset1:137
ds_read_b128 v[116:119], v46 offset:4000
ds_read_b128 v[120:123], v46 offset:1440
ds_read2_b64 v[124:127], v45 offset0:136 offset1:137
v_mfma_f32_32x32x16_bf16 v[48:63], v[128:131], v[136:139], v[48:63]
v_mfma_f32_32x32x16_bf16 v[80:95], v[140:143], v[136:139], v[80:95]
s_waitcnt lgkmcnt(4)
v_mfma_f32_32x32x16_bf16 v[64:79], v[96:99], v[100:103], v[64:79]
ds_read2_b64 v[128:131], v44 offset0:140 offset1:141
ds_read_b128 v[132:135], v46 offset:4032
ds_read_b128 v[136:139], v46 offset:1472
ds_read2_b64 v[140:143], v45 offset0:140 offset1:141
v_mfma_f32_32x32x16_bf16 v[48:63], v[96:99], v[104:107], v[48:63]
v_mfma_f32_32x32x16_bf16 v[80:95], v[108:111], v[104:107], v[80:95]
s_waitcnt lgkmcnt(4)
v_mfma_f32_32x32x16_bf16 v[64:79], v[112:115], v[116:119], v[64:79]
ds_read2_b64 v[96:99], v44 offset0:128 offset1:129
ds_read_b128 v[100:103], v46 offset:3920
ds_read_b128 v[104:107], v46 offset:1360
ds_read2_b64 v[108:111], v45 offset0:128 offset1:129
v_mfma_f32_32x32x16_bf16 v[48:63], v[112:115], v[120:123], v[48:63]
v_mfma_f32_32x32x16_bf16 v[80:95], v[124:127], v[120:123], v[80:95]
s_waitcnt lgkmcnt(4)
v_mfma_f32_32x32x16_bf16 v[64:79], v[128:131], v[132:135], v[64:79]
ds_read2_b64 v[112:115], v44 offset0:132 offset1:133
ds_read_b128 v[116:119], v46 offset:3952
ds_read_b128 v[120:123], v46 offset:1392
ds_read2_b64 v[124:127], v45 offset0:132 offset1:133
v_mfma_f32_32x32x16_bf16 v[48:63], v[128:131], v[136:139], v[48:63]
v_mfma_f32_32x32x16_bf16 v[80:95], v[140:143], v[136:139], v[80:95]
s_waitcnt lgkmcnt(4)
v_mfma_f32_32x32x16_bf16 v[64:79], v[96:99], v[100:103], v[64:79]
ds_read2_b64 v[128:131], v44 offset0:120 offset1:121
ds_read_b128 v[132:135], v46 offset:3840
ds_read_b128 v[136:139], v46 offset:1280
ds_read2_b64 v[140:143], v45 offset0:120 offset1:121
v_mfma_f32_32x32x16_bf16 v[48:63], v[96:99], v[104:107], v[48:63]
v_mfma_f32_32x32x16_bf16 v[80:95], v[108:111], v[104:107], v[80:95]
s_waitcnt lgkmcnt(4)
v_mfma_f32_32x32x16_bf16 v[64:79], v[112:115], v[116:119], v[64:79]
ds_read2_b64 v[96:99], v44 offset0:124 offset1:125
ds_read_b128 v[100:103], v46 offset:3872
ds_read_b128 v[104:107], v46 offset:1312
ds_read2_b64 v[108:111], v45 offset0:124 offset1:125
v_mfma_f32_32x32x16_bf16 v[48:63], v[112:115], v[120:123], v[48:63]
v_mfma_f32_32x32x16_bf16 v[80:95], v[124:127], v[120:123], v[80:95]
s_waitcnt lgkmcnt(4)
v_mfma_f32_32x32x16_bf16 v[64:79], v[128:131], v[132:135], v[64:79]
ds_read2_b64 v[112:115], v44 offset0:112 offset1:113
ds_read_b128 v[116:119], v46 offset:3760
ds_read_b128 v[120:123], v46 offset:1200
ds_read2_b64 v[124:127], v45 offset0:112 offset1:113
v_mfma_f32_32x32x16_bf16 v[48:63], v[128:131], v[136:139], v[48:63]
v_mfma_f32_32x32x16_bf16 v[80:95], v[140:143], v[136:139], v[80:95]
s_waitcnt lgkmcnt(4)
v_mfma_f32_32x32x16_bf16 v[64:79], v[96:99], v[100:103], v[64:79]
ds_read2_b64 v[128:131], v44 offset0:116 offset1:117
ds_read_b128 v[132:135], v46 offset:3792
ds_read_b128 v[136:139], v46 offset:1232
ds_read2_b64 v[140:143], v45 offset0:116 offset1:117
v_mfma_f32_32x32x16_bf16 v[48:63], v[96:99], v[104:107], v[48:63]
v_mfma_f32_32x32x16_bf16 v[80:95], v[108:111], v[104:107], v[80:95]
s_waitcnt lgkmcnt(4)
v_mfma_f32_32x32x16_bf16 v[64:79], v[112:115], v[116:119], v[64:79]
ds_read2_b64 v[96:99], v44 offset0:104 offset1:105
ds_read_b128 v[100:103], v46 offset:3680
ds_read_b128 v[104:107], v46 offset:1120
ds_read2_b64 v[108:111], v45 offset0:104 offset1:105
v_mfma_f32_32x32x16_bf16 v[48:63], v[112:115], v[120:123], v[48:63]
v_mfma_f32_32x32x16_bf16 v[80:95], v[124:127], v[120:123], v[80:95]
s_waitcnt lgkmcnt(4)
v_mfma_f32_32x32x16_bf16 v[64:79], v[128:131], v[132:135], v[64:79]
ds_read2_b64 v[112:115], v44 offset0:108 offset1:109
ds_read_b128 v[116:119], v46 offset:3712
ds_read_b128 v[120:123], v46 offset:1152
ds_read2_b64 v[124:127], v45 offset0:108 offset1:109
v_mfma_f32_32x32x16_bf16 v[48:63], v[128:131], v[136:139], v[48:63]
v_mfma_f32_32x32x16_bf16 v[80:95], v[140:143], v[136:139], v[80:95]
s_waitcnt lgkmcnt(4)
v_mfma_f32_32x32x16_bf16 v[64:79], v[96:99], v[100:103], v[64:79]
ds_read2_b64 v[128:131], v44 offset0:96 offset1:97
ds_read_b128 v[132:135], v46 offset:3600
ds_read_b128 v[136:139], v46 offset:1040
ds_read2_b64 v[140:143], v45 offset0:96 offset1:97
v_mfma_f32_32x32x16_bf16 v[48:63], v[96:99], v[104:107], v[48:63]
v_mfma_f32_32x32x16_bf16 v[80:95], v[108:111], v[104:107], v[80:95]
s_waitcnt lgkmcnt(4)
v_mfma_f32_32x32x16_bf16 v[64:79], v[112:115], v[116:119], v[64:79]
ds_read2_b64 v[96:99], v44 offset0:100 offset1:101
ds_read_b128 v[100:103], v46 offset:3632
ds_read_b128 v[104:107], v46 offset:1072
ds_read2_b64 v[108:111], v45 offset0:100 offset1:101
v_mfma_f32_32x32x16_bf16 v[48:63], v[112:115], v[120:123], v[48:63]
v_mfma_f32_32x32x16_bf16 v[80:95], v[124:127], v[120:123], v[80:95]
s_waitcnt lgkmcnt(4)
v_mfma_f32_32x32x16_bf16 v[64:79], v[128:131], v[132:135], v[64:79]
ds_read2_b64 v[112:115], v44 offset0:88 offset1:89
ds_read_b128 v[116:119], v46 offset:3520
ds_read_b128 v[120:123], v46 offset:960
ds_read2_b64 v[124:127], v45 offset0:88 offset1:89
v_mfma_f32_32x32x16_bf16 v[48:63], v[128:131], v[136:139], v[48:63]
v_mfma_f32_32x32x16_bf16 v[80:95], v[140:143], v[136:139], v[80:95]
s_waitcnt lgkmcnt(4)
v_mfma_f32_32x32x16_bf16 v[64:79], v[96:99], v[100:103], v[64:79]
ds_read2_b64 v[128:131], v44 offset0:92 offset1:93
ds_read_b128 v[132:135], v46 offset:3552
ds_read_b128 v[136:139], v46 offset:992
ds_read2_b64 v[140:143], v45 offset0:92 offset1:93
v_mfma_f32_32x32x16_bf16 v[48:63], v[96:99], v[104:107], v[48:63]
v_mfma_f32_32x32x16_bf16 v[80:95], v[108:111], v[104:107], v[80:95]
s_waitcnt lgkmcnt(4)
v_mfma_f32_32x32x16_bf16 v[64:79], v[112:115], v[116:119], v[64:79]
ds_read2_b64 v[96:99], v44 offset0:80 offset1:81
ds_read_b128 v[100:103], v46 offset:3440
ds_read_b128 v[104:107], v46 offset:880
ds_read2_b64 v[108:111], v45 offset0:80 offset1:81
v_mfma_f32_32x32x16_bf16 v[48:63], v[112:115], v[120:123], v[48:63]
v_mfma_f32_32x32x16_bf16 v[80:95], v[124:127], v[120:123], v[80:95]
s_waitcnt lgkmcnt(4)
v_mfma_f32_32x32x16_bf16 v[64:79], v[128:131], v[132:135], v[64:79]
ds_read2_b64 v[112:115], v44 offset0:84 offset1:85
ds_read_b128 v[116:119], v46 offset:3472
ds_read_b128 v[120:123], v46 offset:912
ds_read2_b64 v[124:127], v45 offset0:84 offset1:85
v_mfma_f32_32x32x16_bf16 v[48:63], v[128:131], v[136:139], v[48:63]
v_mfma_f32_32x32x16_bf16 v[80:95], v[140:143], v[136:139], v[80:95]
s_waitcnt lgkmcnt(4)
v_mfma_f32_32x32x16_bf16 v[64:79], v[96:99], v[100:103], v[64:79]
ds_read2_b64 v[128:131], v44 offset0:72 offset1:73
ds_read_b128 v[132:135], v46 offset:3360
ds_read_b128 v[136:139], v46 offset:800
ds_read2_b64 v[140:143], v45 offset0:72 offset1:73
v_mfma_f32_32x32x16_bf16 v[48:63], v[96:99], v[104:107], v[48:63]
v_mfma_f32_32x32x16_bf16 v[80:95], v[108:111], v[104:107], v[80:95]
s_waitcnt lgkmcnt(4)
v_mfma_f32_32x32x16_bf16 v[64:79], v[112:115], v[116:119], v[64:79]
ds_read2_b64 v[96:99], v44 offset0:76 offset1:77
ds_read_b128 v[100:103], v46 offset:3392
ds_read_b128 v[104:107], v46 offset:832
ds_read2_b64 v[108:111], v45 offset0:76 offset1:77
v_mfma_f32_32x32x16_bf16 v[48:63], v[112:115], v[120:123], v[48:63]
v_mfma_f32_32x32x16_bf16 v[80:95], v[124:127], v[120:123], v[80:95]
s_waitcnt lgkmcnt(4)
v_mfma_f32_32x32x16_bf16 v[64:79], v[128:131], v[132:135], v[64:79]
ds_read2_b64 v[112:115], v44 offset0:64 offset1:65
ds_read_b128 v[116:119], v46 offset:3280
ds_read_b128 v[120:123], v46 offset:720
ds_read2_b64 v[124:127], v45 offset0:64 offset1:65
v_mfma_f32_32x32x16_bf16 v[48:63], v[128:131], v[136:139], v[48:63]
v_mfma_f32_32x32x16_bf16 v[80:95], v[140:143], v[136:139], v[80:95]
s_waitcnt lgkmcnt(4)
v_mfma_f32_32x32x16_bf16 v[64:79], v[96:99], v[100:103], v[64:79]
ds_read2_b64 v[128:131], v44 offset0:68 offset1:69
ds_read_b128 v[132:135], v46 offset:3312
ds_read_b128 v[136:139], v46 offset:752
ds_read2_b64 v[140:143], v45 offset0:68 offset1:69
v_mfma_f32_32x32x16_bf16 v[48:63], v[96:99], v[104:107], v[48:63]
v_mfma_f32_32x32x16_bf16 v[80:95], v[108:111], v[104:107], v[80:95]
s_waitcnt lgkmcnt(4)
v_mfma_f32_32x32x16_bf16 v[64:79], v[112:115], v[116:119], v[64:79]
ds_read2_b64 v[96:99], v44 offset0:56 offset1:57
ds_read_b128 v[100:103], v46 offset:3200
ds_read_b128 v[104:107], v46 offset:640
ds_read2_b64 v[108:111], v45 offset0:56 offset1:57
v_mfma_f32_32x32x16_bf16 v[48:63], v[112:115], v[120:123], v[48:63]
v_mfma_f32_32x32x16_bf16 v[80:95], v[124:127], v[120:123], v[80:95]
s_waitcnt lgkmcnt(4)
v_mfma_f32_32x32x16_bf16 v[64:79], v[128:131], v[132:135], v[64:79]
ds_read2_b64 v[112:115], v44 offset0:60 offset1:61
ds_read_b128 v[116:119], v46 offset:3232
ds_read_b128 v[120:123], v46 offset:672
ds_read2_b64 v[124:127], v45 offset0:60 offset1:61
v_mfma_f32_32x32x16_bf16 v[48:63], v[128:131], v[136:139], v[48:63]
v_mfma_f32_32x32x16_bf16 v[80:95], v[140:143], v[136:139], v[80:95]
s_waitcnt lgkmcnt(4)
v_mfma_f32_32x32x16_bf16 v[64:79], v[96:99], v[100:103], v[64:79]
ds_read2_b64 v[128:131], v44 offset0:48 offset1:49
ds_read_b128 v[132:135], v46 offset:3120
ds_read_b128 v[136:139], v46 offset:560
ds_read2_b64 v[140:143], v45 offset0:48 offset1:49
v_mfma_f32_32x32x16_bf16 v[48:63], v[96:99], v[104:107], v[48:63]
v_mfma_f32_32x32x16_bf16 v[80:95], v[108:111], v[104:107], v[80:95]
s_waitcnt lgkmcnt(4)
v_mfma_f32_32x32x16_bf16 v[64:79], v[112:115], v[116:119], v[64:79]
ds_read2_b64 v[96:99], v44 offset0:52 offset1:53
ds_read_b128 v[100:103], v46 offset:3152
ds_read_b128 v[104:107], v46 offset:592
ds_read2_b64 v[108:111], v45 offset0:52 offset1:53
v_mfma_f32_32x32x16_bf16 v[48:63], v[112:115], v[120:123], v[48:63]
v_mfma_f32_32x32x16_bf16 v[80:95], v[124:127], v[120:123], v[80:95]
s_waitcnt lgkmcnt(4)
v_mfma_f32_32x32x16_bf16 v[64:79], v[128:131], v[132:135], v[64:79]
ds_read2_b64 v[112:115], v44 offset0:40 offset1:41
ds_read_b128 v[116:119], v46 offset:3040
ds_read_b128 v[120:123], v46 offset:480
ds_read2_b64 v[124:127], v45 offset0:40 offset1:41
v_mfma_f32_32x32x16_bf16 v[48:63], v[128:131], v[136:139], v[48:63]
v_mfma_f32_32x32x16_bf16 v[80:95], v[140:143], v[136:139], v[80:95]
s_waitcnt lgkmcnt(4)
v_mfma_f32_32x32x16_bf16 v[64:79], v[96:99], v[100:103], v[64:79]
ds_read2_b64 v[128:131], v44 offset0:44 offset1:45
ds_read_b128 v[132:135], v46 offset:3072
ds_read_b128 v[136:139], v46 offset:512
ds_read2_b64 v[140:143], v45 offset0:44 offset1:45
v_mfma_f32_32x32x16_bf16 v[48:63], v[96:99], v[104:107], v[48:63]
v_mfma_f32_32x32x16_bf16 v[80:95], v[108:111], v[104:107], v[80:95]
s_waitcnt lgkmcnt(4)
v_mfma_f32_32x32x16_bf16 v[64:79], v[112:115], v[116:119], v[64:79]
ds_read2_b64 v[96:99], v44 offset0:32 offset1:33
ds_read_b128 v[100:103], v46 offset:2960
ds_read_b128 v[104:107], v46 offset:400
ds_read2_b64 v[108:111], v45 offset0:32 offset1:33
v_mfma_f32_32x32x16_bf16 v[48:63], v[112:115], v[120:123], v[48:63]
v_mfma_f32_32x32x16_bf16 v[80:95], v[124:127], v[120:123], v[80:95]
s_waitcnt lgkmcnt(4)
v_mfma_f32_32x32x16_bf16 v[64:79], v[128:131], v[132:135], v[64:79]
ds_read2_b64 v[112:115], v44 offset0:36 offset1:37
ds_read_b128 v[116:119], v46 offset:2992
ds_read_b128 v[120:123], v46 offset:432
ds_read2_b64 v[124:127], v45 offset0:36 offset1:37
v_mfma_f32_32x32x16_bf16 v[48:63], v[128:131], v[136:139], v[48:63]
v_mfma_f32_32x32x16_bf16 v[80:95], v[140:143], v[136:139], v[80:95]
s_waitcnt lgkmcnt(4)
v_mfma_f32_32x32x16_bf16 v[64:79], v[96:99], v[100:103], v[64:79]
ds_read2_b64 v[128:131], v44 offset0:24 offset1:25
ds_read_b128 v[132:135], v46 offset:2880
ds_read_b128 v[136:139], v46 offset:320
ds_read2_b64 v[140:143], v45 offset0:24 offset1:25
v_mfma_f32_32x32x16_bf16 v[48:63], v[96:99], v[104:107], v[48:63]
v_mfma_f32_32x32x16_bf16 v[80:95], v[108:111], v[104:107], v[80:95]
s_waitcnt lgkmcnt(4)
v_mfma_f32_32x32x16_bf16 v[64:79], v[112:115], v[116:119], v[64:79]
ds_read2_b64 v[96:99], v44 offset0:28 offset1:29
ds_read_b128 v[100:103], v46 offset:2912
ds_read_b128 v[104:107], v46 offset:352
ds_read2_b64 v[108:111], v45 offset0:28 offset1:29
v_mfma_f32_32x32x16_bf16 v[48:63], v[112:115], v[120:123], v[48:63]
v_mfma_f32_32x32x16_bf16 v[80:95], v[124:127], v[120:123], v[80:95]
s_waitcnt lgkmcnt(4)
v_mfma_f32_32x32x16_bf16 v[64:79], v[128:131], v[132:135], v[64:79]
ds_read2_b64 v[112:115], v44 offset0:16 offset1:17
ds_read_b128 v[116:119], v46 offset:2800
ds_read_b128 v[120:123], v46 offset:240
ds_read2_b64 v[124:127], v45 offset0:16 offset1:17
v_mfma_f32_32x32x16_bf16 v[48:63], v[128:131], v[136:139], v[48:63]
v_mfma_f32_32x32x16_bf16 v[80:95], v[140:143], v[136:139], v[80:95]
s_waitcnt lgkmcnt(4)
v_mfma_f32_32x32x16_bf16 v[64:79], v[96:99], v[100:103], v[64:79]
ds_read2_b64 v[128:131], v44 offset0:20 offset1:21
ds_read_b128 v[132:135], v46 offset:2832
ds_read_b128 v[136:139], v46 offset:272
ds_read2_b64 v[140:143], v45 offset0:20 offset1:21
v_mfma_f32_32x32x16_bf16 v[48:63], v[96:99], v[104:107], v[48:63]
v_mfma_f32_32x32x16_bf16 v[80:95], v[108:111], v[104:107], v[80:95]
s_waitcnt lgkmcnt(4)
v_mfma_f32_32x32x16_bf16 v[64:79], v[112:115], v[116:119], v[64:79]
ds_read2_b64 v[96:99], v44 offset0:8 offset1:9
ds_read_b128 v[100:103], v46 offset:2720
ds_read_b128 v[104:107], v46 offset:160
ds_read2_b64 v[108:111], v45 offset0:8 offset1:9
v_mfma_f32_32x32x16_bf16 v[48:63], v[112:115], v[120:123], v[48:63]
v_mfma_f32_32x32x16_bf16 v[80:95], v[124:127], v[120:123], v[80:95]
s_waitcnt lgkmcnt(4)
v_mfma_f32_32x32x16_bf16 v[64:79], v[128:131], v[132:135], v[64:79]
ds_read2_b64 v[112:115], v44 offset0:12 offset1:13
ds_read_b128 v[116:119], v46 offset:2752
ds_read_b128 v[120:123], v46 offset:192
ds_read2_b64 v[124:127], v45 offset0:12 offset1:13
v_mfma_f32_32x32x16_bf16 v[48:63], v[128:131], v[136:139], v[48:63]
v_mfma_f32_32x32x16_bf16 v[80:95], v[140:143], v[136:139], v[80:95]
s_waitcnt lgkmcnt(4)
v_mfma_f32_32x32x16_bf16 v[64:79], v[96:99], v[100:103], v[64:79]
ds_read2_b64 v[128:131], v44 offset0:0 offset1:1
ds_read_b128 v[132:135], v46 offset:2640
ds_read_b128 v[136:139], v46 offset:80
ds_read2_b64 v[140:143], v45 offset0:0 offset1:1
v_mfma_f32_32x32x16_bf16 v[48:63], v[96:99], v[104:107], v[48:63]
v_mfma_f32_32x32x16_bf16 v[80:95], v[108:111], v[104:107], v[80:95]
s_waitcnt lgkmcnt(4)
v_mfma_f32_32x32x16_bf16 v[64:79], v[112:115], v[116:119], v[64:79]
ds_read2_b64 v[96:99], v44 offset0:4 offset1:5
ds_read_b128 v[100:103], v46 offset:2672
ds_read_b128 v[104:107], v46 offset:112
ds_read2_b64 v[108:111], v45 offset0:4 offset1:5
v_mfma_f32_32x32x16_bf16 v[48:63], v[112:115], v[120:123], v[48:63]
v_mfma_f32_32x32x16_bf16 v[80:95], v[124:127], v[120:123], v[80:95]
s_waitcnt lgkmcnt(4)
v_mfma_f32_32x32x16_bf16 v[64:79], v[128:131], v[132:135], v[64:79]
v_mfma_f32_32x32x16_bf16 v[48:63], v[128:131], v[136:139], v[48:63]
v_mfma_f32_32x32x16_bf16 v[80:95], v[140:143], v[136:139], v[80:95]
s_waitcnt lgkmcnt(0)
v_mfma_f32_32x32x16_bf16 v[64:79], v[96:99], v[100:103], v[64:79]
v_mfma_f32_32x32x16_bf16 v[48:63], v[96:99], v[104:107], v[48:63]
v_mfma_f32_32x32x16_bf16 v[80:95], v[108:111], v[104:107], v[80:95]
ds_read_b64 v[16:17], v47 offset:2560
ds_read_b64 v[18:19], v47 offset:2576
ds_read_b64 v[20:21], v47 offset:2592
ds_read_b64 v[22:23], v47 offset:2608
ds_read_b64 v[24:25], v47 offset:5120
ds_read_b64 v[26:27], v47 offset:5136
ds_read_b64 v[28:29], v47 offset:5152
ds_read_b64 v[30:31], v47 offset:5168
s_nop 3
v_add_f32 v64, v64, v80
v_add_f32 v65, v65, v81
v_add_f32 v66, v66, v82
v_add_f32 v67, v67, v83
v_add_f32 v68, v68, v84
v_add_f32 v69, v69, v85
v_add_f32 v70, v70, v86
v_add_f32 v71, v71, v87
v_add_f32 v72, v72, v88
v_add_f32 v73, v73, v89
v_add_f32 v74, v74, v90
v_add_f32 v75, v75, v91
v_add_f32 v76, v76, v92
v_add_f32 v77, v77, v93
v_add_f32 v78, v78, v94
v_add_f32 v79, v79, v95
s_waitcnt lgkmcnt(0)
v_lshlrev_b32 v96, 16, v16
v_and_b32 v97, 0xffff0000, v16
v_lshlrev_b32 v98, 16, v17
v_and_b32 v99, 0xffff0000, v17
v_fmac_f32 v48, s58, v96
v_fmac_f32 v49, s58, v97
v_fmac_f32 v50, s58, v98
v_fmac_f32 v51, s58, v99
v_cvt_pk_bf16_f32 v16, v48, v49
v_cvt_pk_bf16_f32 v17, v50, v51
ds_write_b64 v47, v[16:17] offset:2560
v_lshlrev_b32 v96, 16, v18
v_and_b32 v97, 0xffff0000, v18
v_lshlrev_b32 v98, 16, v19
v_and_b32 v99, 0xffff0000, v19
v_fmac_f32 v52, s58, v96
v_fmac_f32 v53, s58, v97
v_fmac_f32 v54, s58, v98
v_fmac_f32 v55, s58, v99
v_cvt_pk_bf16_f32 v18, v52, v53
v_cvt_pk_bf16_f32 v19, v54, v55
ds_write_b64 v47, v[18:19] offset:2576
v_lshlrev_b32 v96, 16, v20
v_and_b32 v97, 0xffff0000, v20
v_lshlrev_b32 v98, 16, v21
v_and_b32 v99, 0xffff0000, v21
v_fmac_f32 v56, s58, v96
v_fmac_f32 v57, s58, v97
v_fmac_f32 v58, s58, v98
v_fmac_f32 v59, s58, v99
v_cvt_pk_bf16_f32 v20, v56, v57
v_cvt_pk_bf16_f32 v21, v58, v59
ds_write_b64 v47, v[20:21] offset:2592
v_lshlrev_b32 v96, 16, v22
v_and_b32 v97, 0xffff0000, v22
v_lshlrev_b32 v98, 16, v23
v_and_b32 v99, 0xffff0000, v23
v_fmac_f32 v60, s58, v96
v_fmac_f32 v61, s58, v97
v_fmac_f32 v62, s58, v98
v_fmac_f32 v63, s58, v99
v_cvt_pk_bf16_f32 v22, v60, v61
v_cvt_pk_bf16_f32 v23, v62, v63
ds_write_b64 v47, v[22:23] offset:2608
v_lshlrev_b32 v96, 16, v24
v_and_b32 v97, 0xffff0000, v24
v_lshlrev_b32 v98, 16, v25
v_and_b32 v99, 0xffff0000, v25
v_fmac_f32 v64, s58, v96
v_fmac_f32 v65, s58, v97
v_fmac_f32 v66, s58, v98
v_fmac_f32 v67, s58, v99
v_cvt_pk_bf16_f32 v24, v64, v65
v_cvt_pk_bf16_f32 v25, v66, v67
ds_write_b64 v47, v[24:25] offset:5120
v_lshlrev_b32 v96, 16, v26
v_and_b32 v97, 0xffff0000, v26
v_lshlrev_b32 v98, 16, v27
v_and_b32 v99, 0xffff0000, v27
v_fmac_f32 v68, s58, v96
v_fmac_f32 v69, s58, v97
v_fmac_f32 v70, s58, v98
v_fmac_f32 v71, s58, v99
v_cvt_pk_bf16_f32 v26, v68, v69
v_cvt_pk_bf16_f32 v27, v70, v71
ds_write_b64 v47, v[26:27] offset:5136
v_lshlrev_b32 v96, 16, v28
v_and_b32 v97, 0xffff0000, v28
v_lshlrev_b32 v98, 16, v29
v_and_b32 v99, 0xffff0000, v29
v_fmac_f32 v72, s58, v96
v_fmac_f32 v73, s58, v97
v_fmac_f32 v74, s58, v98
v_fmac_f32 v75, s58, v99
v_cvt_pk_bf16_f32 v28, v72, v73
v_cvt_pk_bf16_f32 v29, v74, v75
ds_write_b64 v47, v[28:29] offset:5152
v_lshlrev_b32 v96, 16, v30
v_and_b32 v97, 0xffff0000, v30
v_lshlrev_b32 v98, 16, v31
v_and_b32 v99, 0xffff0000, v31
v_fmac_f32 v76, s58, v96
v_fmac_f32 v77, s58, v97
v_fmac_f32 v78, s58, v98
v_fmac_f32 v79, s58, v99
v_cvt_pk_bf16_f32 v30, v76, v77
v_cvt_pk_bf16_f32 v31, v78, v79
ds_write_b64 v47, v[30:31] offset:5168
v_add_u32 v46, 7680, v46
v_add_u32 v47, 7680, v47
s_mov_b32 s58, s59
s_add_u32 s60, s60, 1
s_cmp_lt_u32 s60, 2
s_cbranch_scc1 S_CH
s_waitcnt lgkmcnt(0)
s_barrier
ds_read_b128 v[64:67], v2 offset:2560
ds_read_b128 v[68:71], v2 offset:10240
ds_read_b128 v[72:75], v2 offset:17920
ds_read_b128 v[76:79], v2 offset:25600
ds_read_b128 v[80:83], v2 offset:33280
ds_read_b128 v[84:87], v2 offset:40960
ds_read_b128 v[88:91], v2 offset:48640
ds_read_b128 v[92:95], v2 offset:56320
v_mul_u32_u24 v11, 144, v0
v_add_u32 v11, s66, v11
v_lshrrev_b32 v12, 3, v0
v_mul_u32_u24 v12, 144, v12
v_and_b32 v13, 7, v0
v_lshl_add_u32 v12, v13, 4, v12
v_add_u32 v12, s66, v12
s_lshl_b32 s2, s47, 15
s_lshl_b32 s3, s42, 13
s_add_u32 s2, s2, s3
s_add_u32 s2, s2, 2097152
s_add_u32 s3, s2, 4096
v_lshlrev_b32 v13, 4, v0
s_waitcnt lgkmcnt(0)
v_perm_b32 v96, v68, v64, s56
v_perm_b32 v97, v76, v72, s56
v_perm_b32 v98, v84, v80, s56
v_perm_b32 v99, v92, v88, s56
ds_write_b128 v11, v[96:99] offset:0
v_perm_b32 v100, v68, v64, s57
v_perm_b32 v101, v76, v72, s57
v_perm_b32 v102, v84, v80, s57
v_perm_b32 v103, v92, v88, s57
ds_write_b128 v11, v[100:103] offset:16
v_perm_b32 v96, v69, v65, s56
v_perm_b32 v97, v77, v73, s56
v_perm_b32 v98, v85, v81, s56
v_perm_b32 v99, v93, v89, s56
ds_write_b128 v11, v[96:99] offset:32
v_perm_b32 v100, v69, v65, s57
v_perm_b32 v101, v77, v73, s57
v_perm_b32 v102, v85, v81, s57
v_perm_b32 v103, v93, v89, s57
ds_write_b128 v11, v[100:103] offset:48
v_perm_b32 v96, v70, v66, s56
v_perm_b32 v97, v78, v74, s56
v_perm_b32 v98, v86, v82, s56
v_perm_b32 v99, v94, v90, s56
ds_write_b128 v11, v[96:99] offset:64
v_perm_b32 v100, v70, v66, s57
v_perm_b32 v101, v78, v74, s57
v_perm_b32 v102, v86, v82, s57
v_perm_b32 v103, v94, v90, s57
ds_write_b128 v11, v[100:103] offset:80
v_perm_b32 v96, v71, v67, s56
v_perm_b32 v97, v79, v75, s56
v_perm_b32 v98, v87, v83, s56
v_perm_b32 v99, v95, v91, s56
ds_write_b128 v11, v[96:99] offset:96
v_perm_b32 v100, v71, v67, s57
v_perm_b32 v101, v79, v75, s57
v_perm_b32 v102, v87, v83, s57
v_perm_b32 v103, v95, v91, s57
ds_write_b128 v11, v[100:103] offset:112
s_waitcnt lgkmcnt(0)
ds_read_b128 v[64:67], v12 offset:0
ds_read_b128 v[68:71], v12 offset:1152
ds_read_b128 v[72:75], v12 offset:2304
ds_read_b128 v[76:79], v12 offset:3456
ds_read_b128 v[80:83], v12 offset:4608
ds_read_b128 v[84:87], v12 offset:5760
ds_read_b128 v[88:91], v12 offset:6912
ds_read_b128 v[92:95], v12 offset:8064
s_waitcnt lgkmcnt(7)
buffer_store_dwordx4 v[64:67], v13, s[8:11], s2 offen offset:0 sc1
s_waitcnt lgkmcnt(6)
buffer_store_dwordx4 v[68:71], v13, s[8:11], s2 offen offset:1024 sc1
s_waitcnt lgkmcnt(5)
buffer_store_dwordx4 v[72:75], v13, s[8:11], s2 offen offset:2048 sc1
s_waitcnt lgkmcnt(4)
buffer_store_dwordx4 v[76:79], v13, s[8:11], s2 offen offset:3072 sc1
s_waitcnt lgkmcnt(3)
buffer_store_dwordx4 v[80:83], v13, s[8:11], s3 offen offset:0 sc1
s_waitcnt lgkmcnt(2)
buffer_store_dwordx4 v[84:87], v13, s[8:11], s3 offen offset:1024 sc1
s_waitcnt lgkmcnt(1)
buffer_store_dwordx4 v[88:91], v13, s[8:11], s3 offen offset:2048 sc1
s_waitcnt lgkmcnt(0)
buffer_store_dwordx4 v[92:95], v13, s[8:11], s3 offen offset:3072 sc1
s_waitcnt vmcnt(0)
s_barrier
s_cmp_lg_u32 s42, 0
s_cbranch_scc1 ARR_4
v_mov_b32 v1, 196
v_mov_b32 v2, 1
s_mov_b64 exec, 1
global_atomic_add v1, v2, s[12:13] sc1
s_mov_b64 exec, -1
ARR_4:
s_branch O_ROLE
G_ROLE:
s_load_dwordx2 s[16:17], s[0:1], 112
s_mov_b32 s18, 1152
s_mov_b32 s19, 0x00020000
s_sub_u32 s2, s47, 72
s_lshl_b32 s2, s2, 2
s_add_u32 s2, s2, s42
s_lshl_b32 s14, s2, 7
s_add_u32 s14, s14, 4456448
s_mul_i32 s2, s2, 36864
s_add_u32 s3, s2, 18432
v_and_b32 v1, 15, v0
v_lshrrev_b32 v2, 4, v0
v_lshlrev_b32 v2, 4, v2
v_mul_u32_u24 v3, 1152, v1
v_add_u32 v3, v3, v2
v_lshlrev_b32 v1, 2, v1
s_waitcnt lgkmcnt(0)
buffer_load_dwordx4 v[16:19], v2, s[16:19], 0 offen offset:0
buffer_load_dwordx4 v[20:23], v3, s[32:35], s2 offen offset:0
buffer_load_dwordx4 v[24:27], v3, s[32:35], s3 offen offset:0
buffer_load_dwordx4 v[28:31], v2, s[16:19], 0 offen offset:64
buffer_load_dwordx4 v[32:35], v3, s[32:35], s2 offen offset:64
buffer_load_dwordx4 v[36:39], v3, s[32:35], s3 offen offset:64
buffer_load_dwordx4 v[40:43], v2, s[16:19], 0 offen offset:128
buffer_load_dwordx4 v[44:47], v3, s[32:35], s2 offen offset:128
buffer_load_dwordx4 v[48:51], v3, s[32:35], s3 offen offset:128
buffer_load_dwordx4 v[52:55], v2, s[16:19], 0 offen offset:192
buffer_load_dwordx4 v[56:59], v3, s[32:35], s2 offen offset:192
buffer_load_dwordx4 v[60:63], v3, s[32:35], s3 offen offset:192
buffer_load_dwordx4 v[64:67], v2, s[16:19], 0 offen offset:256
buffer_load_dwordx4 v[68:71], v3, s[32:35], s2 offen offset:256
buffer_load_dwordx4 v[72:75], v3, s[32:35], s3 offen offset:256
buffer_load_dwordx4 v[76:79], v2, s[16:19], 0 offen offset:320
buffer_load_dwordx4 v[80:83], v3, s[32:35], s2 offen offset:320
buffer_load_dwordx4 v[84:87], v3, s[32:35], s3 offen offset:320
buffer_load_dwordx4 v[88:91], v2, s[16:19], 0 offen offset:384
buffer_load_dwordx4 v[92:95], v3, s[32:35], s2 offen offset:384
buffer_load_dwordx4 v[96:99], v3, s[32:35], s3 offen offset:384
buffer_load_dwordx4 v[100:103], v2, s[16:19], 0 offen offset:448
buffer_load_dwordx4 v[104:107], v3, s[32:35], s2 offen offset:448
buffer_load_dwordx4 v[108:111], v3, s[32:35], s3 offen offset:448
buffer_load_dwordx4 v[112:115], v2, s[16:19], 0 offen offset:512
buffer_load_dwordx4 v[116:119], v3, s[32:35], s2 offen offset:512
buffer_load_dwordx4 v[120:123], v3, s[32:35], s3 offen offset:512
buffer_load_dwordx4 v[124:127], v2, s[16:19], 0 offen offset:576
buffer_load_dwordx4 v[128:131], v3, s[32:35], s2 offen offset:576
buffer_load_dwordx4 v[132:135], v3, s[32:35], s3 offen offset:576
buffer_load_dwordx4 v[136:139], v2, s[16:19], 0 offen offset:640
buffer_load_dwordx4 v[140:143], v3, s[32:35], s2 offen offset:640
buffer_load_dwordx4 v[144:147], v3, s[32:35], s3 offen offset:640
buffer_load_dwordx4 v[148:151], v2, s[16:19], 0 offen offset:704
buffer_load_dwordx4 v[152:155], v3, s[32:35], s2 offen offset:704
buffer_load_dwordx4 v[156:159], v3, s[32:35], s3 offen offset:704
buffer_load_dwordx4 v[160:163], v2, s[16:19], 0 offen offset:768
buffer_load_dwordx4 v[164:167], v3, s[32:35], s2 offen offset:768
buffer_load_dwordx4 v[168:171], v3, s[32:35], s3 offen offset:768
buffer_load_dwordx4 v[172:175], v2, s[16:19], 0 offen offset:832
buffer_load_dwordx4 v[176:179], v3, s[32:35], s2 offen offset:832
buffer_load_dwordx4 v[180:183], v3, s[32:35], s3 offen offset:832
buffer_load_dwordx4 v[184:187], v2, s[16:19], 0 offen offset:896
buffer_load_dwordx4 v[188:191], v3, s[32:35], s2 offen offset:896
buffer_load_dwordx4 v[192:195], v3, s[32:35], s3 offen offset:896
buffer_load_dwordx4 v[196:199], v2, s[16:19], 0 offen offset:960
buffer_load_dwordx4 v[200:203], v3, s[32:35], s2 offen offset:960
buffer_load_dwordx4 v[204:207], v3, s[32:35], s3 offen offset:960
buffer_load_dwordx4 v[208:211], v2, s[16:19], 0 offen offset:1024
buffer_load_dwordx4 v[212:215], v3, s[32:35], s2 offen offset:1024
buffer_load_dwordx4 v[216:219], v3, s[32:35], s3 offen offset:1024
buffer_load_dwordx4 v[220:223], v2, s[16:19], 0 offen offset:1088
buffer_load_dwordx4 v[224:227], v3, s[32:35], s2 offen offset:1088
buffer_load_dwordx4 v[228:231], v3, s[32:35], s3 offen offset:1088
s_waitcnt vmcnt(51)
v_mfma_f32_16x16x32_bf16 v[8:11], v[16:19], v[20:23], 0
v_mfma_f32_16x16x32_bf16 v[12:15], v[16:19], v[24:27], 0
s_waitcnt vmcnt(48)
v_mfma_f32_16x16x32_bf16 v[8:11], v[28:31], v[32:35], v[8:11]
v_mfma_f32_16x16x32_bf16 v[12:15], v[28:31], v[36:39], v[12:15]
s_waitcnt vmcnt(45)
v_mfma_f32_16x16x32_bf16 v[8:11], v[40:43], v[44:47], v[8:11]
v_mfma_f32_16x16x32_bf16 v[12:15], v[40:43], v[48:51], v[12:15]
s_waitcnt vmcnt(42)
v_mfma_f32_16x16x32_bf16 v[8:11], v[52:55], v[56:59], v[8:11]
v_mfma_f32_16x16x32_bf16 v[12:15], v[52:55], v[60:63], v[12:15]
s_waitcnt vmcnt(39)
v_mfma_f32_16x16x32_bf16 v[8:11], v[64:67], v[68:71], v[8:11]
v_mfma_f32_16x16x32_bf16 v[12:15], v[64:67], v[72:75], v[12:15]
s_waitcnt vmcnt(36)
v_mfma_f32_16x16x32_bf16 v[8:11], v[76:79], v[80:83], v[8:11]
v_mfma_f32_16x16x32_bf16 v[12:15], v[76:79], v[84:87], v[12:15]
s_waitcnt vmcnt(33)
v_mfma_f32_16x16x32_bf16 v[8:11], v[88:91], v[92:95], v[8:11]
v_mfma_f32_16x16x32_bf16 v[12:15], v[88:91], v[96:99], v[12:15]
s_waitcnt vmcnt(30)
v_mfma_f32_16x16x32_bf16 v[8:11], v[100:103], v[104:107], v[8:11]
v_mfma_f32_16x16x32_bf16 v[12:15], v[100:103], v[108:111], v[12:15]
s_waitcnt vmcnt(27)
v_mfma_f32_16x16x32_bf16 v[8:11], v[112:115], v[116:119], v[8:11]
v_mfma_f32_16x16x32_bf16 v[12:15], v[112:115], v[120:123], v[12:15]
s_waitcnt vmcnt(24)
v_mfma_f32_16x16x32_bf16 v[8:11], v[124:127], v[128:131], v[8:11]
v_mfma_f32_16x16x32_bf16 v[12:15], v[124:127], v[132:135], v[12:15]
s_waitcnt vmcnt(21)
v_mfma_f32_16x16x32_bf16 v[8:11], v[136:139], v[140:143], v[8:11]
v_mfma_f32_16x16x32_bf16 v[12:15], v[136:139], v[144:147], v[12:15]
s_waitcnt vmcnt(18)
v_mfma_f32_16x16x32_bf16 v[8:11], v[148:151], v[152:155], v[8:11]
v_mfma_f32_16x16x32_bf16 v[12:15], v[148:151], v[156:159], v[12:15]
s_waitcnt vmcnt(15)
v_mfma_f32_16x16x32_bf16 v[8:11], v[160:163], v[164:167], v[8:11]
v_mfma_f32_16x16x32_bf16 v[12:15], v[160:163], v[168:171], v[12:15]
s_waitcnt vmcnt(12)
v_mfma_f32_16x16x32_bf16 v[8:11], v[172:175], v[176:179], v[8:11]
v_mfma_f32_16x16x32_bf16 v[12:15], v[172:175], v[180:183], v[12:15]
s_waitcnt vmcnt(9)
v_mfma_f32_16x16x32_bf16 v[8:11], v[184:187], v[188:191], v[8:11]
v_mfma_f32_16x16x32_bf16 v[12:15], v[184:187], v[192:195], v[12:15]
s_waitcnt vmcnt(6)
v_mfma_f32_16x16x32_bf16 v[8:11], v[196:199], v[200:203], v[8:11]
v_mfma_f32_16x16x32_bf16 v[12:15], v[196:199], v[204:207], v[12:15]
s_waitcnt vmcnt(3)
v_mfma_f32_16x16x32_bf16 v[8:11], v[208:211], v[212:215], v[8:11]
v_mfma_f32_16x16x32_bf16 v[12:15], v[208:211], v[216:219], v[12:15]
s_waitcnt vmcnt(0)
v_mfma_f32_16x16x32_bf16 v[8:11], v[220:223], v[224:227], v[8:11]
v_mfma_f32_16x16x32_bf16 v[12:15], v[220:223], v[228:231], v[12:15]
s_mov_b64 exec, 0xffff
s_nop 2
v_mul_f32 v8, 0xbfb8aa3b, v8
v_exp_f32 v8, v8
s_nop 0
v_add_f32 v8, 1.0, v8
v_rcp_f32 v8, v8
s_nop 0
buffer_store_dword v8, v1, s[8:11], s14 offen offset:0 sc1
v_mul_f32 v12, 0xbfb8aa3b, v12
v_exp_f32 v12, v12
s_nop 0
v_add_f32 v12, 1.0, v12
v_rcp_f32 v12, v12
s_nop 0
buffer_store_dword v12, v1, s[8:11], s14 offen offset:64 sc1
s_mov_b64 exec, -1
s_waitcnt vmcnt(0)
s_barrier
s_cmp_lg_u32 s42, 0
s_cbranch_scc1 ARR_5
v_mov_b32 v1, 196
v_mov_b32 v2, 1
s_mov_b64 exec, 1
global_atomic_add v1, v2, s[12:13] sc1
s_mov_b64 exec, -1
ARR_5:
O_ROLE:
s_load_dwordx2 s[16:17], s[0:1], 120
s_mov_b32 s18, 2359296
s_mov_b32 s19, 0x00020000
s_mul_i32 s48, s47, 43
s_lshr_b32 s48, s48, 9
s_mul_i32 s2, s48, 12
s_sub_u32 s49, s47, s2
s_mul_i32 s50, s42, 36864
s_mul_i32 s2, s49, 96
s_mul_i32 s3, s42, 1179648
s_add_u32 s2, s2, s3
v_add_u32 v4, 0, v0
v_mul_u32_u24 v5, 171, v4
v_lshrrev_b32 v5, 10, v5
v_mul_u32_u24 v6, 1056, v5
v_lshl_add_u32 v6, v0, 4, v6
v_add_u32 v1, s2, v6
v_add_u32 v4, 64, v0
v_mul_u32_u24 v5, 171, v4
v_lshrrev_b32 v5, 10, v5
v_mul_u32_u24 v6, 1056, v5
v_lshl_add_u32 v6, v0, 4, v6
v_add_u32 v2, s2, v6
v_add_u32 v4, 128, v0
v_mul_u32_u24 v5, 171, v4
v_lshrrev_b32 v5, 10, v5
v_mul_u32_u24 v6, 1056, v5
v_lshl_add_u32 v6, v0, 4, v6
v_add_u32 v3, s2, v6
v_lshrrev_b32 v4, 2, v0
v_mul_u32_u24 v4, 96, v4
v_and_b32 v5, 3, v0
v_lshl_add_u32 v4, v5, 3, v4
v_add_u32 v7, s50, v4
s_add_u32 m0, s50, 0
s_mov_b32 s2, 0
buffer_load_dwordx4 v1, s[28:31], s2 offen offset:0 lds
buffer_load_dwordx4 v2, s[28:31], s2 offen offset:1024 lds
buffer_load_dwordx4 v3, s[28:31], s2 offen offset:2048 lds
s_add_u32 m0, s50, 3072
s_mov_b32 s2, 36864
buffer_load_dwordx4 v1, s[28:31], s2 offen offset:0 lds
buffer_load_dwordx4 v2, s[28:31], s2 offen offset:1024 lds
buffer_load_dwordx4 v3, s[28:31], s2 offen offset:2048 lds
s_add_u32 m0, s50, 6144
s_mov_b32 s2, 73728
buffer_load_dwordx4 v1, s[28:31], s2 offen offset:0 lds
buffer_load_dwordx4 v2, s[28:31], s2 offen offset:1024 lds
buffer_load_dwordx4 v3, s[28:31], s2 offen offset:2048 lds
s_add_u32 m0, s50, 9216
s_mov_b32 s2, 110592
buffer_load_dwordx4 v1, s[28:31], s2 offen offset:0 lds
buffer_load_dwordx4 v2, s[28:31], s2 offen offset:1024 lds
buffer_load_dwordx4 v3, s[28:31], s2 offen offset:2048 lds
s_add_u32 m0, s50, 12288
s_mov_b32 s2, 147456
buffer_load_dwordx4 v1, s[28:31], s2 offen offset:0 lds
buffer_load_dwordx4 v2, s[28:31], s2 offen offset:1024 lds
buffer_load_dwordx4 v3, s[28:31], s2 offen offset:2048 lds
s_add_u32 m0, s50, 15360
s_mov_b32 s2, 184320
buffer_load_dwordx4 v1, s[28:31], s2 offen offset:0 lds
buffer_load_dwordx4 v2, s[28:31], s2 offen offset:1024 lds
buffer_load_dwordx4 v3, s[28:31], s2 offen offset:2048 lds
s_add_u32 m0, s50, 18432
s_mov_b32 s2, 221184
buffer_load_dwordx4 v1, s[28:31], s2 offen offset:0 lds
buffer_load_dwordx4 v2, s[28:31], s2 offen offset:1024 lds
buffer_load_dwordx4 v3, s[28:31], s2 offen offset:2048 lds
s_add_u32 m0, s50, 21504
s_mov_b32 s2, 258048
buffer_load_dwordx4 v1, s[28:31], s2 offen offset:0 lds
buffer_load_dwordx4 v2, s[28:31], s2 offen offset:1024 lds
buffer_load_dwordx4 v3, s[28:31], s2 offen offset:2048 lds
s_add_u32 m0, s50, 24576
s_mov_b32 s2, 294912
buffer_load_dwordx4 v1, s[28:31], s2 offen offset:0 lds
buffer_load_dwordx4 v2, s[28:31], s2 offen offset:1024 lds
buffer_load_dwordx4 v3, s[28:31], s2 offen offset:2048 lds
s_add_u32 m0, s50, 27648
s_mov_b32 s2, 331776
buffer_load_dwordx4 v1, s[28:31], s2 offen offset:0 lds
buffer_load_dwordx4 v2, s[28:31], s2 offen offset:1024 lds
buffer_load_dwordx4 v3, s[28:31], s2 offen offset:2048 lds
s_add_u32 m0, s50, 30720
s_mov_b32 s2, 368640
buffer_load_dwordx4 v1, s[28:31], s2 offen offset:0 lds
buffer_load_dwordx4 v2, s[28:31], s2 offen offset:1024 lds
buffer_load_dwordx4 v3, s[28:31], s2 offen offset:2048 lds
s_add_u32 m0, s50, 33792
s_mov_b32 s2, 405504
buffer_load_dwordx4 v1, s[28:31], s2 offen offset:0 lds
buffer_load_dwordx4 v2, s[28:31], s2 offen offset:1024 lds
buffer_load_dwordx4 v3, s[28:31], s2 offen offset:2048 lds
s_waitcnt vmcnt(33)
ds_read_b64_tr_b16 v[128:129], v7 offset:0
ds_read_b64_tr_b16 v[130:131], v7 offset:1536
ds_read_b64_tr_b16 v[132:133], v7 offset:32
ds_read_b64_tr_b16 v[134:135], v7 offset:1568
ds_read_b64_tr_b16 v[136:137], v7 offset:64
ds_read_b64_tr_b16 v[138:139], v7 offset:1600
s_waitcnt lgkmcnt(0)
s_add_u32 m0, s50, 0
s_mov_b32 s2, 442368
buffer_load_dwordx4 v1, s[28:31], s2 offen offset:0 lds
buffer_load_dwordx4 v2, s[28:31], s2 offen offset:1024 lds
buffer_load_dwordx4 v3, s[28:31], s2 offen offset:2048 lds
s_waitcnt vmcnt(33)
ds_read_b64_tr_b16 v[140:141], v7 offset:3072
ds_read_b64_tr_b16 v[142:143], v7 offset:4608
ds_read_b64_tr_b16 v[144:145], v7 offset:3104
ds_read_b64_tr_b16 v[146:147], v7 offset:4640
ds_read_b64_tr_b16 v[148:149], v7 offset:3136
ds_read_b64_tr_b16 v[150:151], v7 offset:4672
s_waitcnt lgkmcnt(0)
s_add_u32 m0, s50, 3072
s_mov_b32 s2, 479232
buffer_load_dwordx4 v1, s[28:31], s2 offen offset:0 lds
buffer_load_dwordx4 v2, s[28:31], s2 offen offset:1024 lds
buffer_load_dwordx4 v3, s[28:31], s2 offen offset:2048 lds
s_waitcnt vmcnt(33)
ds_read_b64_tr_b16 v[152:153], v7 offset:6144
ds_read_b64_tr_b16 v[154:155], v7 offset:7680
ds_read_b64_tr_b16 v[156:157], v7 offset:6176
ds_read_b64_tr_b16 v[158:159], v7 offset:7712
ds_read_b64_tr_b16 v[160:161], v7 offset:6208
ds_read_b64_tr_b16 v[162:163], v7 offset:7744
s_waitcnt lgkmcnt(0)
s_add_u32 m0, s50, 6144
s_mov_b32 s2, 516096
buffer_load_dwordx4 v1, s[28:31], s2 offen offset:0 lds
buffer_load_dwordx4 v2, s[28:31], s2 offen offset:1024 lds
buffer_load_dwordx4 v3, s[28:31], s2 offen offset:2048 lds
s_waitcnt vmcnt(33)
ds_read_b64_tr_b16 v[164:165], v7 offset:9216
ds_read_b64_tr_b16 v[166:167], v7 offset:10752
ds_read_b64_tr_b16 v[168:169], v7 offset:9248
ds_read_b64_tr_b16 v[170:171], v7 offset:10784
ds_read_b64_tr_b16 v[172:173], v7 offset:9280
ds_read_b64_tr_b16 v[174:175], v7 offset:10816
s_waitcnt lgkmcnt(0)
s_add_u32 m0, s50, 9216
s_mov_b32 s2, 552960
buffer_load_dwordx4 v1, s[28:31], s2 offen offset:0 lds
buffer_load_dwordx4 v2, s[28:31], s2 offen offset:1024 lds
buffer_load_dwordx4 v3, s[28:31], s2 offen offset:2048 lds
s_waitcnt vmcnt(33)
ds_read_b64_tr_b16 v[176:177], v7 offset:12288
ds_read_b64_tr_b16 v[178:179], v7 offset:13824
ds_read_b64_tr_b16 v[180:181], v7 offset:12320
ds_read_b64_tr_b16 v[182:183], v7 offset:13856
ds_read_b64_tr_b16 v[184:185], v7 offset:12352
ds_read_b64_tr_b16 v[186:187], v7 offset:13888
s_waitcnt lgkmcnt(0)
s_add_u32 m0, s50, 12288
s_mov_b32 s2, 589824
buffer_load_dwordx4 v1, s[28:31], s2 offen offset:0 lds
buffer_load_dwordx4 v2, s[28:31], s2 offen offset:1024 lds
buffer_load_dwordx4 v3, s[28:31], s2 offen offset:2048 lds
s_waitcnt vmcnt(33)
ds_read_b64_tr_b16 v[188:189], v7 offset:15360
ds_read_b64_tr_b16 v[190:191], v7 offset:16896
ds_read_b64_tr_b16 v[192:193], v7 offset:15392
ds_read_b64_tr_b16 v[194:195], v7 offset:16928
ds_read_b64_tr_b16 v[196:197], v7 offset:15424
ds_read_b64_tr_b16 v[198:199], v7 offset:16960
s_waitcnt lgkmcnt(0)
s_add_u32 m0, s50, 15360
s_mov_b32 s2, 626688
buffer_load_dwordx4 v1, s[28:31], s2 offen offset:0 lds
buffer_load_dwordx4 v2, s[28:31], s2 offen offset:1024 lds
buffer_load_dwordx4 v3, s[28:31], s2 offen offset:2048 lds
s_waitcnt vmcnt(33)
ds_read_b64_tr_b16 v[200:201], v7 offset:18432
ds_read_b64_tr_b16 v[202:203], v7 offset:19968
ds_read_b64_tr_b16 v[204:205], v7 offset:18464
ds_read_b64_tr_b16 v[206:207], v7 offset:20000
ds_read_b64_tr_b16 v[208:209], v7 offset:18496
ds_read_b64_tr_b16 v[210:211], v7 offset:20032
s_waitcnt lgkmcnt(0)
s_add_u32 m0, s50, 18432
s_mov_b32 s2, 663552
buffer_load_dwordx4 v1, s[28:31], s2 offen offset:0 lds
buffer_load_dwordx4 v2, s[28:31], s2 offen offset:1024 lds
buffer_load_dwordx4 v3, s[28:31], s2 offen offset:2048 lds
s_waitcnt vmcnt(33)
ds_read_b64_tr_b16 v[212:213], v7 offset:21504
ds_read_b64_tr_b16 v[214:215], v7 offset:23040
ds_read_b64_tr_b16 v[216:217], v7 offset:21536
ds_read_b64_tr_b16 v[218:219], v7 offset:23072
ds_read_b64_tr_b16 v[220:221], v7 offset:21568
ds_read_b64_tr_b16 v[222:223], v7 offset:23104
s_waitcnt lgkmcnt(0)
s_add_u32 m0, s50, 21504
s_mov_b32 s2, 700416
buffer_load_dwordx4 v1, s[28:31], s2 offen offset:0 lds
buffer_load_dwordx4 v2, s[28:31], s2 offen offset:1024 lds
buffer_load_dwordx4 v3, s[28:31], s2 offen offset:2048 lds
s_waitcnt vmcnt(33)
ds_read_b64_tr_b16 v[224:225], v7 offset:24576
ds_read_b64_tr_b16 v[226:227], v7 offset:26112
ds_read_b64_tr_b16 v[228:229], v7 offset:24608
ds_read_b64_tr_b16 v[230:231], v7 offset:26144
ds_read_b64_tr_b16 v[232:233], v7 offset:24640
ds_read_b64_tr_b16 v[234:235], v7 offset:26176
s_waitcnt lgkmcnt(0)
s_add_u32 m0, s50, 24576
s_mov_b32 s2, 737280
buffer_load_dwordx4 v1, s[28:31], s2 offen offset:0 lds
buffer_load_dwordx4 v2, s[28:31], s2 offen offset:1024 lds
buffer_load_dwordx4 v3, s[28:31], s2 offen offset:2048 lds
s_waitcnt vmcnt(33)
ds_read_b64_tr_b16 v[236:237], v7 offset:27648
ds_read_b64_tr_b16 v[238:239], v7 offset:29184
ds_read_b64_tr_b16 v[240:241], v7 offset:27680
ds_read_b64_tr_b16 v[242:243], v7 offset:29216
ds_read_b64_tr_b16 v[244:245], v7 offset:27712
ds_read_b64_tr_b16 v[246:247], v7 offset:29248
s_waitcnt lgkmcnt(0)
s_add_u32 m0, s50, 27648
s_mov_b32 s2, 774144
buffer_load_dwordx4 v1, s[28:31], s2 offen offset:0 lds
buffer_load_dwordx4 v2, s[28:31], s2 offen offset:1024 lds
buffer_load_dwordx4 v3, s[28:31], s2 offen offset:2048 lds
s_waitcnt vmcnt(33)
ds_read_b64_tr_b16 v[248:249], v7 offset:30720
ds_read_b64_tr_b16 v[250:251], v7 offset:32256
ds_read_b64_tr_b16 v[252:253], v7 offset:30752
ds_read_b64_tr_b16 v[254:255], v7 offset:32288
ds_read_b64_tr_b16 a[0:1], v7 offset:30784
ds_read_b64_tr_b16 a[2:3], v7 offset:32320
s_waitcnt lgkmcnt(0)
s_add_u32 m0, s50, 30720
s_mov_b32 s2, 811008
buffer_load_dwordx4 v1, s[28:31], s2 offen offset:0 lds
buffer_load_dwordx4 v2, s[28:31], s2 offen offset:1024 lds
buffer_load_dwordx4 v3, s[28:31], s2 offen offset:2048 lds
s_waitcnt vmcnt(33)
ds_read_b64_tr_b16 a[4:5], v7 offset:33792
ds_read_b64_tr_b16 a[6:7], v7 offset:35328
ds_read_b64_tr_b16 a[8:9], v7 offset:33824
ds_read_b64_tr_b16 a[10:11], v7 offset:35360
ds_read_b64_tr_b16 a[12:13], v7 offset:33856
ds_read_b64_tr_b16 a[14:15], v7 offset:35392
s_waitcnt lgkmcnt(0)
s_add_u32 m0, s50, 33792
s_mov_b32 s2, 847872
buffer_load_dwordx4 v1, s[28:31], s2 offen offset:0 lds
buffer_load_dwordx4 v2, s[28:31], s2 offen offset:1024 lds
buffer_load_dwordx4 v3, s[28:31], s2 offen offset:2048 lds
s_waitcnt vmcnt(33)
ds_read_b64_tr_b16 a[16:17], v7 offset:0
ds_read_b64_tr_b16 a[18:19], v7 offset:1536
ds_read_b64_tr_b16 a[20:21], v7 offset:32
ds_read_b64_tr_b16 a[22:23], v7 offset:1568
ds_read_b64_tr_b16 a[24:25], v7 offset:64
ds_read_b64_tr_b16 a[26:27], v7 offset:1600
s_waitcnt lgkmcnt(0)
s_add_u32 m0, s50, 0
s_mov_b32 s2, 884736
buffer_load_dwordx4 v1, s[28:31], s2 offen offset:0 lds
buffer_load_dwordx4 v2, s[28:31], s2 offen offset:1024 lds
buffer_load_dwordx4 v3, s[28:31], s2 offen offset:2048 lds
s_waitcnt vmcnt(33)
ds_read_b64_tr_b16 a[28:29], v7 offset:3072
ds_read_b64_tr_b16 a[30:31], v7 offset:4608
ds_read_b64_tr_b16 a[32:33], v7 offset:3104
ds_read_b64_tr_b16 a[34:35], v7 offset:4640
ds_read_b64_tr_b16 a[36:37], v7 offset:3136
ds_read_b64_tr_b16 a[38:39], v7 offset:4672
s_waitcnt lgkmcnt(0)
s_add_u32 m0, s50, 3072
s_mov_b32 s2, 921600
buffer_load_dwordx4 v1, s[28:31], s2 offen offset:0 lds
buffer_load_dwordx4 v2, s[28:31], s2 offen offset:1024 lds
buffer_load_dwordx4 v3, s[28:31], s2 offen offset:2048 lds
s_waitcnt vmcnt(33)
ds_read_b64_tr_b16 a[40:41], v7 offset:6144
ds_read_b64_tr_b16 a[42:43], v7 offset:7680
ds_read_b64_tr_b16 a[44:45], v7 offset:6176
ds_read_b64_tr_b16 a[46:47], v7 offset:7712
ds_read_b64_tr_b16 a[48:49], v7 offset:6208
ds_read_b64_tr_b16 a[50:51], v7 offset:7744
s_waitcnt lgkmcnt(0)
s_add_u32 m0, s50, 6144
s_mov_b32 s2, 958464
buffer_load_dwordx4 v1, s[28:31], s2 offen offset:0 lds
buffer_load_dwordx4 v2, s[28:31], s2 offen offset:1024 lds
buffer_load_dwordx4 v3, s[28:31], s2 offen offset:2048 lds
s_waitcnt vmcnt(33)
ds_read_b64_tr_b16 a[52:53], v7 offset:9216
ds_read_b64_tr_b16 a[54:55], v7 offset:10752
ds_read_b64_tr_b16 a[56:57], v7 offset:9248
ds_read_b64_tr_b16 a[58:59], v7 offset:10784
ds_read_b64_tr_b16 a[60:61], v7 offset:9280
ds_read_b64_tr_b16 a[62:63], v7 offset:10816
s_waitcnt lgkmcnt(0)
s_add_u32 m0, s50, 9216
s_mov_b32 s2, 995328
buffer_load_dwordx4 v1, s[28:31], s2 offen offset:0 lds
buffer_load_dwordx4 v2, s[28:31], s2 offen offset:1024 lds
buffer_load_dwordx4 v3, s[28:31], s2 offen offset:2048 lds
s_waitcnt vmcnt(33)
ds_read_b64_tr_b16 a[64:65], v7 offset:12288
ds_read_b64_tr_b16 a[66:67], v7 offset:13824
ds_read_b64_tr_b16 a[68:69], v7 offset:12320
ds_read_b64_tr_b16 a[70:71], v7 offset:13856
ds_read_b64_tr_b16 a[72:73], v7 offset:12352
ds_read_b64_tr_b16 a[74:75], v7 offset:13888
s_waitcnt lgkmcnt(0)
s_add_u32 m0, s50, 12288
s_mov_b32 s2, 1032192
buffer_load_dwordx4 v1, s[28:31], s2 offen offset:0 lds
buffer_load_dwordx4 v2, s[28:31], s2 offen offset:1024 lds
buffer_load_dwordx4 v3, s[28:31], s2 offen offset:2048 lds
s_waitcnt vmcnt(33)
ds_read_b64_tr_b16 a[76:77], v7 offset:15360
ds_read_b64_tr_b16 a[78:79], v7 offset:16896
ds_read_b64_tr_b16 a[80:81], v7 offset:15392
ds_read_b64_tr_b16 a[82:83], v7 offset:16928
ds_read_b64_tr_b16 a[84:85], v7 offset:15424
ds_read_b64_tr_b16 a[86:87], v7 offset:16960
s_waitcnt lgkmcnt(0)
s_add_u32 m0, s50, 15360
s_mov_b32 s2, 1069056
buffer_load_dwordx4 v1, s[28:31], s2 offen offset:0 lds
buffer_load_dwordx4 v2, s[28:31], s2 offen offset:1024 lds
buffer_load_dwordx4 v3, s[28:31], s2 offen offset:2048 lds
s_waitcnt vmcnt(33)
ds_read_b64_tr_b16 a[88:89], v7 offset:18432
ds_read_b64_tr_b16 a[90:91], v7 offset:19968
ds_read_b64_tr_b16 a[92:93], v7 offset:18464
ds_read_b64_tr_b16 a[94:95], v7 offset:20000
ds_read_b64_tr_b16 a[96:97], v7 offset:18496
ds_read_b64_tr_b16 a[98:99], v7 offset:20032
s_waitcnt lgkmcnt(0)
s_add_u32 m0, s50, 18432
s_mov_b32 s2, 1105920
buffer_load_dwordx4 v1, s[28:31], s2 offen offset:0 lds
buffer_load_dwordx4 v2, s[28:31], s2 offen offset:1024 lds
buffer_load_dwordx4 v3, s[28:31], s2 offen offset:2048 lds
s_waitcnt vmcnt(33)
ds_read_b64_tr_b16 a[100:101], v7 offset:21504
ds_read_b64_tr_b16 a[102:103], v7 offset:23040
ds_read_b64_tr_b16 a[104:105], v7 offset:21536
ds_read_b64_tr_b16 a[106:107], v7 offset:23072
ds_read_b64_tr_b16 a[108:109], v7 offset:21568
ds_read_b64_tr_b16 a[110:111], v7 offset:23104
s_waitcnt lgkmcnt(0)
s_add_u32 m0, s50, 21504
s_mov_b32 s2, 1142784
buffer_load_dwordx4 v1, s[28:31], s2 offen offset:0 lds
buffer_load_dwordx4 v2, s[28:31], s2 offen offset:1024 lds
buffer_load_dwordx4 v3, s[28:31], s2 offen offset:2048 lds
s_waitcnt vmcnt(33)
ds_read_b64_tr_b16 a[112:113], v7 offset:24576
ds_read_b64_tr_b16 a[114:115], v7 offset:26112
ds_read_b64_tr_b16 a[116:117], v7 offset:24608
ds_read_b64_tr_b16 a[118:119], v7 offset:26144
ds_read_b64_tr_b16 a[120:121], v7 offset:24640
ds_read_b64_tr_b16 a[122:123], v7 offset:26176
s_waitcnt vmcnt(30)
ds_read_b64_tr_b16 a[124:125], v7 offset:27648
ds_read_b64_tr_b16 a[126:127], v7 offset:29184
ds_read_b64_tr_b16 a[128:129], v7 offset:27680
ds_read_b64_tr_b16 a[130:131], v7 offset:29216
ds_read_b64_tr_b16 a[132:133], v7 offset:27712
ds_read_b64_tr_b16 a[134:135], v7 offset:29248
s_waitcnt vmcnt(27)
ds_read_b64_tr_b16 a[136:137], v7 offset:30720
ds_read_b64_tr_b16 a[138:139], v7 offset:32256
ds_read_b64_tr_b16 a[140:141], v7 offset:30752
ds_read_b64_tr_b16 a[142:143], v7 offset:32288
ds_read_b64_tr_b16 a[144:145], v7 offset:30784
ds_read_b64_tr_b16 a[146:147], v7 offset:32320
s_waitcnt vmcnt(24)
ds_read_b64_tr_b16 a[148:149], v7 offset:33792
ds_read_b64_tr_b16 a[150:151], v7 offset:35328
ds_read_b64_tr_b16 a[152:153], v7 offset:33824
ds_read_b64_tr_b16 a[154:155], v7 offset:35360
ds_read_b64_tr_b16 a[156:157], v7 offset:33856
ds_read_b64_tr_b16 a[158:159], v7 offset:35392
s_waitcnt vmcnt(21)
ds_read_b64_tr_b16 a[160:161], v7 offset:0
ds_read_b64_tr_b16 a[162:163], v7 offset:1536
ds_read_b64_tr_b16 a[164:165], v7 offset:32
ds_read_b64_tr_b16 a[166:167], v7 offset:1568
ds_read_b64_tr_b16 a[168:169], v7 offset:64
ds_read_b64_tr_b16 a[170:171], v7 offset:1600
s_waitcnt vmcnt(18)
ds_read_b64_tr_b16 a[172:173], v7 offset:3072
ds_read_b64_tr_b16 a[174:175], v7 offset:4608
ds_read_b64_tr_b16 a[176:177], v7 offset:3104
ds_read_b64_tr_b16 a[178:179], v7 offset:4640
ds_read_b64_tr_b16 a[180:181], v7 offset:3136
ds_read_b64_tr_b16 a[182:183], v7 offset:4672
s_waitcnt vmcnt(15)
ds_read_b64_tr_b16 a[184:185], v7 offset:6144
ds_read_b64_tr_b16 a[186:187], v7 offset:7680
ds_read_b64_tr_b16 a[188:189], v7 offset:6176
ds_read_b64_tr_b16 a[190:191], v7 offset:7712
ds_read_b64_tr_b16 a[192:193], v7 offset:6208
ds_read_b64_tr_b16 a[194:195], v7 offset:7744
s_waitcnt vmcnt(12)
ds_read_b64_tr_b16 a[196:197], v7 offset:9216
ds_read_b64_tr_b16 a[198:199], v7 offset:10752
ds_read_b64_tr_b16 a[200:201], v7 offset:9248
ds_read_b64_tr_b16 a[202:203], v7 offset:10784
ds_read_b64_tr_b16 a[204:205], v7 offset:9280
ds_read_b64_tr_b16 a[206:207], v7 offset:10816
s_waitcnt vmcnt(9)
ds_read_b64_tr_b16 a[208:209], v7 offset:12288
ds_read_b64_tr_b16 a[210:211], v7 offset:13824
ds_read_b64_tr_b16 a[212:213], v7 offset:12320
ds_read_b64_tr_b16 a[214:215], v7 offset:13856
ds_read_b64_tr_b16 a[216:217], v7 offset:12352
ds_read_b64_tr_b16 a[218:219], v7 offset:13888
s_waitcnt vmcnt(6)
ds_read_b64_tr_b16 a[220:221], v7 offset:15360
ds_read_b64_tr_b16 a[222:223], v7 offset:16896
ds_read_b64_tr_b16 a[224:225], v7 offset:15392
ds_read_b64_tr_b16 a[226:227], v7 offset:16928
ds_read_b64_tr_b16 a[228:229], v7 offset:15424
ds_read_b64_tr_b16 a[230:231], v7 offset:16960
s_waitcnt vmcnt(3)
ds_read_b64_tr_b16 a[232:233], v7 offset:18432
ds_read_b64_tr_b16 a[234:235], v7 offset:19968
ds_read_b64_tr_b16 a[236:237], v7 offset:18464
ds_read_b64_tr_b16 a[238:239], v7 offset:20000
ds_read_b64_tr_b16 a[240:241], v7 offset:18496
ds_read_b64_tr_b16 a[242:243], v7 offset:20032
s_waitcnt vmcnt(0)
ds_read_b64_tr_b16 a[244:245], v7 offset:21504
ds_read_b64_tr_b16 a[246:247], v7 offset:23040
ds_read_b64_tr_b16 a[248:249], v7 offset:21536
ds_read_b64_tr_b16 a[250:251], v7 offset:23072
ds_read_b64_tr_b16 a[252:253], v7 offset:21568
ds_read_b64_tr_b16 a[254:255], v7 offset:23104
s_waitcnt lgkmcnt(0)
s_lshr_b32 s2, s48, 1
s_lshl_b32 s2, s2, 7
s_lshl_b32 s3, s42, 5
s_add_u32 s2, s2, s3
s_add_u32 s2, s2, 4096
v_and_b32 v8, 7, v0
v_lshl_add_u32 v2, v8, 2, s2
v_lshlrev_b32 v1, 4, v0
s_lshl_b32 s51, s48, 17
s_lshl_b32 s3, s42, 15
s_add_u32 s51, s51, s3
s_add_u32 s51, s51, 50331648
s_lshl_b32 s53, s48, 4
s_mov_b32 s52, 0
v_and_b32 v8, 15, v0
v_lshrrev_b32 v9, 4, v0
v_lshlrev_b32 v4, 2, v8
v_add_u32 v4, 4456448, v4
s_min_u32 s14, s42, 2
s_mul_i32 s2, s49, 3
s_add_u32 s2, s2, s14
s_lshl_b32 s3, s2, 16
s_add_u32 s3, s3, 2097152
s_lshl_b32 s2, s2, 5
v_lshrrev_b32 v10, 1, v9
v_lshlrev_b32 v10, 15, v10
v_lshl_add_u32 v10, v8, 4, v10
v_and_b32 v11, 1, v9
v_lshl_add_u32 v10, v11, 3, v10
v_add_u32 v3, s3, v10
v_mul_u32_u24 v10, 1152, v8
v_lshl_add_u32 v10, v9, 3, v10
v_add_u32 v5, s2, v10
s_lshl_b32 s2, s42, 10
v_add_u32 v6, s2, v1
s_lshl_b32 s2, s14, 12
v_add_u32 v7, s2, v1
v_mov_b32 v8, 192
WD_6:
s_sub_u32 s45, s45, 1
s_cbranch_scc1 END
global_load_dword v9, v8, s[12:13] sc1
s_waitcnt vmcnt(0)
v_readfirstlane_b32 s2, v9
s_cmp_lt_u32 s2, 1
s_cbranch_scc1 WD_6
v_mov_b32 v8, 196
WD_7:
s_sub_u32 s45, s45, 1
s_cbranch_scc1 END
global_load_dword v9, v8, s[12:13] sc1
s_waitcnt vmcnt(0)
v_readfirstlane_b32 s2, v9
s_cmp_lt_u32 s2, 88
s_cbranch_scc1 WD_7
s_barrier
s_nop 1
O_LOOP:
s_lshl_b32 s2, s53, 4
s_lshl_b32 s3, s53, 2
buffer_load_dwordx2 v[10:11], v3, s[8:11], s2 offen sc1
buffer_load_dword v12, v4, s[8:11], s3 offen sc1
O_W:
s_sub_u32 s45, s45, 1
s_cbranch_scc1 END
buffer_load_dword v8, v2, s[8:11], 0 offen sc1
s_waitcnt vmcnt(0)
v_cmp_ge_u32 vcc, s52, v8
s_cbranch_vccnz O_W
s_add_u32 s2, s51, 0
buffer_load_dwordx4 v[32:35], v1, s[8:11], s2 offen offset:0 sc1
buffer_load_dwordx4 v[36:39], v1, s[8:11], s2 offen offset:1024 sc1
buffer_load_dwordx4 v[40:43], v1, s[8:11], s2 offen offset:2048 sc1
buffer_load_dwordx4 v[44:47], v1, s[8:11], s2 offen offset:3072 sc1
s_add_u32 s2, s51, 4096
buffer_load_dwordx4 v[48:51], v1, s[8:11], s2 offen offset:0 sc1
buffer_load_dwordx4 v[52:55], v1, s[8:11], s2 offen offset:1024 sc1
buffer_load_dwordx4 v[56:59], v1, s[8:11], s2 offen offset:2048 sc1
buffer_load_dwordx4 v[60:63], v1, s[8:11], s2 offen offset:3072 sc1
s_add_u32 s2, s51, 8192
buffer_load_dwordx4 v[64:67], v1, s[8:11], s2 offen offset:0 sc1
buffer_load_dwordx4 v[68:71], v1, s[8:11], s2 offen offset:1024 sc1
buffer_load_dwordx4 v[72:75], v1, s[8:11], s2 offen offset:2048 sc1
buffer_load_dwordx4 v[76:79], v1, s[8:11], s2 offen offset:3072 sc1
s_add_u32 s2, s51, 12288
buffer_load_dwordx4 v[80:83], v1, s[8:11], s2 offen offset:0 sc1
buffer_load_dwordx4 v[84:87], v1, s[8:11], s2 offen offset:1024 sc1
buffer_load_dwordx4 v[88:91], v1, s[8:11], s2 offen offset:2048 sc1
buffer_load_dwordx4 v[92:95], v1, s[8:11], s2 offen offset:3072 sc1
s_add_u32 s2, s51, 16384
buffer_load_dwordx4 v[96:99], v1, s[8:11], s2 offen offset:0 sc1
buffer_load_dwordx4 v[100:103], v1, s[8:11], s2 offen offset:1024 sc1
buffer_load_dwordx4 v[104:107], v1, s[8:11], s2 offen offset:2048 sc1
buffer_load_dwordx4 v[108:111], v1, s[8:11], s2 offen offset:3072 sc1
s_add_u32 s2, s51, 20480
buffer_load_dwordx4 v[112:115], v1, s[8:11], s2 offen offset:0 sc1
buffer_load_dwordx4 v[116:119], v1, s[8:11], s2 offen offset:1024 sc1
buffer_load_dwordx4 v[120:123], v1, s[8:11], s2 offen offset:2048 sc1
buffer_load_dwordx4 v[124:127], v1, s[8:11], s2 offen offset:3072 sc1
s_waitcnt vmcnt(23)
v_mfma_f32_16x16x32_bf16 v[16:19], v[128:131], v[32:35], 0
v_mfma_f32_16x16x32_bf16 v[20:23], v[132:135], v[32:35], 0
v_mfma_f32_16x16x32_bf16 v[24:27], v[136:139], v[32:35], 0
s_waitcnt vmcnt(22)
v_mfma_f32_16x16x32_bf16 v[16:19], v[140:143], v[36:39], v[16:19]
s_add_u32 s2, s51, 24576
buffer_load_dwordx4 v[32:35], v1, s[8:11], s2 offen offset:0 sc1
v_mfma_f32_16x16x32_bf16 v[20:23], v[144:147], v[36:39], v[20:23]
v_mfma_f32_16x16x32_bf16 v[24:27], v[148:151], v[36:39], v[24:27]
s_waitcnt vmcnt(22)
v_mfma_f32_16x16x32_bf16 v[16:19], v[152:155], v[40:43], v[16:19]
buffer_load_dwordx4 v[36:39], v1, s[8:11], s2 offen offset:1024 sc1
v_mfma_f32_16x16x32_bf16 v[20:23], v[156:159], v[40:43], v[20:23]
v_mfma_f32_16x16x32_bf16 v[24:27], v[160:163], v[40:43], v[24:27]
s_waitcnt vmcnt(22)
v_mfma_f32_16x16x32_bf16 v[16:19], v[164:167], v[44:47], v[16:19]
buffer_load_dwordx4 v[40:43], v1, s[8:11], s2 offen offset:2048 sc1
v_mfma_f32_16x16x32_bf16 v[20:23], v[168:171], v[44:47], v[20:23]
v_mfma_f32_16x16x32_bf16 v[24:27], v[172:175], v[44:47], v[24:27]
s_waitcnt vmcnt(22)
v_mfma_f32_16x16x32_bf16 v[16:19], v[176:179], v[48:51], v[16:19]
buffer_load_dwordx4 v[44:47], v1, s[8:11], s2 offen offset:3072 sc1
v_mfma_f32_16x16x32_bf16 v[20:23], v[180:183], v[48:51], v[20:23]
v_mfma_f32_16x16x32_bf16 v[24:27], v[184:187], v[48:51], v[24:27]
s_waitcnt vmcnt(22)
v_mfma_f32_16x16x32_bf16 v[16:19], v[188:191], v[52:55], v[16:19]
s_add_u32 s2, s51, 28672
buffer_load_dwordx4 v[48:51], v1, s[8:11], s2 offen offset:0 sc1
v_mfma_f32_16x16x32_bf16 v[20:23], v[192:195], v[52:55], v[20:23]
v_mfma_f32_16x16x32_bf16 v[24:27], v[196:199], v[52:55], v[24:27]
s_waitcnt vmcnt(22)
v_mfma_f32_16x16x32_bf16 v[16:19], v[200:203], v[56:59], v[16:19]
buffer_load_dwordx4 v[52:55], v1, s[8:11], s2 offen offset:1024 sc1
v_mfma_f32_16x16x32_bf16 v[20:23], v[204:207], v[56:59], v[20:23]
v_mfma_f32_16x16x32_bf16 v[24:27], v[208:211], v[56:59], v[24:27]
s_waitcnt vmcnt(22)
v_mfma_f32_16x16x32_bf16 v[16:19], v[212:215], v[60:63], v[16:19]
buffer_load_dwordx4 v[56:59], v1, s[8:11], s2 offen offset:2048 sc1
v_mfma_f32_16x16x32_bf16 v[20:23], v[216:219], v[60:63], v[20:23]
v_mfma_f32_16x16x32_bf16 v[24:27], v[220:223], v[60:63], v[24:27]
s_waitcnt vmcnt(22)
v_mfma_f32_16x16x32_bf16 v[16:19], v[224:227], v[64:67], v[16:19]
buffer_load_dwordx4 v[60:63], v1, s[8:11], s2 offen offset:3072 sc1
v_mfma_f32_16x16x32_bf16 v[20:23], v[228:231], v[64:67], v[20:23]
v_mfma_f32_16x16x32_bf16 v[24:27], v[232:235], v[64:67], v[24:27]
s_waitcnt vmcnt(22)
v_mfma_f32_16x16x32_bf16 v[16:19], v[236:239], v[68:71], v[16:19]
v_mfma_f32_16x16x32_bf16 v[20:23], v[240:243], v[68:71], v[20:23]
v_mfma_f32_16x16x32_bf16 v[24:27], v[244:247], v[68:71], v[24:27]
s_waitcnt vmcnt(21)
v_mfma_f32_16x16x32_bf16 v[16:19], v[248:251], v[72:75], v[16:19]
v_mfma_f32_16x16x32_bf16 v[20:23], v[252:255], v[72:75], v[20:23]
v_mfma_f32_16x16x32_bf16 v[24:27], a[0:3], v[72:75], v[24:27]
s_waitcnt vmcnt(20)
v_mfma_f32_16x16x32_bf16 v[16:19], a[4:7], v[76:79], v[16:19]
v_mfma_f32_16x16x32_bf16 v[20:23], a[8:11], v[76:79], v[20:23]
v_mfma_f32_16x16x32_bf16 v[24:27], a[12:15], v[76:79], v[24:27]
s_waitcnt vmcnt(19)
v_mfma_f32_16x16x32_bf16 v[16:19], a[16:19], v[80:83], v[16:19]
v_mfma_f32_16x16x32_bf16 v[20:23], a[20:23], v[80:83], v[20:23]
v_mfma_f32_16x16x32_bf16 v[24:27], a[24:27], v[80:83], v[24:27]
s_waitcnt vmcnt(18)
v_mfma_f32_16x16x32_bf16 v[16:19], a[28:31], v[84:87], v[16:19]
v_mfma_f32_16x16x32_bf16 v[20:23], a[32:35], v[84:87], v[20:23]
v_mfma_f32_16x16x32_bf16 v[24:27], a[36:39], v[84:87], v[24:27]
s_waitcnt vmcnt(17)
v_mfma_f32_16x16x32_bf16 v[16:19], a[40:43], v[88:91], v[16:19]
v_mfma_f32_16x16x32_bf16 v[20:23], a[44:47], v[88:91], v[20:23]
v_mfma_f32_16x16x32_bf16 v[24:27], a[48:51], v[88:91], v[24:27]
s_waitcnt vmcnt(16)
v_mfma_f32_16x16x32_bf16 v[16:19], a[52:55], v[92:95], v[16:19]
v_mfma_f32_16x16x32_bf16 v[20:23], a[56:59], v[92:95], v[20:23]
v_mfma_f32_16x16x32_bf16 v[24:27], a[60:63], v[92:95], v[24:27]
s_waitcnt vmcnt(15)
v_mfma_f32_16x16x32_bf16 v[16:19], a[64:67], v[96:99], v[16:19]
v_mfma_f32_16x16x32_bf16 v[20:23], a[68:71], v[96:99], v[20:23]
v_mfma_f32_16x16x32_bf16 v[24:27], a[72:75], v[96:99], v[24:27]
s_waitcnt vmcnt(14)
v_mfma_f32_16x16x32_bf16 v[16:19], a[76:79], v[100:103], v[16:19]
v_mfma_f32_16x16x32_bf16 v[20:23], a[80:83], v[100:103], v[20:23]
v_mfma_f32_16x16x32_bf16 v[24:27], a[84:87], v[100:103], v[24:27]
s_waitcnt vmcnt(13)
v_mfma_f32_16x16x32_bf16 v[16:19], a[88:91], v[104:107], v[16:19]
v_mfma_f32_16x16x32_bf16 v[20:23], a[92:95], v[104:107], v[20:23]
v_mfma_f32_16x16x32_bf16 v[24:27], a[96:99], v[104:107], v[24:27]
s_waitcnt vmcnt(12)
v_mfma_f32_16x16x32_bf16 v[16:19], a[100:103], v[108:111], v[16:19]
v_mfma_f32_16x16x32_bf16 v[20:23], a[104:107], v[108:111], v[20:23]
v_mfma_f32_16x16x32_bf16 v[24:27], a[108:111], v[108:111], v[24:27]
s_waitcnt vmcnt(11)
v_mfma_f32_16x16x32_bf16 v[16:19], a[112:115], v[112:115], v[16:19]
v_mfma_f32_16x16x32_bf16 v[20:23], a[116:119], v[112:115], v[20:23]
v_mfma_f32_16x16x32_bf16 v[24:27], a[120:123], v[112:115], v[24:27]
s_waitcnt vmcnt(10)
v_mfma_f32_16x16x32_bf16 v[16:19], a[124:127], v[116:119], v[16:19]
v_mfma_f32_16x16x32_bf16 v[20:23], a[128:131], v[116:119], v[20:23]
v_mfma_f32_16x16x32_bf16 v[24:27], a[132:135], v[116:119], v[24:27]
s_waitcnt vmcnt(9)
v_mfma_f32_16x16x32_bf16 v[16:19], a[136:139], v[120:123], v[16:19]
v_mfma_f32_16x16x32_bf16 v[20:23], a[140:143], v[120:123], v[20:23]
v_mfma_f32_16x16x32_bf16 v[24:27], a[144:147], v[120:123], v[24:27]
s_waitcnt vmcnt(8)
v_mfma_f32_16x16x32_bf16 v[16:19], a[148:151], v[124:127], v[16:19]
v_mfma_f32_16x16x32_bf16 v[20:23], a[152:155], v[124:127], v[20:23]
v_mfma_f32_16x16x32_bf16 v[24:27], a[156:159], v[124:127], v[24:27]
s_waitcnt vmcnt(7)
v_mfma_f32_16x16x32_bf16 v[16:19], a[160:163], v[32:35], v[16:19]
v_mfma_f32_16x16x32_bf16 v[20:23], a[164:167], v[32:35], v[20:23]
v_mfma_f32_16x16x32_bf16 v[24:27], a[168:171], v[32:35], v[24:27]
s_waitcnt vmcnt(6)
v_mfma_f32_16x16x32_bf16 v[16:19], a[172:175], v[36:39], v[16:19]
v_mfma_f32_16x16x32_bf16 v[20:23], a[176:179], v[36:39], v[20:23]
v_mfma_f32_16x16x32_bf16 v[24:27], a[180:183], v[36:39], v[24:27]
s_waitcnt vmcnt(5)
v_mfma_f32_16x16x32_bf16 v[16:19], a[184:187], v[40:43], v[16:19]
v_mfma_f32_16x16x32_bf16 v[20:23], a[188:191], v[40:43], v[20:23]
v_mfma_f32_16x16x32_bf16 v[24:27], a[192:195], v[40:43], v[24:27]
s_waitcnt vmcnt(4)
v_mfma_f32_16x16x32_bf16 v[16:19], a[196:199], v[44:47], v[16:19]
v_mfma_f32_16x16x32_bf16 v[20:23], a[200:203], v[44:47], v[20:23]
v_mfma_f32_16x16x32_bf16 v[24:27], a[204:207], v[44:47], v[24:27]
s_waitcnt vmcnt(3)
v_mfma_f32_16x16x32_bf16 v[16:19], a[208:211], v[48:51], v[16:19]
v_mfma_f32_16x16x32_bf16 v[20:23], a[212:215], v[48:51], v[20:23]
v_mfma_f32_16x16x32_bf16 v[24:27], a[216:219], v[48:51], v[24:27]
s_waitcnt vmcnt(2)
v_mfma_f32_16x16x32_bf16 v[16:19], a[220:223], v[52:55], v[16:19]
v_mfma_f32_16x16x32_bf16 v[20:23], a[224:227], v[52:55], v[20:23]
v_mfma_f32_16x16x32_bf16 v[24:27], a[228:231], v[52:55], v[24:27]
s_waitcnt vmcnt(1)
v_mfma_f32_16x16x32_bf16 v[16:19], a[232:235], v[56:59], v[16:19]
v_mfma_f32_16x16x32_bf16 v[20:23], a[236:239], v[56:59], v[20:23]
v_mfma_f32_16x16x32_bf16 v[24:27], a[240:243], v[56:59], v[24:27]
s_waitcnt vmcnt(0)
v_mfma_f32_16x16x32_bf16 v[16:19], a[244:247], v[60:63], v[16:19]
v_mfma_f32_16x16x32_bf16 v[20:23], a[248:251], v[60:63], v[20:23]
v_mfma_f32_16x16x32_bf16 v[24:27], a[252:255], v[60:63], v[24:27]
s_add_u32 s51, s51, 0x100000
s_mul_i32 s2, s53, 1152
s_add_u32 s53, s53, 128
s_add_u32 s52, s52, 1
ds_write_b128 v6, v[16:19] offset:0
ds_write_b128 v6, v[20:23] offset:4096
s_nop 1
ds_write_b128 v6, v[24:27] offset:8192
v_xor_b32 v6, 0x4000, v6
s_waitcnt lgkmcnt(0)
s_barrier
s_cmp_eq_u32 s42, 3
s_cbranch_scc1 O_NX
ds_read_b128 v[32:35], v7 offset:0
ds_read_b128 v[36:39], v7 offset:1024
ds_read_b128 v[40:43], v7 offset:2048
ds_read_b128 v[44:47], v7 offset:3072
v_xor_b32 v7, 0x4000, v7
v_sub_f32 v13, 1.0, v12
v_lshlrev_b32 v16, 16, v10
v_and_b32 v17, 0xffff0000, v10
v_lshlrev_b32 v18, 16, v11
v_and_b32 v19, 0xffff0000, v11
v_mul_f32 v16, v13, v16
v_mul_f32 v17, v13, v17
v_mul_f32 v18, v13, v18
v_mul_f32 v19, v13, v19
s_waitcnt lgkmcnt(0)
v_add_f32 v32, v32, v36
v_add_f32 v40, v40, v44
v_add_f32 v32, v32, v40
v_fmac_f32 v16, v12, v32
v_add_f32 v33, v33, v37
v_add_f32 v41, v41, v45
v_add_f32 v33, v33, v41
v_fmac_f32 v17, v12, v33
v_add_f32 v34, v34, v38
v_add_f32 v42, v42, v46
v_add_f32 v34, v34, v42
v_fmac_f32 v18, v12, v34
v_add_f32 v35, v35, v39
v_add_f32 v43, v43, v47
v_add_f32 v35, v35, v43
v_fmac_f32 v19, v12, v35
v_cvt_pk_bf16_f32 v14, v16, v17
v_cvt_pk_bf16_f32 v15, v18, v19
buffer_store_dwordx2 v[14:15], v5, s[16:19], s2 offen
O_NX:
s_cmp_lt_u32 s52, 16
s_nop 0
s_cbranch_scc1 O_LOOP
s_branch END
s_endpgm
.section .rodata,"a"
.p2align 6
.amdhsa_kernel gated_mix__memory_aug_recurrent_mem_tr__ssm_conv_s4d__prompt_kernel
  .amdhsa_next_free_vgpr 512
  .amdhsa_next_free_sgpr 102
  .amdhsa_accum_offset 256
  .amdhsa_group_segment_fixed_size 0
  .amdhsa_kernarg_size 144
  .amdhsa_user_sgpr_count 2
  .amdhsa_user_sgpr_kernarg_segment_ptr 1
  .amdhsa_system_sgpr_workgroup_id_x 1
.end_amdhsa_kernel
```
